```python
import torch

def _softmax(x, axis=-1):
    return torch.softmax(x, dim=axis)
def _gelu(x):
    return torch.nn.functional.gelu(x, approximate="tanh")
def _silu(x):
    return torch.nn.functional.silu(x)
def _sigmoid(x):
    return torch.sigmoid(x)
def _layernorm(x, axis=-1, eps=1e-5):
    m = x.mean(dim=axis, keepdim=True)
    v = x.var(dim=axis, keepdim=True, unbiased=False)
    return (x - m) / torch.sqrt(v + eps)
def _scatter_add(tgt, idx, src, axis=0):
    return tgt.clone().index_add_(axis, idx, src)
def _segment_sum(src, seg, n):
    out = torch.zeros((n,) + src.shape[1:], dtype=src.dtype)
    return out.index_add_(0, seg, src)
def _pad(x, pw):
    flat = tuple(v for pair in reversed(pw) for v in pair)
    return torch.nn.functional.pad(x, flat)

kernel_name = 'standalone__gqa_softmax__near_ridge'

def setup_inputs():

    _w = (lambda a: (lambda t: t.to(torch.bfloat16) if t.is_floating_point() else t)(torch.as_tensor(a)))
    B, Hq, Hkv, Sq, Sk, D = 8, 16, 8, 512, 512, 256
    return {
        "q": _w((lambda *s: torch.randn(*s, dtype=torch.bfloat16) * 0.8)(B, Hq, Sq, D)),
        "k": _w((lambda *s: torch.randn(*s, dtype=torch.bfloat16) * 0.8)(B, Hkv, Sk, D)),
        "v": _w((lambda *s: torch.randn(*s, dtype=torch.bfloat16) * 0.05)(B, Hkv, Sk, D)),
    }

def reference(q, k, v):
    B, Hq, Sq, D = q.shape
    Hkv = k.shape[1]
    rep = Hq // Hkv
    k = (lambda x, n, axis: torch.repeat_interleave(x, n, dim=axis))(k, rep, axis=1)
    v = (lambda x, n, axis: torch.repeat_interleave(x, n, dim=axis))(v, rep, axis=1)
    scale = D ** -0.5
    scores = torch.einsum("bhqd,bhkd->bhqk", q, k) * scale
    p = _softmax(scores, axis=-1)
    return torch.einsum("bhqk,bhkd->bhqd", p, v)
```

```asm
; @launch grid=(256,1,1) block=(256,1,1) lds=152128
.amdgcn_target "amdgcn-amd-amdhsa--gfx950"
.text
.globl standalone__gqa_softmax__near_ridge_kernel
.p2align 8
.type standalone__gqa_softmax__near_ridge_kernel,@function
standalone__gqa_softmax__near_ridge_kernel:
    s_load_dwordx4 s[4:7], s[0:1], 0
    s_load_dwordx4 s[32:35], s[0:1], 16
    v_lshrrev_b32 v1, 6, v0
    s_cmp_ge_u32 s2, 256
    s_cbranch_scc1 L_end
    v_readfirstlane_b32 s24, v1
    s_getpc_b64 s[92:93]
L_pc:
    s_lshr_b32 s38, s2, 3
    s_lshl_b32 s38, s38, 11
    v_lshl_add_u32 v3, v0, 3, s38
    v_min_u32 v2, L_code_end-L_pc-4, v3
    v_mov_b32 v17, s93
    v_add_co_u32 v16, vcc, s92, v2
    s_nop 1
    v_addc_co_u32 v17, vcc, 0, v17, vcc
    global_load_dword v11, v[16:17], off
    v_lshlrev_b32 v2, 12, v1
    v_and_b32 v0, 63, v0
    v_lshlrev_b32 v6, 4, v0
    v_add_u32 v4, v2, v6
    s_and_b32 s38, s2, 7
    s_lshl_b32 s38, s38, 3
    s_lshr_b32 s39, s2, 5
    s_add_u32 s38, s38, s39
    s_lshl_b32 s37, s38, 18
    s_and_b32 s96, s38, 15
    s_lshl_b32 s96, s96, 14
    s_bfe_u32 s3, s2, 0x20003
    s_mov_b32 s97, 0
    s_lshl_b32 s3, s3, 2
    s_add_u32 s3, s3, s24
    s_lshl_b32 s36, s3, 15
    s_lshl_b32 s38, s38, 19
    s_add_u32 s36, s36, s38
    s_mul_i32 s25, s24, 4224
    s_mov_b32 s14, 262144
    s_mov_b32 s15, 0x20000
    s_mov_b32 s10, 32768
    s_mov_b32 s11, 0x20000
    s_mov_b32 s27, 0
    s_getreg_b32 s94, hwreg(HW_REG_XCC_ID, 0, 3)
    s_lshl_b32 s94, s94, 2
    s_lshr_b32 s94, 0x3030303, s94
    s_and_b32 s94, s94, 15
    v_mov_b32 v12, 0xff800000
    v_mov_b32 v13, 0xff800000
    v_mov_b32 v14, 0xff800000
    v_mov_b32 v15, 0xff800000
    s_waitcnt lgkmcnt(0)
    s_add_u32 s12, s6, s37
    s_addc_u32 s13, s7, 0
    s_add_u32 s8, s4, s36
    s_addc_u32 s9, s5, 0
L_start:
    s_add_u32 m0, s25, 67584
    s_xor_b32 s28, s96, 0
    buffer_load_dwordx4 v4, s[12:15], s28 offen offset:0 nt lds
    s_add_u32 m0, s25, 84480
    s_xor_b32 s29, s97, 0
    buffer_load_dwordx4 v6, s[8:11], s29 offen offset:0 nt lds
    s_add_u32 m0, s25, 67616
    s_nop 0
    buffer_load_dwordx4 v4, s[12:15], s28 offen offset:1024 nt lds
    s_add_u32 m0, s25, 84512
    s_nop 0
    buffer_load_dwordx4 v6, s[8:11], s29 offen offset:1024 nt lds
    s_add_u32 m0, s25, 67648
    s_nop 0
    buffer_load_dwordx4 v4, s[12:15], s28 offen offset:2048 nt lds
    s_add_u32 m0, s25, 67680
    s_nop 0
    buffer_load_dwordx4 v4, s[12:15], s28 offen offset:3072 nt lds
    s_add_u32 m0, s25, 84544
    s_nop 0
    buffer_load_dwordx4 v6, s[8:11], s29 offen offset:2048 nt lds
    s_add_u32 m0, s25, 50688
    s_xor_b32 s28, s96, 16384
    buffer_load_dwordx4 v4, s[12:15], s28 offen offset:0 nt lds
    s_add_u32 m0, s25, 84576
    s_nop 0
    buffer_load_dwordx4 v6, s[8:11], s29 offen offset:3072 nt lds
    s_add_u32 m0, s25, 50720
    s_nop 0
    buffer_load_dwordx4 v4, s[12:15], s28 offen offset:1024 nt lds
    s_add_u32 m0, s25, 101376
    s_xor_b32 s29, s97, 4096
    buffer_load_dwordx4 v6, s[8:11], s29 offen offset:0 nt lds
    s_add_u32 m0, s25, 50752
    s_nop 0
    buffer_load_dwordx4 v4, s[12:15], s28 offen offset:2048 nt lds
    s_add_u32 m0, s25, 50784
    s_nop 0
    buffer_load_dwordx4 v4, s[12:15], s28 offen offset:3072 nt lds
    s_add_u32 m0, s25, 101408
    s_nop 0
    buffer_load_dwordx4 v6, s[8:11], s29 offen offset:1024 nt lds
    s_add_u32 s20, s34, s36
    s_addc_u32 s21, s35, 0
    s_mov_b32 s22, 32768
    s_mov_b32 s23, 0x20000
    s_add_u32 s16, s32, s37
    s_addc_u32 s17, s33, 0
    s_mov_b32 s18, 262144
    s_mov_b32 s19, 0x20000
    s_mov_b32 s26, 0x3db8aa3b
    s_mov_b32 s31, 0x27800000
    s_bfe_u32 s38, s2, 0x20005
    s_lshl_b32 s38, s38, 7
    s_and_b32 s30, s96, 196608
    s_or_b32 s98, s30, s38
    s_and_b32 s99, s97, 24576
    s_or_b32 s99, s99, s38
    v_and_b32 v16, 15, v0
    v_lshrrev_b32 v17, 4, v0
    v_mul_u32_u24 v24, 1056, v16
    v_lshl_add_u32 v24, v17, 4, v24
    v_add_u32 v25, 67584, v24
    v_add_u32 v26, 135168, v24
    v_and_b32 v18, 3, v0
    v_mul_u32_u24 v7, 1056, v18
    v_bfe_u32 v19, v0, 2, 1
    v_mul_u32_u24 v19, 16896, v19
    v_add_u32 v7, v7, v19
    v_lshrrev_b32 v19, 3, v16
    v_lshl_add_u32 v7, v19, 9, v7
    v_lshl_add_u32 v7, v17, 4, v7
    s_add_u32 s38, s25, 84480
    v_add_u32 v7, s38, v7
    v_lshlrev_b32 v8, 9, v19
    v_and_b32 v19, 7, v0
    v_lshl_add_u32 v8, v19, 10, v8
    v_lshl_add_u32 v8, v17, 4, v8
    s_and_b32 s38, s97, 4096
    v_xor_b32 v8, s38, v8
    v_bfe_u32 v16, v0, 2, 2
    v_bfe_u32 v2, v0, 2, 1
    v_mul_u32_u24 v1, 1032, v2
    v_bfe_u32 v2, v0, 3, 1
    v_mul_u32_u24 v2, 2112, v2
    v_add_u32 v1, v1, v2
    v_lshl_add_u32 v1, v17, 7, v1
    v_lshl_add_u32 v1, v18, 4, v1
    v_add_u32 v2, 67584, v1
    v_add_u32 v3, 135168, v1
    v_bfe_u32 v16, v0, 3, 2
    v_lshlrev_b32 v5, 12, v16
    v_lshrrev_b32 v16, 5, v0
    v_lshl_add_u32 v5, v16, 9, v5
    v_lshl_add_u32 v5, v19, 4, v5
    s_lshl_b32 s39, s24, 14
    s_xor_b32 s39, s39, s96
    s_and_b32 s39, s39, 49152
    v_add_u32 v5, s39, v5
    s_mul_i32 s39, s3, 2048
    v_mul_u32_u24 v10, 32, v0
    v_add_u32 v10, s39, v10
    s_lshl_b32 s38, s24, 2
    s_add_u32 s38, s38, 152064
    v_mov_b32 v9, s38
    v_and_b32 v16, 3, v0
    v_add_u32 v16, -1, v16
    v_ashrrev_i32 v16, 31, v16
    v_and_b32 v16, 0x3f803f80, v16
    v_accvgpr_write_b32 a252, v16
    v_accvgpr_write_b32 a253, v16
    v_accvgpr_write_b32 a254, v16
    v_accvgpr_write_b32 a255, v16
    s_mov_b64 vcc, -1
    s_cmp_eq_u32 s24, 0
    s_cbranch_scc1 L_pad0
    s_cmp_eq_u32 s24, 1
    s_cbranch_scc1 L_pad1
    s_cmp_eq_u32 s24, 2
    s_cbranch_scc1 L_pad2
    s_branch L_pad3
L_warm_done:
    s_mov_b64 vcc, 0
    s_add_u32 m0, s25, 101440
    s_waitcnt vmcnt(7)
    buffer_load_dwordx4 v6, s[8:11], s29 offen offset:2048 nt lds
    s_add_u32 m0, s25, 101472
    s_waitcnt vmcnt(7)
    buffer_load_dwordx4 v6, s[8:11], s29 offen offset:3072 nt lds
    s_add_u32 m0, s25, 0
    s_xor_b32 s28, s96, 32768
    s_waitcnt vmcnt(7)
    buffer_load_dwordx4 v4, s[12:15], s28 offen offset:0 nt lds
    s_add_u32 m0, s25, 118272
    s_xor_b32 s29, s97, 8192
    s_waitcnt vmcnt(7)
    buffer_load_dwordx4 v6, s[8:11], s29 offen offset:0 nt lds
    s_add_u32 m0, s25, 32
    s_waitcnt vmcnt(7)
    buffer_load_dwordx4 v4, s[12:15], s28 offen offset:1024 nt lds
    s_add_u32 m0, s25, 118304
    s_waitcnt vmcnt(7)
    buffer_load_dwordx4 v6, s[8:11], s29 offen offset:1024 nt lds
    s_add_u32 m0, s25, 64
    s_waitcnt vmcnt(7)
    buffer_load_dwordx4 v4, s[12:15], s28 offen offset:2048 nt lds
    s_add_u32 m0, s25, 96
    s_waitcnt vmcnt(7)
    buffer_load_dwordx4 v4, s[12:15], s28 offen offset:3072 nt lds
    s_add_u32 m0, s25, 118336
    s_waitcnt vmcnt(7)
    buffer_load_dwordx4 v6, s[8:11], s29 offen offset:2048 nt lds
    s_add_u32 m0, s25, 16896
    s_xor_b32 s28, s96, 49152
    s_waitcnt vmcnt(8)
    buffer_load_dwordx4 v4, s[12:15], s28 offen offset:0 nt lds
    s_branch L_main
.p2align 12
L_main:
L_pad0:
    s_cbranch_vccnz L_pad4
    s_waitcnt vmcnt(8)
    s_barrier
    ds_read_b128 v[64:67], v25 offset:0
    ds_read_b128 v[68:71], v25 offset:64
    ds_read_b128 v[72:75], v25 offset:128
    ds_read_b128 v[76:79], v25 offset:192
    ds_read_b128 v[80:83], v25 offset:256
    ds_read_b128 v[84:87], v25 offset:320
    ds_read_b128 v[88:91], v25 offset:384
    ds_read_b128 v[92:95], v25 offset:448
    ds_read_b128 v[96:99], v25 offset:512
    ds_read_b128 v[100:103], v25 offset:576
    ds_read_b128 v[104:107], v25 offset:640
    ds_read_b128 a[0:3], v7 offset:0
    ds_read_b128 a[4:7], v7 offset:64
    ds_read_b128 a[8:11], v7 offset:128
    ds_read_b128 a[12:15], v7 offset:192
    ds_read_b128 a[16:19], v7 offset:256
    ds_read_b128 a[20:23], v7 offset:320
    ds_read_b128 a[24:27], v7 offset:384
    ds_read_b128 a[28:31], v7 offset:448
    s_waitcnt lgkmcnt(7)
    v_mfma_f32_16x16x32_bf16 v[32:35], v[64:67], a[0:3], 0
    s_waitcnt lgkmcnt(6)
    ds_read_b128 v[108:111], v25 offset:704
    v_mfma_f32_16x16x32_bf16 v[32:35], v[68:71], a[4:7], v[32:35]
    s_waitcnt lgkmcnt(6)
    s_add_u32 m0, s25, 118368
    ds_read_b128 v[112:115], v25 offset:768
    v_mfma_f32_16x16x32_bf16 v[32:35], v[72:75], a[8:11], v[32:35]
    s_waitcnt lgkmcnt(6)
    ds_read_b128 v[116:119], v25 offset:832
    buffer_load_dwordx4 v6, s[8:11], s29 offen offset:3072 nt lds
    v_mfma_f32_16x16x32_bf16 v[32:35], v[76:79], a[12:15], v[32:35]
    s_waitcnt lgkmcnt(6)
    ds_read_b128 v[120:123], v25 offset:896
    v_mfma_f32_16x16x32_bf16 v[32:35], v[80:83], a[16:19], v[32:35]
    s_waitcnt lgkmcnt(6)
    ds_read_b128 v[124:127], v25 offset:960
    v_mfma_f32_16x16x32_bf16 v[32:35], v[84:87], a[20:23], v[32:35]
    s_waitcnt lgkmcnt(5)
    ds_read_b128 v[128:131], v24 offset:50688
    v_mfma_f32_16x16x32_bf16 v[32:35], v[88:91], a[24:27], v[32:35]
    s_add_u32 m0, s25, 16928
    ds_read_b128 v[132:135], v24 offset:50752
    v_mfma_f32_16x16x32_bf16 v[32:35], v[92:95], a[28:31], v[32:35]
    ds_read_b128 v[136:139], v24 offset:50816
    buffer_load_dwordx4 v4, s[12:15], s28 offen offset:1024 nt lds
    v_mfma_f32_16x16x32_bf16 v[36:39], v[96:99], a[0:3], 0
    s_xor_b32 s29, s97, 12288
    ds_read_b128 v[140:143], v24 offset:50880
    v_mfma_f32_16x16x32_bf16 v[36:39], v[100:103], a[4:7], v[36:39]
    s_add_u32 m0, s25, 135168
    ds_read_b128 v[144:147], v24 offset:50944
    v_mfma_f32_16x16x32_bf16 v[36:39], v[104:107], a[8:11], v[36:39]
    s_waitcnt lgkmcnt(7)
    ds_read_b128 v[148:151], v24 offset:51008
    buffer_load_dwordx4 v6, s[8:11], s29 offen offset:0 nt lds
    v_mfma_f32_16x16x32_bf16 v[36:39], v[108:111], a[12:15], v[36:39]
    ds_read_b128 v[152:155], v24 offset:51072
    v_max3_f32 v20, v32, v33, v12
    v_mfma_f32_16x16x32_bf16 v[36:39], v[112:115], a[16:19], v[36:39]
    ds_read_b128 v[156:159], v24 offset:51136
    v_max3_f32 v20, v34, v35, v20
    v_mfma_f32_16x16x32_bf16 v[36:39], v[116:119], a[20:23], v[36:39]
    s_waitcnt lgkmcnt(7)
    ds_read_b128 v[160:163], v24 offset:51200
    v_mov_b32 v21, v20
    v_mfma_f32_16x16x32_bf16 v[36:39], v[120:123], a[24:27], v[36:39]
    s_add_u32 m0, s25, 16960
    ds_read_b128 v[164:167], v24 offset:51264
    v_mfma_f32_16x16x32_bf16 v[36:39], v[124:127], a[28:31], v[36:39]
    ds_read_b128 v[168:171], v24 offset:51328
    buffer_load_dwordx4 v4, s[12:15], s28 offen offset:2048 nt lds
    v_mfma_f32_16x16x32_bf16 v[40:43], v[128:131], a[0:3], 0
    s_waitcnt lgkmcnt(7)
    ds_read_b128 v[172:175], v24 offset:51392
    v_mfma_f32_16x16x32_bf16 v[40:43], v[132:135], a[4:7], v[40:43]
    ds_read_b128 v[176:179], v24 offset:51456
    v_mfma_f32_16x16x32_bf16 v[40:43], v[136:139], a[8:11], v[40:43]
    ds_read_b128 v[180:183], v24 offset:51520
    v_mfma_f32_16x16x32_bf16 v[40:43], v[140:143], a[12:15], v[40:43]
    s_waitcnt lgkmcnt(7)
    ds_read_b128 v[184:187], v24 offset:51584
    v_permlane16_swap_b32 v20, v21
    v_max_f32 v20, v20, v21
    v_mov_b32 v21, v20
    s_nop 1
    v_permlane32_swap_b32 v20, v21
    v_max_f32 v20, v20, v21
    v_mul_f32_e64 v12, v20, -s26
    v_fma_f32 v16, v32, s26, v12
    v_exp_f32 v16, v16
    v_fma_f32 v17, v33, s26, v12
    v_exp_f32 v17, v17
    v_fma_f32 v18, v34, s26, v12
    v_exp_f32 v18, v18
    v_fma_f32 v19, v35, s26, v12
    v_cvt_pk_bf16_f32 v28, v16, v17
    v_accvgpr_write_b32 a128, v28
    v_exp_f32 v19, v19
    v_fma_f32 v16, v36, s26, v12
    v_exp_f32 v16, v16
    v_fma_f32 v17, v37, s26, v12
    v_cvt_pk_bf16_f32 v29, v18, v19
    v_accvgpr_write_b32 a129, v29
    v_exp_f32 v17, v17
    v_fma_f32 v18, v38, s26, v12
    v_exp_f32 v18, v18
    v_fma_f32 v19, v39, s26, v12
    v_cvt_pk_bf16_f32 v28, v16, v17
    v_accvgpr_write_b32 a130, v28
    v_exp_f32 v19, v19
    s_add_u32 m0, s25, 16992
    s_waitcnt vmcnt(8)
    buffer_load_dwordx4 v4, s[12:15], s28 offen offset:3072 nt lds
    s_add_u32 m0, s25, 135200
    s_waitcnt vmcnt(8)
    buffer_load_dwordx4 v6, s[8:11], s29 offen offset:1024 nt lds
    v_mfma_f32_16x16x32_bf16 v[40:43], v[144:147], a[16:19], v[40:43]
    s_waitcnt vmcnt(8) lgkmcnt(7)
    ds_read_b128 v[188:191], v24 offset:51648
    v_mfma_f32_16x16x32_bf16 v[40:43], v[148:151], a[20:23], v[40:43]
    s_barrier
    ds_read_b128 v[192:195], v24 offset:0
    v_mfma_f32_16x16x32_bf16 v[40:43], v[152:155], a[24:27], v[40:43]
    ds_read_b128 v[196:199], v24 offset:64
    v_mfma_f32_16x16x32_bf16 v[40:43], v[156:159], a[28:31], v[40:43]
    s_waitcnt lgkmcnt(7)
    ds_read_b128 v[200:203], v24 offset:128
    v_mfma_f32_16x16x32_bf16 v[32:35], v[160:163], a[0:3], 0
    ds_read_b128 v[204:207], v24 offset:192
    v_mfma_f32_16x16x32_bf16 v[32:35], v[164:167], a[4:7], v[32:35]
    ds_read_b128 v[208:211], v24 offset:256
    v_mfma_f32_16x16x32_bf16 v[32:35], v[168:171], a[8:11], v[32:35]
    s_waitcnt lgkmcnt(7)
    ds_read_b128 v[212:215], v24 offset:320
    v_mfma_f32_16x16x32_bf16 v[32:35], v[172:175], a[12:15], v[32:35]
    ds_read_b128 v[216:219], v24 offset:384
    v_fma_f32 v16, v40, s26, v12
    v_mfma_f32_16x16x32_bf16 v[32:35], v[176:179], a[16:19], v[32:35]
    ds_read_b128 v[220:223], v24 offset:448
    v_mfma_f32_16x16x32_bf16 v[32:35], v[180:183], a[20:23], v[32:35]
    s_waitcnt lgkmcnt(7)
    ds_read_b128 v[224:227], v24 offset:512
    v_mfma_f32_16x16x32_bf16 v[32:35], v[184:187], a[24:27], v[32:35]
    s_add_u32 m0, s25, 135232
    ds_read_b128 v[228:231], v24 offset:576
    v_mfma_f32_16x16x32_bf16 v[32:35], v[188:191], a[28:31], v[32:35]
    ds_read_b128 v[232:235], v24 offset:640
    buffer_load_dwordx4 v6, s[8:11], s29 offen offset:2048 nt lds
    v_mfma_f32_16x16x32_bf16 v[36:39], v[192:195], a[0:3], 0
    s_waitcnt lgkmcnt(7)
    ds_read_b128 v[236:239], v24 offset:704
    v_mfma_f32_16x16x32_bf16 v[36:39], v[196:199], a[4:7], v[36:39]
    s_add_u32 m0, s25, 135264
    ds_read_b128 v[240:243], v24 offset:768
    v_mfma_f32_16x16x32_bf16 v[36:39], v[200:203], a[8:11], v[36:39]
    ds_read_b128 v[244:247], v24 offset:832
    buffer_load_dwordx4 v6, s[8:11], s29 offen offset:3072 nt lds
    v_mfma_f32_16x16x32_bf16 v[36:39], v[204:207], a[12:15], v[36:39]
    s_waitcnt lgkmcnt(7)
    ds_read_b128 v[248:251], v24 offset:896
    v_exp_f32 v16, v16
    v_fma_f32 v17, v41, s26, v12
    v_cvt_pk_bf16_f32 v29, v18, v19
    v_accvgpr_write_b32 a131, v29
    v_exp_f32 v17, v17
    v_fma_f32 v18, v42, s26, v12
    v_exp_f32 v18, v18
    v_fma_f32 v19, v43, s26, v12
    v_cvt_pk_bf16_f32 v28, v16, v17
    v_accvgpr_write_b32 a132, v28
    v_exp_f32 v19, v19
    v_fma_f32 v16, v32, s26, v12
    v_exp_f32 v16, v16
    v_fma_f32 v17, v33, s26, v12
    v_cvt_pk_bf16_f32 v29, v18, v19
    v_accvgpr_write_b32 a133, v29
    v_exp_f32 v17, v17
    v_fma_f32 v18, v34, s26, v12
    v_exp_f32 v18, v18
    v_fma_f32 v19, v35, s26, v12
    v_cvt_pk_bf16_f32 v28, v16, v17
    v_accvgpr_write_b32 a134, v28
    v_exp_f32 v19, v19
    s_add_u32 m0, s25, 84480
    s_xor_b32 s29, s97, 16384
    s_waitcnt vmcnt(5)
    s_cmp_lt_u32 s94, 3
    s_cbranch_scc1 L_go32
    s_waitcnt vmcnt(2)
L_go32:
    buffer_load_dwordx4 v6, s[8:11], s29 offen offset:0 nt lds
    s_add_u32 m0, s25, 84512
    s_waitcnt vmcnt(5)
    s_cmp_lt_u32 s94, 3
    s_cbranch_scc1 L_go33
    s_waitcnt vmcnt(2)
L_go33:
    buffer_load_dwordx4 v6, s[8:11], s29 offen offset:1024 nt lds
    v_mfma_f32_16x16x32_bf16 v[36:39], v[208:211], a[16:19], v[36:39]
    s_waitcnt vmcnt(5) lgkmcnt(7)
    ds_read_b128 v[252:255], v24 offset:960
    v_mfma_f32_16x16x32_bf16 v[36:39], v[212:215], a[20:23], v[36:39]
    s_barrier
    ds_read_b128 a[192:195], v24 offset:16896
    v_mfma_f32_16x16x32_bf16 v[36:39], v[216:219], a[24:27], v[36:39]
    s_add_u32 m0, s25, 84544
    ds_read_b128 a[196:199], v24 offset:16960
    v_mfma_f32_16x16x32_bf16 v[36:39], v[220:223], a[28:31], v[36:39]
    s_waitcnt lgkmcnt(7)
    ds_read_b128 a[200:203], v24 offset:17024
    buffer_load_dwordx4 v6, s[8:11], s29 offen offset:2048 nt lds
    v_mfma_f32_16x16x32_bf16 v[40:43], v[224:227], a[0:3], 0
    ds_read_b128 a[204:207], v24 offset:17088
    v_mfma_f32_16x16x32_bf16 v[40:43], v[228:231], a[4:7], v[40:43]
    ds_read_b128 a[208:211], v24 offset:17152
    v_mfma_f32_16x16x32_bf16 v[40:43], v[232:235], a[8:11], v[40:43]
    s_waitcnt lgkmcnt(7)
    ds_read_b128 a[212:215], v24 offset:17216
    v_mfma_f32_16x16x32_bf16 v[40:43], v[236:239], a[12:15], v[40:43]
    ds_read_b128 a[216:219], v24 offset:17280
    v_fma_f32 v16, v36, s26, v12
    v_mfma_f32_16x16x32_bf16 v[40:43], v[240:243], a[16:19], v[40:43]
    ds_read_b128 a[220:223], v24 offset:17344
    v_exp_f32 v16, v16
    v_fma_f32 v17, v37, s26, v12
    v_mfma_f32_16x16x32_bf16 v[40:43], v[244:247], a[20:23], v[40:43]
    s_waitcnt lgkmcnt(7)
    ds_read_b128 a[224:227], v24 offset:17408
    v_cvt_pk_bf16_f32 v29, v18, v19
    v_mfma_f32_16x16x32_bf16 v[40:43], v[248:251], a[24:27], v[40:43]
    s_add_u32 m0, s25, 84576
    ds_read_b128 a[228:231], v24 offset:17472
    v_accvgpr_write_b32 a135, v29
    v_mfma_f32_16x16x32_bf16 v[40:43], v[252:255], a[28:31], v[40:43]
    ds_read_b128 a[232:235], v24 offset:17536
    buffer_load_dwordx4 v6, s[8:11], s29 offen offset:3072 nt lds
    v_exp_f32 v17, v17
    v_fma_f32 v18, v38, s26, v12
    v_mfma_f32_16x16x32_bf16 a[236:239], a[252:255], a[128:131], 0
    v_exp_f32 v18, v18
    v_fma_f32 v19, v39, s26, v12
    s_add_u32 m0, s25, 101376
    s_xor_b32 s29, s97, 20480
    s_waitcnt vmcnt(5)
    s_cmp_lt_u32 s94, 3
    s_cbranch_scc1 L_go36
    s_waitcnt vmcnt(2)
L_go36:
    buffer_load_dwordx4 v6, s[8:11], s29 offen offset:0 nt lds
    v_mfma_f32_16x16x32_bf16 v[32:35], a[192:195], a[0:3], 0
    s_waitcnt vmcnt(5) lgkmcnt(6)
    ds_read_b128 a[172:175], v24 offset:17600
    v_cvt_pk_bf16_f32 v28, v16, v17
    v_mfma_f32_16x16x32_bf16 v[32:35], a[196:199], a[4:7], v[32:35]
    s_add_u32 m0, s25, 101408
    ds_read_b128 a[176:179], v24 offset:17664
    v_accvgpr_write_b32 a136, v28
    v_mfma_f32_16x16x32_bf16 v[32:35], a[200:203], a[8:11], v[32:35]
    ds_read_b128 a[180:183], v24 offset:17728
    buffer_load_dwordx4 v6, s[8:11], s29 offen offset:1024 nt lds
    v_exp_f32 v19, v19
    v_mfma_f32_16x16x32_bf16 v[32:35], a[204:207], a[12:15], v[32:35]
    ds_read_b128 a[184:187], v24 offset:17792
    ds_read_b128 a[32:35], v7 offset:33792
    v_mfma_f32_16x16x32_bf16 v[32:35], a[208:211], a[16:19], v[32:35]
    s_waitcnt lgkmcnt(7)
    ds_read_b128 a[188:191], v24 offset:17856
    ds_read_b128 a[36:39], v7 offset:33856
    v_mfma_f32_16x16x32_bf16 v[32:35], a[212:215], a[20:23], v[32:35]
    ds_read_b128 a[40:43], v7 offset:33920
    v_fma_f32 v16, v40, s26, v12
    v_mfma_f32_16x16x32_bf16 v[32:35], a[216:219], a[24:27], v[32:35]
    ds_read_b128 a[44:47], v7 offset:33984
    v_mfma_f32_16x16x32_bf16 v[32:35], a[220:223], a[28:31], v[32:35]
    ds_read_b128 a[48:51], v7 offset:34048
    v_exp_f32 v16, v16
    v_mfma_f32_16x16x32_bf16 v[36:39], a[224:227], a[0:3], 0
    s_waitcnt lgkmcnt(9)
    ds_read_b128 a[52:55], v7 offset:34112
    v_fma_f32 v17, v41, s26, v12
    v_mfma_f32_16x16x32_bf16 v[36:39], a[228:231], a[4:7], v[36:39]
    ds_read_b128 a[56:59], v7 offset:34176
    v_cvt_pk_bf16_f32 v29, v18, v19
    v_mfma_f32_16x16x32_bf16 v[36:39], a[232:235], a[8:11], v[36:39]
    s_add_u32 m0, s25, 101440
    ds_read_b128 a[60:63], v7 offset:34240
    v_accvgpr_write_b32 a137, v29
    v_mfma_f32_16x16x32_bf16 v[36:39], a[172:175], a[12:15], v[36:39]
    s_waitcnt lgkmcnt(8)
    buffer_load_dwordx4 v6, s[8:11], s29 offen offset:2048 nt lds
    v_mfma_f32_16x16x32_bf16 v[36:39], a[176:179], a[16:19], v[36:39]
    v_exp_f32 v17, v17
    v_mfma_f32_16x16x32_bf16 v[36:39], a[180:183], a[20:23], v[36:39]
    v_fma_f32 v18, v42, s26, v12
    v_mfma_f32_16x16x32_bf16 v[36:39], a[184:187], a[24:27], v[36:39]
    s_waitcnt lgkmcnt(4)
    v_exp_f32 v18, v18
    v_mfma_f32_16x16x32_bf16 v[36:39], a[188:191], a[28:31], v[36:39]
    v_fma_f32 v19, v43, s26, v12
    v_cvt_pk_bf16_f32 v28, v16, v17
    v_mfma_f32_16x16x32_bf16 a[236:239], a[252:255], a[132:135], a[236:239]
    v_accvgpr_write_b32 a138, v28
    v_exp_f32 v19, v19
    v_fma_f32 v16, v32, s26, v12
    v_mfma_f32_16x16x32_bf16 v[40:43], v[64:67], a[32:35], 0
    v_exp_f32 v16, v16
    v_mfma_f32_16x16x32_bf16 v[40:43], v[68:71], a[36:39], v[40:43]
    v_fma_f32 v17, v33, s26, v12
    v_cvt_pk_bf16_f32 v29, v18, v19
    v_mfma_f32_16x16x32_bf16 v[40:43], v[72:75], a[40:43], v[40:43]
    v_accvgpr_write_b32 a139, v29
    v_mfma_f32_16x16x32_bf16 v[40:43], v[76:79], a[44:47], v[40:43]
    s_waitcnt lgkmcnt(0)
    v_exp_f32 v17, v17
    v_mfma_f32_16x16x32_bf16 v[40:43], v[80:83], a[48:51], v[40:43]
    v_fma_f32 v18, v34, s26, v12
    v_mfma_f32_16x16x32_bf16 v[40:43], v[84:87], a[52:55], v[40:43]
    v_exp_f32 v18, v18
    v_mfma_f32_16x16x32_bf16 v[40:43], v[88:91], a[56:59], v[40:43]
    s_add_u32 m0, s25, 101472
    v_fma_f32 v19, v35, s26, v12
    v_cvt_pk_bf16_f32 v28, v16, v17
    v_mfma_f32_16x16x32_bf16 v[40:43], v[92:95], a[60:63], v[40:43]
    buffer_load_dwordx4 v6, s[8:11], s29 offen offset:3072 nt lds
    v_accvgpr_write_b32 a140, v28
    v_exp_f32 v19, v19
    v_fma_f32 v16, v36, s26, v12
    v_mfma_f32_16x16x32_bf16 v[32:35], v[96:99], a[32:35], 0
    v_exp_f32 v16, v16
    v_mfma_f32_16x16x32_bf16 v[32:35], v[100:103], a[36:39], v[32:35]
    v_fma_f32 v17, v37, s26, v12
    v_cvt_pk_bf16_f32 v29, v18, v19
    v_mfma_f32_16x16x32_bf16 v[32:35], v[104:107], a[40:43], v[32:35]
    v_accvgpr_write_b32 a141, v29
    v_mfma_f32_16x16x32_bf16 v[32:35], v[108:111], a[44:47], v[32:35]
    v_exp_f32 v17, v17
    v_mfma_f32_16x16x32_bf16 v[32:35], v[112:115], a[48:51], v[32:35]
    v_fma_f32 v18, v38, s26, v12
    v_mfma_f32_16x16x32_bf16 v[32:35], v[116:119], a[52:55], v[32:35]
    v_exp_f32 v18, v18
    v_mfma_f32_16x16x32_bf16 v[32:35], v[120:123], a[56:59], v[32:35]
    v_fma_f32 v19, v39, s26, v12
    v_cvt_pk_bf16_f32 v28, v16, v17
    v_mfma_f32_16x16x32_bf16 v[32:35], v[124:127], a[60:63], v[32:35]
    v_accvgpr_write_b32 a142, v28
    v_exp_f32 v19, v19
    v_max3_f32 v20, v40, v41, v13
    v_mfma_f32_16x16x32_bf16 a[236:239], a[252:255], a[136:139], a[236:239]
    v_max3_f32 v20, v42, v43, v20
    v_mov_b32 v21, v20
    v_mfma_f32_16x16x32_bf16 v[36:39], v[128:131], a[32:35], 0
    v_cvt_pk_bf16_f32 v29, v18, v19
    v_accvgpr_write_b32 a143, v29
    v_mfma_f32_16x16x32_bf16 v[36:39], v[132:135], a[36:39], v[36:39]
    v_permlane16_swap_b32 v20, v21
    v_mfma_f32_16x16x32_bf16 v[36:39], v[136:139], a[40:43], v[36:39]
    v_max_f32 v20, v20, v21
    v_mov_b32 v21, v20
    v_mfma_f32_16x16x32_bf16 v[36:39], v[140:143], a[44:47], v[36:39]
    s_nop 0
    v_permlane32_swap_b32 v20, v21
    v_mfma_f32_16x16x32_bf16 v[36:39], v[144:147], a[48:51], v[36:39]
    v_max_f32 v20, v20, v21
    v_mul_f32_e64 v13, v20, -s26
    v_mfma_f32_16x16x32_bf16 v[36:39], v[148:151], a[52:55], v[36:39]
    v_fma_f32 v16, v40, s26, v13
    v_mfma_f32_16x16x32_bf16 v[36:39], v[152:155], a[56:59], v[36:39]
    v_exp_f32 v16, v16
    v_mfma_f32_16x16x32_bf16 v[36:39], v[156:159], a[60:63], v[36:39]
    v_fma_f32 v17, v41, s26, v13
    v_exp_f32 v17, v17
    v_fma_f32 v18, v42, s26, v13
    v_exp_f32 v18, v18
    v_fma_f32 v19, v43, s26, v13
    v_mfma_f32_16x16x32_bf16 v[40:43], v[160:163], a[32:35], 0
    v_cvt_pk_bf16_f32 v28, v16, v17
    v_accvgpr_write_b32 a144, v28
    v_mfma_f32_16x16x32_bf16 v[40:43], v[164:167], a[36:39], v[40:43]
    v_exp_f32 v19, v19
    v_mfma_f32_16x16x32_bf16 v[40:43], v[168:171], a[40:43], v[40:43]
    v_fma_f32 v16, v32, s26, v13
    v_mfma_f32_16x16x32_bf16 v[40:43], v[172:175], a[44:47], v[40:43]
    v_exp_f32 v16, v16
    v_mfma_f32_16x16x32_bf16 v[40:43], v[176:179], a[48:51], v[40:43]
    v_fma_f32 v17, v33, s26, v13
    v_cvt_pk_bf16_f32 v29, v18, v19
    v_mfma_f32_16x16x32_bf16 v[40:43], v[180:183], a[52:55], v[40:43]
    v_accvgpr_write_b32 a145, v29
    v_mfma_f32_16x16x32_bf16 v[40:43], v[184:187], a[56:59], v[40:43]
    s_xor_b32 s28, s96, 65536
    v_exp_f32 v17, v17
    v_mfma_f32_16x16x32_bf16 v[40:43], v[188:191], a[60:63], v[40:43]
    s_add_u32 m0, s25, 33792
    v_fma_f32 v18, v34, s26, v13
    v_exp_f32 v18, v18
    v_mfma_f32_16x16x32_bf16 a[236:239], a[252:255], a[140:143], a[236:239]
    buffer_load_dwordx4 v4, s[12:15], s28 offen offset:0 nt lds
    v_fma_f32 v19, v35, s26, v13
    v_mfma_f32_16x16x32_bf16 v[32:35], v[192:195], a[32:35], 0
    v_cvt_pk_bf16_f32 v28, v16, v17
    v_accvgpr_write_b32 a146, v28
    v_mfma_f32_16x16x32_bf16 v[32:35], v[196:199], a[36:39], v[32:35]
    v_exp_f32 v19, v19
    v_mfma_f32_16x16x32_bf16 v[32:35], v[200:203], a[40:43], v[32:35]
    v_fma_f32 v16, v36, s26, v13
    v_mfma_f32_16x16x32_bf16 v[32:35], v[204:207], a[44:47], v[32:35]
    v_exp_f32 v16, v16
    v_mfma_f32_16x16x32_bf16 v[32:35], v[208:211], a[48:51], v[32:35]
    v_fma_f32 v17, v37, s26, v13
    v_cvt_pk_bf16_f32 v29, v18, v19
    v_mfma_f32_16x16x32_bf16 v[32:35], v[212:215], a[52:55], v[32:35]
    ds_read_b128 a[192:195], v24 offset:16896
    v_accvgpr_write_b32 a147, v29
    v_mfma_f32_16x16x32_bf16 v[32:35], v[216:219], a[56:59], v[32:35]
    ds_read_b128 a[196:199], v24 offset:16960
    v_mfma_f32_16x16x32_bf16 v[32:35], v[220:223], a[60:63], v[32:35]
    ds_read_b128 a[200:203], v24 offset:17024
    v_exp_f32 v17, v17
    v_fma_f32 v18, v38, s26, v13
    v_exp_f32 v18, v18
    v_fma_f32 v19, v39, s26, v13
    v_mfma_f32_16x16x32_bf16 v[36:39], v[224:227], a[32:35], 0
    s_xor_b32 s29, s97, 24576
    ds_read_b128 a[204:207], v24 offset:17088
    v_cvt_pk_bf16_f32 v28, v16, v17
    v_mfma_f32_16x16x32_bf16 v[36:39], v[228:231], a[36:39], v[36:39]
    s_add_u32 m0, s25, 118272
    ds_read_b128 a[208:211], v24 offset:17152
    v_accvgpr_write_b32 a148, v28
    v_mfma_f32_16x16x32_bf16 v[36:39], v[232:235], a[40:43], v[36:39]
    ds_read_b128 a[212:215], v24 offset:17216
    buffer_load_dwordx4 v6, s[8:11], s29 offen offset:0 nt lds
    v_mfma_f32_16x16x32_bf16 v[36:39], v[236:239], a[44:47], v[36:39]
    ds_read_b128 a[216:219], v24 offset:17280
    v_mfma_f32_16x16x32_bf16 v[36:39], v[240:243], a[48:51], v[36:39]
    ds_read_b128 a[220:223], v24 offset:17344
    v_mfma_f32_16x16x32_bf16 v[36:39], v[244:247], a[52:55], v[36:39]
    ds_read_b128 a[224:227], v24 offset:17408
    v_mfma_f32_16x16x32_bf16 v[36:39], v[248:251], a[56:59], v[36:39]
    ds_read_b128 a[228:231], v24 offset:17472
    v_mfma_f32_16x16x32_bf16 v[36:39], v[252:255], a[60:63], v[36:39]
    ds_read_b128 a[232:235], v24 offset:17536
    v_exp_f32 v19, v19
    v_fma_f32 v16, v40, s26, v13
    v_exp_f32 v16, v16
    v_fma_f32 v17, v41, s26, v13
    v_cvt_pk_bf16_f32 v29, v18, v19
    v_accvgpr_write_b32 a149, v29
    v_exp_f32 v17, v17
    v_fma_f32 v18, v42, s26, v13
    v_exp_f32 v18, v18
    v_fma_f32 v19, v43, s26, v13
    v_cvt_pk_bf16_f32 v28, v16, v17
    v_accvgpr_write_b32 a150, v28
    v_exp_f32 v19, v19
    v_fma_f32 v16, v32, s26, v13
    v_exp_f32 v16, v16
    v_fma_f32 v17, v33, s26, v13
    v_cvt_pk_bf16_f32 v29, v18, v19
    v_accvgpr_write_b32 a151, v29
    v_exp_f32 v17, v17
    v_fma_f32 v18, v34, s26, v13
    v_exp_f32 v18, v18
    v_fma_f32 v19, v35, s26, v13
    v_cvt_pk_bf16_f32 v28, v16, v17
    v_accvgpr_write_b32 a152, v28
    v_exp_f32 v19, v19
    s_add_u32 m0, s25, 33824
    s_waitcnt vmcnt(5)
    s_cmp_lt_u32 s94, 3
    s_cbranch_scc1 L_go42
    s_waitcnt vmcnt(2)
L_go42:
    buffer_load_dwordx4 v4, s[12:15], s28 offen offset:1024 nt lds
    s_add_u32 m0, s25, 118304
    s_waitcnt vmcnt(5)
    s_cmp_lt_u32 s94, 3
    s_cbranch_scc1 L_go43
    s_waitcnt vmcnt(2)
L_go43:
    buffer_load_dwordx4 v6, s[8:11], s29 offen offset:1024 nt lds
    s_add_u32 m0, s25, 33856
    s_waitcnt vmcnt(5)
    s_cmp_lt_u32 s94, 3
    s_cbranch_scc1 L_go44
    s_waitcnt vmcnt(2)
L_go44:
    buffer_load_dwordx4 v4, s[12:15], s28 offen offset:2048 nt lds
    s_add_u32 m0, s25, 33888
    s_waitcnt vmcnt(6)
    s_cmp_lt_u32 s94, 3
    s_cbranch_scc1 L_go45
    s_waitcnt vmcnt(3)
L_go45:
    buffer_load_dwordx4 v4, s[12:15], s28 offen offset:3072 nt lds
    v_mfma_f32_16x16x32_bf16 a[240:243], a[252:255], a[144:147], 0
    s_waitcnt vmcnt(6) lgkmcnt(7)
    v_mfma_f32_16x16x32_bf16 v[40:43], a[192:195], a[32:35], 0
    s_add_u32 m0, s25, 118336
    ds_read_b128 a[172:175], v24 offset:17600
    v_mfma_f32_16x16x32_bf16 v[40:43], a[196:199], a[36:39], v[40:43]
    ds_read_b128 a[176:179], v24 offset:17664
    buffer_load_dwordx4 v6, s[8:11], s29 offen offset:2048 nt lds
    v_mfma_f32_16x16x32_bf16 v[40:43], a[200:203], a[40:43], v[40:43]
    ds_read_b128 a[180:183], v24 offset:17728
    v_fma_f32 v16, v36, s26, v13
    v_mfma_f32_16x16x32_bf16 v[40:43], a[204:207], a[44:47], v[40:43]
    s_waitcnt lgkmcnt(6)
    ds_read_b128 a[184:187], v24 offset:17792
    ds_read_b128 a[64:67], v7 offset:0
    v_exp_f32 v16, v16
    v_fma_f32 v17, v37, s26, v13
    v_mfma_f32_16x16x32_bf16 v[40:43], a[208:211], a[48:51], v[40:43]
    ds_read_b128 a[188:191], v24 offset:17856
    ds_read_b128 a[68:71], v7 offset:64
    v_mfma_f32_16x16x32_bf16 v[40:43], a[212:215], a[52:55], v[40:43]
    ds_read_b128 a[72:75], v7 offset:128
    v_cvt_pk_bf16_f32 v29, v18, v19
    v_mfma_f32_16x16x32_bf16 v[40:43], a[216:219], a[56:59], v[40:43]
    ds_read_b128 a[76:79], v7 offset:192
    v_accvgpr_write_b32 a153, v29
    v_mfma_f32_16x16x32_bf16 v[40:43], a[220:223], a[60:63], v[40:43]
    s_waitcnt lgkmcnt(9)
    ds_read_b128 a[80:83], v7 offset:256
    v_exp_f32 v17, v17
    v_fma_f32 v18, v38, s26, v13
    v_exp_f32 v18, v18
    v_mfma_f32_16x16x32_bf16 v[32:35], a[224:227], a[32:35], 0
    ds_read_b128 a[84:87], v7 offset:320
    v_fma_f32 v19, v39, s26, v13
    v_mfma_f32_16x16x32_bf16 v[32:35], a[228:231], a[36:39], v[32:35]
    ds_read_b128 a[88:91], v7 offset:384
    v_cvt_pk_bf16_f32 v28, v16, v17
    v_mfma_f32_16x16x32_bf16 v[32:35], a[232:235], a[40:43], v[32:35]
    s_waitcnt lgkmcnt(9)
    ds_read_b128 a[92:95], v7 offset:448
    v_accvgpr_write_b32 a154, v28
    v_mfma_f32_16x16x32_bf16 v[32:35], a[172:175], a[44:47], v[32:35]
    v_exp_f32 v19, v19
    v_mfma_f32_16x16x32_bf16 v[32:35], a[176:179], a[48:51], v[32:35]
    v_fma_f32 v16, v40, s26, v13
    v_mfma_f32_16x16x32_bf16 v[32:35], a[180:183], a[52:55], v[32:35]
    s_waitcnt lgkmcnt(5)
    v_exp_f32 v16, v16
    v_mfma_f32_16x16x32_bf16 v[32:35], a[184:187], a[56:59], v[32:35]
    s_add_u32 m0, s25, 118368
    v_fma_f32 v17, v41, s26, v13
    v_cvt_pk_bf16_f32 v29, v18, v19
    v_mfma_f32_16x16x32_bf16 v[32:35], a[188:191], a[60:63], v[32:35]
    buffer_load_dwordx4 v6, s[8:11], s29 offen offset:3072 nt lds
    v_accvgpr_write_b32 a155, v29
    v_mfma_f32_16x16x32_bf16 a[240:243], a[252:255], a[148:151], a[240:243]
    v_exp_f32 v17, v17
    v_fma_f32 v18, v42, s26, v13
    v_mfma_f32_16x16x32_bf16 v[36:39], v[64:67], a[64:67], 0
    s_xor_b32 s29, s97, 28672
    v_exp_f32 v18, v18
    v_mfma_f32_16x16x32_bf16 v[36:39], v[68:71], a[68:71], v[36:39]
    s_add_u32 m0, s25, 135168
    v_fma_f32 v19, v43, s26, v13
    v_cvt_pk_bf16_f32 v28, v16, v17
    v_mfma_f32_16x16x32_bf16 v[36:39], v[72:75], a[72:75], v[36:39]
    s_waitcnt lgkmcnt(0)
    v_accvgpr_write_b32 a156, v28
    v_mfma_f32_16x16x32_bf16 v[36:39], v[76:79], a[76:79], v[36:39]
    buffer_load_dwordx4 v6, s[8:11], s29 offen offset:0 nt lds
    v_mfma_f32_16x16x32_bf16 v[36:39], v[80:83], a[80:83], v[36:39]
    v_exp_f32 v19, v19
    v_mfma_f32_16x16x32_bf16 v[36:39], v[84:87], a[84:87], v[36:39]
    v_fma_f32 v16, v32, s26, v13
    v_mfma_f32_16x16x32_bf16 v[36:39], v[88:91], a[88:91], v[36:39]
    v_exp_f32 v16, v16
    v_mfma_f32_16x16x32_bf16 v[36:39], v[92:95], a[92:95], v[36:39]
    v_fma_f32 v17, v33, s26, v13
    v_cvt_pk_bf16_f32 v29, v18, v19
    v_accvgpr_write_b32 a157, v29
    v_mfma_f32_16x16x32_bf16 v[40:43], v[96:99], a[64:67], 0
    v_exp_f32 v17, v17
    v_mfma_f32_16x16x32_bf16 v[40:43], v[100:103], a[68:71], v[40:43]
    v_fma_f32 v18, v34, s26, v13
    v_mfma_f32_16x16x32_bf16 v[40:43], v[104:107], a[72:75], v[40:43]
    v_exp_f32 v18, v18
    v_mfma_f32_16x16x32_bf16 v[40:43], v[108:111], a[76:79], v[40:43]
    v_fma_f32 v19, v35, s26, v13
    v_cvt_pk_bf16_f32 v28, v16, v17
    v_mfma_f32_16x16x32_bf16 v[40:43], v[112:115], a[80:83], v[40:43]
    v_accvgpr_write_b32 a158, v28
    v_mfma_f32_16x16x32_bf16 v[40:43], v[116:119], a[84:87], v[40:43]
L_pad1:
    s_cbranch_vccnz L_pad5
    v_exp_f32 v19, v19
    v_mfma_f32_16x16x32_bf16 v[40:43], v[120:123], a[88:91], v[40:43]
    v_max3_f32 v20, v36, v37, v14
    v_max3_f32 v20, v38, v39, v20
    v_mfma_f32_16x16x32_bf16 v[40:43], v[124:127], a[92:95], v[40:43]
    s_add_u32 m0, s25, 135200
    v_mov_b32 v21, v20
    v_cvt_pk_bf16_f32 v29, v18, v19
    v_mfma_f32_16x16x32_bf16 a[240:243], a[252:255], a[152:155], a[240:243]
    buffer_load_dwordx4 v6, s[8:11], s29 offen offset:1024 nt lds
    v_accvgpr_write_b32 a159, v29
    v_mfma_f32_16x16x32_bf16 v[32:35], v[128:131], a[64:67], 0
    v_permlane16_swap_b32 v20, v21
    v_mfma_f32_16x16x32_bf16 v[32:35], v[132:135], a[68:71], v[32:35]
    v_max_f32 v20, v20, v21
    v_mov_b32 v21, v20
    v_mfma_f32_16x16x32_bf16 v[32:35], v[136:139], a[72:75], v[32:35]
    s_nop 0
    v_permlane32_swap_b32 v20, v21
    v_mfma_f32_16x16x32_bf16 v[32:35], v[140:143], a[76:79], v[32:35]
    v_max_f32 v20, v20, v21
    v_mul_f32_e64 v14, v20, -s26
    v_mfma_f32_16x16x32_bf16 v[32:35], v[144:147], a[80:83], v[32:35]
    v_fma_f32 v16, v36, s26, v14
    v_exp_f32 v16, v16
    v_fma_f32 v17, v37, s26, v14
    v_exp_f32 v17, v17
    v_fma_f32 v18, v38, s26, v14
    v_mfma_f32_16x16x32_bf16 v[32:35], v[148:151], a[84:87], v[32:35]
    v_exp_f32 v18, v18
    v_mfma_f32_16x16x32_bf16 v[32:35], v[152:155], a[88:91], v[32:35]
    v_fma_f32 v19, v39, s26, v14
    v_cvt_pk_bf16_f32 v28, v16, v17
    v_mfma_f32_16x16x32_bf16 v[32:35], v[156:159], a[92:95], v[32:35]
    s_add_u32 m0, s25, 135232
    v_accvgpr_write_b32 a160, v28
    v_exp_f32 v19, v19
    v_fma_f32 v16, v40, s26, v14
    v_mfma_f32_16x16x32_bf16 v[36:39], v[160:163], a[64:67], 0
    buffer_load_dwordx4 v6, s[8:11], s29 offen offset:2048 nt lds
    v_mfma_f32_16x16x32_bf16 v[36:39], v[164:167], a[68:71], v[36:39]
    v_exp_f32 v16, v16
    v_mfma_f32_16x16x32_bf16 v[36:39], v[168:171], a[72:75], v[36:39]
    v_fma_f32 v17, v41, s26, v14
    v_cvt_pk_bf16_f32 v29, v18, v19
    v_mfma_f32_16x16x32_bf16 v[36:39], v[172:175], a[76:79], v[36:39]
    v_accvgpr_write_b32 a161, v29
    v_mfma_f32_16x16x32_bf16 v[36:39], v[176:179], a[80:83], v[36:39]
    v_exp_f32 v17, v17
    v_mfma_f32_16x16x32_bf16 v[36:39], v[180:183], a[84:87], v[36:39]
    v_fma_f32 v18, v42, s26, v14
    v_mfma_f32_16x16x32_bf16 v[36:39], v[184:187], a[88:91], v[36:39]
    v_exp_f32 v18, v18
    v_mfma_f32_16x16x32_bf16 v[36:39], v[188:191], a[92:95], v[36:39]
    v_fma_f32 v19, v43, s26, v14
    v_cvt_pk_bf16_f32 v28, v16, v17
    v_mfma_f32_16x16x32_bf16 a[240:243], a[252:255], a[156:159], a[240:243]
    v_accvgpr_write_b32 a162, v28
    v_exp_f32 v19, v19
    v_fma_f32 v16, v32, s26, v14
    v_mfma_f32_16x16x32_bf16 v[40:43], v[192:195], a[64:67], 0
    v_exp_f32 v16, v16
    v_mfma_f32_16x16x32_bf16 v[40:43], v[196:199], a[68:71], v[40:43]
    v_fma_f32 v17, v33, s26, v14
    v_cvt_pk_bf16_f32 v29, v18, v19
    v_mfma_f32_16x16x32_bf16 v[40:43], v[200:203], a[72:75], v[40:43]
    v_accvgpr_write_b32 a163, v29
    v_exp_f32 v17, v17
    v_fma_f32 v18, v34, s26, v14
    v_mfma_f32_16x16x32_bf16 v[40:43], v[204:207], a[76:79], v[40:43]
    v_exp_f32 v18, v18
    v_mfma_f32_16x16x32_bf16 v[40:43], v[208:211], a[80:83], v[40:43]
    v_fma_f32 v19, v35, s26, v14
    v_cvt_pk_bf16_f32 v28, v16, v17
    v_mfma_f32_16x16x32_bf16 v[40:43], v[212:215], a[84:87], v[40:43]
    ds_read_b128 a[192:195], v24 offset:16896
    v_accvgpr_write_b32 a164, v28
    v_exp_f32 v19, v19
    v_mfma_f32_16x16x32_bf16 v[40:43], v[216:219], a[88:91], v[40:43]
    s_add_u32 m0, s25, 135264
    ds_read_b128 a[196:199], v24 offset:16960
    v_fma_f32 v16, v36, s26, v14
    v_mfma_f32_16x16x32_bf16 v[40:43], v[220:223], a[92:95], v[40:43]
    ds_read_b128 a[200:203], v24 offset:17024
    buffer_load_dwordx4 v6, s[8:11], s29 offen offset:3072 nt lds
    v_exp_f32 v16, v16
    v_mfma_f32_16x16x32_bf16 v[32:35], v[224:227], a[64:67], 0
    ds_read_b128 a[204:207], v24 offset:17088
    v_fma_f32 v17, v37, s26, v14
    v_mfma_f32_16x16x32_bf16 v[32:35], v[228:231], a[68:71], v[32:35]
    ds_read_b128 a[208:211], v24 offset:17152
    v_cvt_pk_bf16_f32 v29, v18, v19
    v_mfma_f32_16x16x32_bf16 v[32:35], v[232:235], a[72:75], v[32:35]
    ds_read_b128 a[212:215], v24 offset:17216
    v_accvgpr_write_b32 a165, v29
    v_mfma_f32_16x16x32_bf16 v[32:35], v[236:239], a[76:79], v[32:35]
    s_xor_b32 s28, s96, 81920
    ds_read_b128 a[216:219], v24 offset:17280
    v_exp_f32 v17, v17
    v_fma_f32 v18, v38, s26, v14
    v_exp_f32 v18, v18
    v_mfma_f32_16x16x32_bf16 v[32:35], v[240:243], a[80:83], v[32:35]
    s_waitcnt vmcnt(6)
    ds_read_b128 a[220:223], v24 offset:17344
    v_fma_f32 v19, v39, s26, v14
    v_mfma_f32_16x16x32_bf16 v[32:35], v[244:247], a[84:87], v[32:35]
    s_barrier
    ds_read_b128 a[224:227], v24 offset:33792
    v_cvt_pk_bf16_f32 v28, v16, v17
    v_mfma_f32_16x16x32_bf16 v[32:35], v[248:251], a[88:91], v[32:35]
    s_add_u32 m0, s25, 67584
    ds_read_b128 a[228:231], v24 offset:33856
    v_accvgpr_write_b32 a166, v28
    v_mfma_f32_16x16x32_bf16 v[32:35], v[252:255], a[92:95], v[32:35]
    ds_read_b128 a[232:235], v24 offset:33920
    buffer_load_dwordx4 v4, s[12:15], s28 offen offset:0 nt lds
    v_mfma_f32_16x16x32_bf16 a[244:247], a[252:255], a[160:163], 0
    s_waitcnt lgkmcnt(7)
    v_exp_f32 v19, v19
    v_mfma_f32_16x16x32_bf16 v[36:39], a[192:195], a[64:67], 0
    s_add_u32 m0, s25, 67616
    ds_read_b128 a[172:175], v24 offset:33984
    v_fma_f32 v16, v40, s26, v14
    v_mfma_f32_16x16x32_bf16 v[36:39], a[196:199], a[68:71], v[36:39]
    ds_read_b128 a[176:179], v24 offset:34048
    buffer_load_dwordx4 v4, s[12:15], s28 offen offset:1024 nt lds
    v_exp_f32 v16, v16
    v_mfma_f32_16x16x32_bf16 v[36:39], a[200:203], a[72:75], v[36:39]
    ds_read_b128 a[180:183], v24 offset:34112
    v_fma_f32 v17, v41, s26, v14
    v_mfma_f32_16x16x32_bf16 v[36:39], a[204:207], a[76:79], v[36:39]
    s_waitcnt lgkmcnt(6)
    ds_read_b128 a[184:187], v24 offset:34176
    v_cvt_pk_bf16_f32 v29, v18, v19
    v_mfma_f32_16x16x32_bf16 v[36:39], a[208:211], a[80:83], v[36:39]
    ds_read_b128 a[188:191], v24 offset:34240
    v_accvgpr_write_b32 a167, v29
    v_mfma_f32_16x16x32_bf16 v[36:39], a[212:215], a[84:87], v[36:39]
    v_exp_f32 v17, v17
    v_mfma_f32_16x16x32_bf16 v[36:39], a[216:219], a[88:91], v[36:39]
    v_fma_f32 v18, v42, s26, v14
    v_mfma_f32_16x16x32_bf16 v[36:39], a[220:223], a[92:95], v[36:39]
    s_waitcnt lgkmcnt(5)
    ds_read_b128 a[192:195], v24 offset:34304
    v_exp_f32 v18, v18
    v_fma_f32 v19, v43, s26, v14
    v_cvt_pk_bf16_f32 v28, v16, v17
    v_accvgpr_write_b32 a168, v28
    v_mfma_f32_16x16x32_bf16 v[40:43], a[224:227], a[0:3], 0
    s_add_u32 m0, s25, 67648
    v_exp_f32 v19, v19
    v_mfma_f32_16x16x32_bf16 v[40:43], a[228:231], a[4:7], v[40:43]
    buffer_load_dwordx4 v4, s[12:15], s28 offen offset:2048 nt lds
    v_mfma_f32_16x16x32_bf16 v[40:43], a[232:235], a[8:11], v[40:43]
    s_waitcnt lgkmcnt(3)
    ds_read_b128 a[196:199], v24 offset:34368
    v_fma_f32 v16, v32, s26, v14
    v_mfma_f32_16x16x32_bf16 v[40:43], a[172:175], a[12:15], v[40:43]
    v_exp_f32 v16, v16
    v_mfma_f32_16x16x32_bf16 v[40:43], a[176:179], a[16:19], v[40:43]
    v_fma_f32 v17, v33, s26, v14
    v_cvt_pk_bf16_f32 v29, v18, v19
    v_mfma_f32_16x16x32_bf16 v[40:43], a[180:183], a[20:23], v[40:43]
    s_waitcnt lgkmcnt(2)
    ds_read_b128 a[200:203], v24 offset:34432
    v_accvgpr_write_b32 a169, v29
    v_mfma_f32_16x16x32_bf16 v[40:43], a[184:187], a[24:27], v[40:43]
    s_add_u32 m0, s25, 67680
    v_exp_f32 v17, v17
    v_mfma_f32_16x16x32_bf16 v[40:43], a[188:191], a[28:31], v[40:43]
    buffer_load_dwordx4 v4, s[12:15], s28 offen offset:3072 nt lds
    v_fma_f32 v18, v34, s26, v14
    v_exp_f32 v18, v18
    v_fma_f32 v19, v35, s26, v14
    v_cvt_pk_bf16_f32 v28, v16, v17
    v_mfma_f32_16x16x32_bf16 a[244:247], a[252:255], a[164:167], a[244:247]
    v_accvgpr_write_b32 a170, v28
    v_exp_f32 v19, v19
    v_mfma_f32_16x16x32_bf16 v[32:35], a[188:191], a[60:63], 0
    ds_read_b128 a[204:207], v24 offset:34496
    v_fma_f32 v16, v36, s26, v14
    v_mfma_f32_16x16x32_bf16 v[32:35], a[184:187], a[56:59], v[32:35]
    s_xor_b32 s28, s96, 98304
    v_exp_f32 v16, v16
    v_mfma_f32_16x16x32_bf16 v[32:35], a[180:183], a[52:55], v[32:35]
    s_add_u32 m0, s25, 50688
    v_fma_f32 v17, v37, s26, v14
    v_cvt_pk_bf16_f32 v29, v18, v19
    v_mfma_f32_16x16x32_bf16 v[32:35], a[176:179], a[48:51], v[32:35]
    ds_read_b128 a[208:211], v24 offset:34560
    buffer_load_dwordx4 v4, s[12:15], s28 offen offset:0 nt lds
    v_accvgpr_write_b32 a171, v29
    v_exp_f32 v17, v17
    v_mfma_f32_16x16x32_bf16 v[32:35], a[172:175], a[44:47], v[32:35]
    v_fma_f32 v18, v38, s26, v14
    v_mfma_f32_16x16x32_bf16 v[32:35], a[232:235], a[40:43], v[32:35]
    v_exp_f32 v18, v18
    v_mfma_f32_16x16x32_bf16 v[32:35], a[228:231], a[36:39], v[32:35]
    ds_read_b128 a[212:215], v24 offset:34624
    v_fma_f32 v19, v39, s26, v14
    v_mfma_f32_16x16x32_bf16 v[32:35], a[224:227], a[32:35], v[32:35]
    v_cvt_pk_bf16_f32 v44, v16, v17
    v_exp_f32 v19, v19
    v_fma_f32 v16, v40, s26, v12
    v_mfma_f32_16x16x32_bf16 v[36:39], a[224:227], a[64:67], 0
    v_exp_f32 v16, v16
    v_mfma_f32_16x16x32_bf16 v[36:39], a[228:231], a[68:71], v[36:39]
    ds_read_b128 a[216:219], v24 offset:34688
    v_fma_f32 v17, v41, s26, v12
    v_mfma_f32_16x16x32_bf16 v[36:39], a[232:235], a[72:75], v[36:39]
    v_cvt_pk_bf16_f32 v45, v18, v19
    v_mfma_f32_16x16x32_bf16 v[36:39], a[172:175], a[76:79], v[36:39]
    v_exp_f32 v17, v17
    v_mfma_f32_16x16x32_bf16 v[36:39], a[176:179], a[80:83], v[36:39]
    ds_read_b128 a[220:223], v24 offset:34752
    v_fma_f32 v18, v42, s26, v12
    v_mfma_f32_16x16x32_bf16 v[36:39], a[180:183], a[84:87], v[36:39]
    v_exp_f32 v18, v18
    v_mfma_f32_16x16x32_bf16 v[36:39], a[184:187], a[88:91], v[36:39]
    s_add_u32 m0, s25, 50720
    v_fma_f32 v19, v43, s26, v12
    v_cvt_pk_bf16_f32 v48, v16, v17
    v_mfma_f32_16x16x32_bf16 v[36:39], a[188:191], a[92:95], v[36:39]
    buffer_load_dwordx4 v4, s[12:15], s28 offen offset:1024 nt lds
    v_mfma_f32_16x16x32_bf16 a[244:247], a[252:255], a[168:171], a[244:247]
    s_waitcnt lgkmcnt(2)
    v_exp_f32 v19, v19
    v_mfma_f32_16x16x32_bf16 v[40:43], a[192:195], a[0:3], 0
    s_add_u32 m0, s25, 50752
    v_fma_f32 v16, v32, s26, v13
    v_mfma_f32_16x16x32_bf16 v[40:43], a[196:199], a[4:7], v[40:43]
    buffer_load_dwordx4 v4, s[12:15], s28 offen offset:2048 nt lds
    v_mfma_f32_16x16x32_bf16 v[40:43], a[200:203], a[8:11], v[40:43]
    v_exp_f32 v16, v16
    v_mfma_f32_16x16x32_bf16 v[40:43], a[204:207], a[12:15], v[40:43]
    v_fma_f32 v17, v33, s26, v13
    v_cvt_pk_bf16_f32 v49, v18, v19
    v_mfma_f32_16x16x32_bf16 v[40:43], a[208:211], a[16:19], v[40:43]
    v_exp_f32 v17, v17
    v_mfma_f32_16x16x32_bf16 v[40:43], a[212:215], a[20:23], v[40:43]
    s_waitcnt lgkmcnt(0)
    ds_read_b128 a[224:227], v24 offset:16896
    v_fma_f32 v18, v34, s26, v13
    v_mfma_f32_16x16x32_bf16 v[40:43], a[216:219], a[24:27], v[40:43]
    v_exp_f32 v18, v18
    v_mfma_f32_16x16x32_bf16 v[40:43], a[220:223], a[28:31], v[40:43]
    v_fma_f32 v19, v35, s26, v13
    v_cvt_pk_bf16_f32 v52, v16, v17
    v_mfma_f32_16x16x32_bf16 v[32:35], a[220:223], a[60:63], 0
    v_exp_f32 v19, v19
    v_mfma_f32_16x16x32_bf16 v[32:35], a[216:219], a[56:59], v[32:35]
    s_add_u32 m0, s25, 50784
    v_fma_f32 v16, v36, s26, v14
    v_exp_f32 v16, v16
    v_fma_f32 v17, v37, s26, v14
    v_cvt_pk_bf16_f32 v53, v18, v19
    v_exp_f32 v17, v17
    v_fma_f32 v18, v38, s26, v14
    v_exp_f32 v18, v18
    v_fma_f32 v19, v39, s26, v14
    v_cvt_pk_bf16_f32 v56, v16, v17
    v_exp_f32 v19, v19
    v_mfma_f32_16x16x32_bf16 v[32:35], a[212:215], a[52:55], v[32:35]
    s_waitcnt vmcnt(7)
    buffer_load_dwordx4 v4, s[12:15], s28 offen offset:3072 nt lds
    v_mfma_f32_16x16x32_bf16 v[32:35], a[208:211], a[48:51], v[32:35]
    ds_read_b128 a[96:99], v7 offset:33792
    v_fma_f32 v16, v40, s26, v12
    v_mfma_f32_16x16x32_bf16 v[32:35], a[204:207], a[44:47], v[32:35]
    ds_read_b128 a[100:103], v7 offset:33856
    v_exp_f32 v16, v16
    v_fma_f32 v17, v41, s26, v12
    v_cvt_pk_bf16_f32 v57, v18, v19
    v_exp_f32 v17, v17
    v_mfma_f32_16x16x32_bf16 v[32:35], a[200:203], a[40:43], v[32:35]
    s_xor_b32 s28, s96, 114688
    ds_read_b128 a[104:107], v7 offset:33920
    v_fma_f32 v18, v42, s26, v12
    v_mfma_f32_16x16x32_bf16 v[32:35], a[196:199], a[36:39], v[32:35]
    s_add_u32 m0, s25, 84480
    ds_read_b128 a[228:231], v24 offset:16960
    ds_read_b128 a[108:111], v7 offset:33984
    v_mfma_f32_16x16x32_bf16 v[32:35], a[192:195], a[32:35], v[32:35]
    ds_read_b128 a[112:115], v7 offset:34048
    buffer_load_dwordx4 v4, s[12:15], s28 offen offset:0 nt lds
    v_exp_f32 v18, v18
    v_mfma_f32_16x16x32_bf16 v[36:39], a[192:195], a[64:67], 0
    ds_read_b128 a[116:119], v7 offset:34112
    v_fma_f32 v19, v43, s26, v12
    v_mfma_f32_16x16x32_bf16 v[36:39], a[196:199], a[68:71], v[36:39]
    s_add_u32 m0, s25, 84512
    ds_read_b128 a[120:123], v7 offset:34176
    v_cvt_pk_bf16_f32 v50, v16, v17
    v_mfma_f32_16x16x32_bf16 v[36:39], a[200:203], a[72:75], v[36:39]
    ds_read_b128 a[124:127], v7 offset:34240
    buffer_load_dwordx4 v4, s[12:15], s28 offen offset:1024 nt lds
    v_exp_f32 v19, v19
    v_mfma_f32_16x16x32_bf16 v[36:39], a[204:207], a[76:79], v[36:39]
    v_fma_f32 v16, v32, s26, v13
    v_mfma_f32_16x16x32_bf16 v[36:39], a[208:211], a[80:83], v[36:39]
    v_exp_f32 v16, v16
    v_mfma_f32_16x16x32_bf16 v[36:39], a[212:215], a[84:87], v[36:39]
    v_fma_f32 v17, v33, s26, v13
    v_cvt_pk_bf16_f32 v51, v18, v19
    v_mfma_f32_16x16x32_bf16 v[36:39], a[216:219], a[88:91], v[36:39]
    s_add_u32 m0, s25, 84544
    v_exp_f32 v17, v17
    v_mfma_f32_16x16x32_bf16 v[36:39], a[220:223], a[92:95], v[36:39]
    s_waitcnt lgkmcnt(3)
    ds_read_b128 a[232:235], v24 offset:17024
    buffer_load_dwordx4 v4, s[12:15], s28 offen offset:2048 nt lds
    v_fma_f32 v18, v34, s26, v13
    v_mfma_f32_16x16x32_bf16 v[40:43], v[64:67], a[96:99], 0
    v_exp_f32 v18, v18
    v_mfma_f32_16x16x32_bf16 v[40:43], v[68:71], a[100:103], v[40:43]
    s_add_u32 m0, s25, 84576
    v_fma_f32 v19, v35, s26, v13
    v_cvt_pk_bf16_f32 v54, v16, v17
    v_mfma_f32_16x16x32_bf16 v[40:43], v[72:75], a[104:107], v[40:43]
    buffer_load_dwordx4 v4, s[12:15], s28 offen offset:3072 nt lds
    v_mfma_f32_16x16x32_bf16 v[40:43], v[76:79], a[108:111], v[40:43]
    v_exp_f32 v19, v19
    v_mfma_f32_16x16x32_bf16 v[40:43], v[80:83], a[112:115], v[40:43]
    s_waitcnt lgkmcnt(1)
    v_fma_f32 v16, v36, s26, v14
    v_mfma_f32_16x16x32_bf16 v[40:43], v[84:87], a[116:119], v[40:43]
    v_exp_f32 v16, v16
    v_mfma_f32_16x16x32_bf16 v[40:43], v[88:91], a[120:123], v[40:43]
    s_xor_b32 s28, s96, 131072
    v_fma_f32 v17, v37, s26, v14
    v_cvt_pk_bf16_f32 v55, v18, v19
    v_mfma_f32_16x16x32_bf16 v[40:43], v[92:95], a[124:127], v[40:43]
    s_add_u32 m0, s25, 101376
    v_exp_f32 v17, v17
    v_fma_f32 v18, v38, s26, v14
    v_mfma_f32_16x16x32_bf16 a[236:239], a[252:255], v[48:51], a[236:239]
    buffer_load_dwordx4 v4, s[12:15], s28 offen offset:0 nt lds
    v_exp_f32 v18, v18
    v_fma_f32 v19, v39, s26, v14
    v_mfma_f32_16x16x32_bf16 v[32:35], v[96:99], a[96:99], 0
    ds_read_b128 a[172:175], v24 offset:17088
    v_cvt_pk_bf16_f32 v58, v16, v17
    v_mfma_f32_16x16x32_bf16 v[32:35], v[100:103], a[100:103], v[32:35]
    v_exp_f32 v19, v19
    v_mfma_f32_16x16x32_bf16 v[32:35], v[104:107], a[104:107], v[32:35]
    v_max3_f32 v20, v40, v41, v15
    v_max3_f32 v20, v42, v43, v20
    v_mfma_f32_16x16x32_bf16 v[32:35], v[108:111], a[108:111], v[32:35]
    v_mov_b32 v21, v20
    v_cvt_pk_bf16_f32 v59, v18, v19
    v_mfma_f32_16x16x32_bf16 v[32:35], v[112:115], a[112:115], v[32:35]
    v_permlane16_swap_b32 v20, v21
    v_mfma_f32_16x16x32_bf16 v[32:35], v[116:119], a[116:119], v[32:35]
    v_max_f32 v20, v20, v21
    v_mov_b32 v21, v20
    v_mfma_f32_16x16x32_bf16 v[32:35], v[120:123], a[120:123], v[32:35]
    s_nop 0
    v_permlane32_swap_b32 v20, v21
    v_mfma_f32_16x16x32_bf16 v[32:35], v[124:127], a[124:127], v[32:35]
    v_max_f32 v20, v20, v21
    v_mul_f32_e64 v15, v20, -s26
    v_fma_f32 v16, v40, s26, v15
    v_mfma_f32_16x16x32_bf16 v[36:39], v[128:131], a[96:99], 0
    v_exp_f32 v16, v16
    v_mfma_f32_16x16x32_bf16 v[36:39], v[132:135], a[100:103], v[36:39]
    ds_read_b128 a[176:179], v24 offset:17152
    v_fma_f32 v17, v41, s26, v15
    v_mfma_f32_16x16x32_bf16 v[36:39], v[136:139], a[104:107], v[36:39]
    v_exp_f32 v17, v17
    v_mfma_f32_16x16x32_bf16 v[36:39], v[140:143], a[108:111], v[36:39]
    v_fma_f32 v18, v42, s26, v15
    v_mfma_f32_16x16x32_bf16 v[36:39], v[144:147], a[112:115], v[36:39]
    v_exp_f32 v18, v18
    v_mfma_f32_16x16x32_bf16 v[36:39], v[148:151], a[116:119], v[36:39]
    v_fma_f32 v19, v43, s26, v15
    v_cvt_pk_bf16_f32 v60, v16, v17
    v_mfma_f32_16x16x32_bf16 v[36:39], v[152:155], a[120:123], v[36:39]
    v_exp_f32 v19, v19
    v_mfma_f32_16x16x32_bf16 v[36:39], v[156:159], a[124:127], v[36:39]
    s_add_u32 m0, s25, 101408
    v_fma_f32 v16, v32, s26, v15
    v_exp_f32 v16, v16
    v_mfma_f32_16x16x32_bf16 a[240:243], a[252:255], v[52:55], a[240:243]
    buffer_load_dwordx4 v4, s[12:15], s28 offen offset:1024 nt lds
    v_mfma_f32_16x16x32_bf16 v[40:43], v[160:163], a[96:99], 0
    v_fma_f32 v17, v33, s26, v15
    v_cvt_pk_bf16_f32 v61, v18, v19
    v_mfma_f32_16x16x32_bf16 v[40:43], v[164:167], a[100:103], v[40:43]
    v_exp_f32 v17, v17
    v_mfma_f32_16x16x32_bf16 v[40:43], v[168:171], a[104:107], v[40:43]
    ds_read_b128 a[180:183], v24 offset:17216
    v_fma_f32 v18, v34, s26, v15
    v_mfma_f32_16x16x32_bf16 v[40:43], v[172:175], a[108:111], v[40:43]
    v_exp_f32 v18, v18
    v_mfma_f32_16x16x32_bf16 v[40:43], v[176:179], a[112:115], v[40:43]
    v_fma_f32 v19, v35, s26, v15
    v_cvt_pk_bf16_f32 v62, v16, v17
    v_mfma_f32_16x16x32_bf16 v[40:43], v[180:183], a[116:119], v[40:43]
    v_exp_f32 v19, v19
    v_mfma_f32_16x16x32_bf16 v[40:43], v[184:187], a[120:123], v[40:43]
    v_fma_f32 v16, v36, s26, v15
    v_mfma_f32_16x16x32_bf16 v[40:43], v[188:191], a[124:127], v[40:43]
    v_exp_f32 v16, v16
    v_fma_f32 v17, v37, s26, v15
    v_cvt_pk_bf16_f32 v63, v18, v19
    v_exp_f32 v17, v17
    v_fma_f32 v18, v38, s26, v15
    v_mfma_f32_16x16x32_bf16 v[32:35], v[192:195], a[96:99], 0
    v_exp_f32 v18, v18
    v_mfma_f32_16x16x32_bf16 v[32:35], v[196:199], a[100:103], v[32:35]
    v_fma_f32 v19, v39, s26, v15
    v_cvt_pk_bf16_f32 v64, v16, v17
    v_mfma_f32_16x16x32_bf16 v[32:35], v[200:203], a[104:107], v[32:35]
    v_exp_f32 v19, v19
    v_mfma_f32_16x16x32_bf16 v[32:35], v[204:207], a[108:111], v[32:35]
    ds_read_b128 a[184:187], v24 offset:17280
    v_fma_f32 v16, v40, s26, v15
    v_mfma_f32_16x16x32_bf16 v[32:35], v[208:211], a[112:115], v[32:35]
    v_exp_f32 v16, v16
    v_mfma_f32_16x16x32_bf16 v[32:35], v[212:215], a[116:119], v[32:35]
    v_fma_f32 v17, v41, s26, v15
    v_cvt_pk_bf16_f32 v65, v18, v19
    v_mfma_f32_16x16x32_bf16 v[32:35], v[216:219], a[120:123], v[32:35]
    v_exp_f32 v17, v17
    v_mfma_f32_16x16x32_bf16 v[32:35], v[220:223], a[124:127], v[32:35]
    s_add_u32 m0, s25, 101440
    v_fma_f32 v18, v42, s26, v15
    v_exp_f32 v18, v18
    v_mfma_f32_16x16x32_bf16 a[244:247], a[252:255], v[56:59], a[244:247]
    buffer_load_dwordx4 v4, s[12:15], s28 offen offset:2048 nt lds
    v_mfma_f32_16x16x32_bf16 v[36:39], v[224:227], a[96:99], 0
    v_fma_f32 v19, v43, s26, v15
    v_cvt_pk_bf16_f32 v66, v16, v17
    v_mfma_f32_16x16x32_bf16 v[36:39], v[228:231], a[100:103], v[36:39]
    v_exp_f32 v19, v19
    v_mfma_f32_16x16x32_bf16 v[36:39], v[232:235], a[104:107], v[36:39]
    v_fma_f32 v16, v32, s26, v15
    v_mfma_f32_16x16x32_bf16 v[36:39], v[236:239], a[108:111], v[36:39]
    v_exp_f32 v16, v16
    v_mfma_f32_16x16x32_bf16 v[36:39], v[240:243], a[112:115], v[36:39]
    ds_read_b128 a[188:191], v24 offset:17344
    v_fma_f32 v17, v33, s26, v15
    v_mfma_f32_16x16x32_bf16 v[36:39], v[244:247], a[116:119], v[36:39]
    ds_read_b128 a[192:195], v24 offset:33792
    v_cvt_pk_bf16_f32 v67, v18, v19
    v_mfma_f32_16x16x32_bf16 v[36:39], v[248:251], a[120:123], v[36:39]
    ds_read_b128 a[196:199], v24 offset:33856
    v_mfma_f32_16x16x32_bf16 v[36:39], v[252:255], a[124:127], v[36:39]
    ds_read_b128 a[200:203], v24 offset:33920
    v_exp_f32 v17, v17
    v_fma_f32 v18, v34, s26, v15
    v_exp_f32 v18, v18
    v_mfma_f32_16x16x32_bf16 v[40:43], a[224:227], a[96:99], 0
    ds_read_b128 a[204:207], v24 offset:33984
    v_fma_f32 v19, v35, s26, v15
    v_mfma_f32_16x16x32_bf16 v[40:43], a[228:231], a[100:103], v[40:43]
    s_waitcnt lgkmcnt(5)
    ds_read_b128 a[208:211], v24 offset:34048
    v_cvt_pk_bf16_f32 v68, v16, v17
    v_mfma_f32_16x16x32_bf16 v[40:43], a[232:235], a[104:107], v[40:43]
    ds_read_b128 a[212:215], v24 offset:34112
    v_exp_f32 v19, v19
    v_mfma_f32_16x16x32_bf16 v[40:43], a[172:175], a[108:111], v[40:43]
    ds_read_b128 a[216:219], v24 offset:34176
    v_fma_f32 v16, v36, s26, v15
    v_mfma_f32_16x16x32_bf16 v[40:43], a[176:179], a[112:115], v[40:43]
    ds_read_b128 a[220:223], v24 offset:34240
    v_exp_f32 v16, v16
    v_mfma_f32_16x16x32_bf16 v[40:43], a[180:183], a[116:119], v[40:43]
    ds_read_b128 a[224:227], v24 offset:34304
    v_fma_f32 v17, v37, s26, v15
    v_mfma_f32_16x16x32_bf16 v[40:43], a[184:187], a[120:123], v[40:43]
    s_waitcnt lgkmcnt(7)
    ds_read_b128 a[228:231], v24 offset:34368
    v_cvt_pk_bf16_f32 v69, v18, v19
    v_mfma_f32_16x16x32_bf16 v[40:43], a[188:191], a[124:127], v[40:43]
    s_add_u32 m0, s25, 101472
    ds_read_b128 a[232:235], v24 offset:34432
    v_exp_f32 v17, v17
    v_fma_f32 v18, v38, s26, v15
    v_mfma_f32_16x16x32_bf16 a[248:251], a[252:255], v[60:63], 0
    buffer_load_dwordx4 v4, s[12:15], s28 offen offset:3072 nt lds
    v_exp_f32 v18, v18
    v_mfma_f32_16x16x32_bf16 v[32:35], a[192:195], a[96:99], 0
    ds_read_b128 a[172:175], v24 offset:34496
    v_fma_f32 v19, v39, s26, v15
    v_mfma_f32_16x16x32_bf16 v[32:35], a[196:199], a[100:103], v[32:35]
    s_waitcnt lgkmcnt(6)
    ds_read_b128 a[176:179], v24 offset:34560
    v_cvt_pk_bf16_f32 v70, v16, v17
    v_mfma_f32_16x16x32_bf16 v[32:35], a[200:203], a[104:107], v[32:35]
    ds_read_b128 a[180:183], v24 offset:34624
    v_exp_f32 v19, v19
    v_mfma_f32_16x16x32_bf16 v[32:35], a[204:207], a[108:111], v[32:35]
    ds_read_b128 a[184:187], v24 offset:34688
    v_fma_f32 v16, v40, s26, v15
    v_mfma_f32_16x16x32_bf16 v[32:35], a[208:211], a[112:115], v[32:35]
    ds_read_b128 a[188:191], v24 offset:34752
    v_exp_f32 v16, v16
    v_mfma_f32_16x16x32_bf16 v[32:35], a[212:215], a[116:119], v[32:35]
    s_waitcnt lgkmcnt(6)
    ds_read_b128 a[192:195], v24 offset:17408
    v_fma_f32 v17, v41, s26, v15
    v_mfma_f32_16x16x32_bf16 v[32:35], a[216:219], a[120:123], v[32:35]
    s_xor_b32 s101, s30, 0
    ds_read_b128 a[196:199], v24 offset:17472
    v_cvt_pk_bf16_f32 v71, v18, v19
    v_mfma_f32_16x16x32_bf16 v[32:35], a[220:223], a[124:127], v[32:35]
    ds_read_b128 a[200:203], v24 offset:17536
    buffer_load_dword v11, v10, s[16:19], s101 offen offset:0
    v_exp_f32 v17, v17
    v_mfma_f32_16x16x32_bf16 v[36:39], a[224:227], a[96:99], 0
    ds_read_b128 a[204:207], v24 offset:17600
    v_fma_f32 v18, v42, s26, v15
    v_mfma_f32_16x16x32_bf16 v[36:39], a[228:231], a[100:103], v[36:39]
    s_waitcnt lgkmcnt(7)
    ds_read_b128 a[208:211], v24 offset:17664
    v_exp_f32 v18, v18
    v_mfma_f32_16x16x32_bf16 v[36:39], a[232:235], a[104:107], v[36:39]
    ds_read_b128 a[212:215], v24 offset:17728
    v_fma_f32 v19, v43, s26, v15
    v_mfma_f32_16x16x32_bf16 v[36:39], a[172:175], a[108:111], v[36:39]
    s_xor_b32 s28, s96, 147456
    ds_read_b128 a[216:219], v24 offset:17792
    v_cvt_pk_bf16_f32 v72, v16, v17
    v_mfma_f32_16x16x32_bf16 v[36:39], a[176:179], a[112:115], v[36:39]
    s_waitcnt lgkmcnt(7)
    ds_read_b128 a[220:223], v24 offset:17856
    v_mfma_f32_16x16x32_bf16 v[36:39], a[180:183], a[116:119], v[36:39]
    s_waitcnt vmcnt(13) lgkmcnt(7)
    v_exp_f32 v19, v19
    v_mfma_f32_16x16x32_bf16 v[36:39], a[184:187], a[120:123], v[36:39]
    s_barrier
    ds_read_b128 a[224:227], v25 offset:0
    v_fma_f32 v16, v32, s26, v15
    v_mfma_f32_16x16x32_bf16 v[36:39], a[188:191], a[124:127], v[36:39]
    s_add_u32 m0, s25, 0
    v_exp_f32 v16, v16
    v_fma_f32 v17, v33, s26, v15
    v_mfma_f32_16x16x32_bf16 a[248:251], a[252:255], v[64:67], a[248:251]
    buffer_load_dwordx4 v4, s[12:15], s28 offen offset:0 nt lds
    v_mfma_f32_16x16x32_bf16 v[40:43], a[192:195], a[64:67], 0
    s_waitcnt lgkmcnt(4)
    ds_read_b128 a[228:231], v25 offset:64
    v_cvt_pk_bf16_f32 v73, v18, v19
    v_mfma_f32_16x16x32_bf16 v[40:43], a[196:199], a[68:71], v[40:43]
    v_exp_f32 v17, v17
    v_mfma_f32_16x16x32_bf16 v[40:43], a[200:203], a[72:75], v[40:43]
    ds_read_b128 a[232:235], v25 offset:128
    v_fma_f32 v18, v34, s26, v15
    v_mfma_f32_16x16x32_bf16 v[40:43], a[204:207], a[76:79], v[40:43]
    v_exp_f32 v18, v18
    v_fma_f32 v19, v35, s26, v15
    v_mfma_f32_16x16x32_bf16 v[40:43], a[208:211], a[80:83], v[40:43]
    s_waitcnt lgkmcnt(3)
    ds_read_b128 a[172:175], v25 offset:192
    v_cvt_pk_bf16_f32 v76, v16, v17
    v_mfma_f32_16x16x32_bf16 v[40:43], a[212:215], a[84:87], v[40:43]
    v_exp_f32 v19, v19
    v_mfma_f32_16x16x32_bf16 v[40:43], a[216:219], a[88:91], v[40:43]
    ds_read_b128 a[176:179], v25 offset:256
    v_fma_f32 v16, v36, s26, v15
    v_mfma_f32_16x16x32_bf16 v[40:43], a[220:223], a[92:95], v[40:43]
    v_exp_f32 v16, v16
    v_fma_f32 v17, v37, s26, v15
    v_mfma_f32_16x16x32_bf16 v[32:35], a[220:223], a[124:127], 0
    ds_read_b128 a[180:183], v25 offset:320
    v_cvt_pk_bf16_f32 v77, v18, v19
    v_mfma_f32_16x16x32_bf16 v[32:35], a[216:219], a[120:123], v[32:35]
    v_exp_f32 v17, v17
    v_mfma_f32_16x16x32_bf16 v[32:35], a[212:215], a[116:119], v[32:35]
    ds_read_b128 a[184:187], v25 offset:384
    v_fma_f32 v18, v38, s26, v15
    v_mfma_f32_16x16x32_bf16 v[32:35], a[208:211], a[112:115], v[32:35]
L_pad2:
    s_cbranch_vccnz L_pad6
    v_exp_f32 v18, v18
    v_mfma_f32_16x16x32_bf16 v[32:35], a[204:207], a[108:111], v[32:35]
    ds_read_b128 a[188:191], v25 offset:448
    v_fma_f32 v19, v39, s26, v15
    v_mfma_f32_16x16x32_bf16 v[32:35], a[200:203], a[104:107], v[32:35]
    v_cvt_pk_bf16_f32 v78, v16, v17
    v_mfma_f32_16x16x32_bf16 v[32:35], a[196:199], a[100:103], v[32:35]
    v_exp_f32 v19, v19
    v_mfma_f32_16x16x32_bf16 v[32:35], a[192:195], a[96:99], v[32:35]
    s_add_u32 m0, s25, 32
    v_fma_f32 v16, v40, s26, v14
    v_exp_f32 v16, v16
    v_fma_f32 v17, v41, s26, v14
    v_cvt_pk_bf16_f32 v79, v18, v19
    v_mfma_f32_16x16x32_bf16 a[248:251], a[252:255], v[68:71], a[248:251]
    s_waitcnt lgkmcnt(2)
    buffer_load_dwordx4 v4, s[12:15], s28 offen offset:1024 nt lds
    v_exp_f32 v17, v17
    v_mfma_f32_16x16x32_bf16 v[36:39], a[224:227], a[0:3], 0
    ds_read_b128 a[220:223], v25 offset:512
    v_fma_f32 v18, v42, s26, v14
    v_mfma_f32_16x16x32_bf16 v[36:39], a[228:231], a[4:7], v[36:39]
    v_exp_f32 v18, v18
    v_mfma_f32_16x16x32_bf16 v[36:39], a[232:235], a[8:11], v[36:39]
    v_fma_f32 v19, v43, s26, v14
    v_cvt_pk_bf16_f32 v46, v16, v17
    v_mfma_f32_16x16x32_bf16 v[36:39], a[172:175], a[12:15], v[36:39]
    v_exp_f32 v19, v19
    v_mfma_f32_16x16x32_bf16 v[36:39], a[176:179], a[16:19], v[36:39]
    ds_read_b128 a[216:219], v25 offset:576
    v_fma_f32 v16, v32, s26, v15
    v_mfma_f32_16x16x32_bf16 v[36:39], a[180:183], a[20:23], v[36:39]
    s_waitcnt lgkmcnt(2)
    v_exp_f32 v16, v16
    v_mfma_f32_16x16x32_bf16 v[36:39], a[184:187], a[24:27], v[36:39]
    v_fma_f32 v17, v33, s26, v15
    v_cvt_pk_bf16_f32 v47, v18, v19
    v_mfma_f32_16x16x32_bf16 v[36:39], a[188:191], a[28:31], v[36:39]
    v_exp_f32 v17, v17
    v_mfma_f32_16x16x32_bf16 v[40:43], a[188:191], a[60:63], 0
    ds_read_b128 a[212:215], v25 offset:640
    v_fma_f32 v18, v34, s26, v15
    v_mfma_f32_16x16x32_bf16 v[40:43], a[184:187], a[56:59], v[40:43]
    v_exp_f32 v18, v18
    v_mfma_f32_16x16x32_bf16 v[40:43], a[180:183], a[52:55], v[40:43]
    v_fma_f32 v19, v35, s26, v15
    v_cvt_pk_bf16_f32 v74, v16, v17
    v_mfma_f32_16x16x32_bf16 v[40:43], a[176:179], a[48:51], v[40:43]
    v_exp_f32 v19, v19
    v_mfma_f32_16x16x32_bf16 v[40:43], a[172:175], a[44:47], v[40:43]
    ds_read_b128 a[208:211], v25 offset:704
    v_fma_f32 v16, v36, s26, v12
    v_mfma_f32_16x16x32_bf16 v[40:43], a[232:235], a[40:43], v[40:43]
    v_exp_f32 v16, v16
    v_mfma_f32_16x16x32_bf16 v[40:43], a[228:231], a[36:39], v[40:43]
    v_fma_f32 v17, v37, s26, v12
    v_cvt_pk_bf16_f32 v75, v18, v19
    v_mfma_f32_16x16x32_bf16 v[40:43], a[224:227], a[32:35], v[40:43]
    s_add_u32 m0, s25, 64
    v_exp_f32 v17, v17
    v_mfma_f32_16x16x32_bf16 a[248:251], a[252:255], v[76:79], a[248:251]
    buffer_load_dwordx4 v4, s[12:15], s28 offen offset:2048 nt lds
    v_mfma_f32_16x16x32_bf16 v[32:35], a[224:227], a[64:67], 0
    ds_read_b128 a[204:207], v25 offset:768
    v_fma_f32 v18, v38, s26, v12
    v_mfma_f32_16x16x32_bf16 v[32:35], a[228:231], a[68:71], v[32:35]
    v_exp_f32 v18, v18
    v_mfma_f32_16x16x32_bf16 v[32:35], a[232:235], a[72:75], v[32:35]
    v_fma_f32 v19, v39, s26, v12
    v_cvt_pk_bf16_f32 v80, v16, v17
    v_mfma_f32_16x16x32_bf16 v[32:35], a[172:175], a[76:79], v[32:35]
    v_exp_f32 v19, v19
    v_mfma_f32_16x16x32_bf16 v[32:35], a[176:179], a[80:83], v[32:35]
    ds_read_b128 a[200:203], v25 offset:832
    v_fma_f32 v16, v40, s26, v13
    v_mfma_f32_16x16x32_bf16 v[32:35], a[180:183], a[84:87], v[32:35]
    v_exp_f32 v16, v16
    v_mfma_f32_16x16x32_bf16 v[32:35], a[184:187], a[88:91], v[32:35]
    v_fma_f32 v17, v41, s26, v13
    v_cvt_pk_bf16_f32 v81, v18, v19
    v_mfma_f32_16x16x32_bf16 v[32:35], a[188:191], a[92:95], v[32:35]
    v_exp_f32 v17, v17
    v_mfma_f32_16x16x32_bf16 v[36:39], a[188:191], a[124:127], 0
    ds_read_b128 a[196:199], v25 offset:896
    v_fma_f32 v18, v42, s26, v13
    v_mfma_f32_16x16x32_bf16 v[36:39], a[184:187], a[120:123], v[36:39]
    v_exp_f32 v18, v18
    v_mfma_f32_16x16x32_bf16 v[36:39], a[180:183], a[116:119], v[36:39]
    v_fma_f32 v19, v43, s26, v13
    v_cvt_pk_bf16_f32 v84, v16, v17
    v_mfma_f32_16x16x32_bf16 v[36:39], a[176:179], a[112:115], v[36:39]
    v_exp_f32 v19, v19
    v_mfma_f32_16x16x32_bf16 v[36:39], a[172:175], a[108:111], v[36:39]
    ds_read_b128 a[192:195], v25 offset:960
    v_fma_f32 v16, v32, s26, v14
    v_mfma_f32_16x16x32_bf16 v[36:39], a[232:235], a[104:107], v[36:39]
    v_exp_f32 v16, v16
    v_mfma_f32_16x16x32_bf16 v[36:39], a[228:231], a[100:103], v[36:39]
    v_fma_f32 v17, v33, s26, v14
    v_cvt_pk_bf16_f32 v85, v18, v19
    v_mfma_f32_16x16x32_bf16 v[36:39], a[224:227], a[96:99], v[36:39]
    s_add_u32 m0, s25, 96
    v_exp_f32 v17, v17
    v_mfma_f32_16x16x32_bf16 a[244:247], a[252:255], v[44:47], a[244:247]
    s_waitcnt vmcnt(8) lgkmcnt(1)
    buffer_load_dwordx4 v4, s[12:15], s28 offen offset:3072 nt lds
    v_mfma_f32_16x16x32_bf16 v[40:43], a[220:223], a[0:3], 0
    s_barrier
    ds_read_b128 a[188:191], v24 offset:50688
    v_fma_f32 v18, v34, s26, v14
    v_mfma_f32_16x16x32_bf16 v[40:43], a[216:219], a[4:7], v[40:43]
    v_exp_f32 v18, v18
    v_mfma_f32_16x16x32_bf16 v[40:43], a[212:215], a[8:11], v[40:43]
    v_fma_f32 v19, v35, s26, v14
    v_cvt_pk_bf16_f32 v88, v16, v17
    v_mfma_f32_16x16x32_bf16 v[40:43], a[208:211], a[12:15], v[40:43]
    v_exp_f32 v19, v19
    v_mfma_f32_16x16x32_bf16 v[40:43], a[204:207], a[16:19], v[40:43]
    ds_read_b128 a[184:187], v24 offset:50752
    v_fma_f32 v16, v36, s26, v15
    v_mfma_f32_16x16x32_bf16 v[40:43], a[200:203], a[20:23], v[40:43]
    s_xor_b32 s101, s30, 32768
    v_exp_f32 v16, v16
    v_mfma_f32_16x16x32_bf16 v[40:43], a[196:199], a[24:27], v[40:43]
    s_waitcnt lgkmcnt(2)
    v_fma_f32 v17, v37, s26, v15
    v_cvt_pk_bf16_f32 v89, v18, v19
    v_mfma_f32_16x16x32_bf16 v[40:43], a[192:195], a[28:31], v[40:43]
    buffer_load_dword v11, v10, s[16:19], s101 offen offset:0
    v_exp_f32 v17, v17
    v_mfma_f32_16x16x32_bf16 v[32:35], a[192:195], a[60:63], 0
    ds_read_b128 a[180:183], v24 offset:50816
    v_fma_f32 v18, v38, s26, v15
    v_mfma_f32_16x16x32_bf16 v[32:35], a[196:199], a[56:59], v[32:35]
    v_exp_f32 v18, v18
    v_mfma_f32_16x16x32_bf16 v[32:35], a[200:203], a[52:55], v[32:35]
    v_fma_f32 v19, v39, s26, v15
    v_cvt_pk_bf16_f32 v92, v16, v17
    v_mfma_f32_16x16x32_bf16 v[32:35], a[204:207], a[48:51], v[32:35]
    v_exp_f32 v19, v19
    v_mfma_f32_16x16x32_bf16 v[32:35], a[208:211], a[44:47], v[32:35]
    ds_read_b128 a[176:179], v24 offset:50880
    v_fma_f32 v16, v40, s26, v12
    v_mfma_f32_16x16x32_bf16 v[32:35], a[212:215], a[40:43], v[32:35]
    v_exp_f32 v16, v16
    v_mfma_f32_16x16x32_bf16 v[32:35], a[216:219], a[36:39], v[32:35]
    s_xor_b32 s28, s96, 163840
    v_fma_f32 v17, v41, s26, v12
    v_cvt_pk_bf16_f32 v93, v18, v19
    v_mfma_f32_16x16x32_bf16 v[32:35], a[220:223], a[32:35], v[32:35]
    s_add_u32 m0, s25, 118272
    v_exp_f32 v17, v17
    v_mfma_f32_16x16x32_bf16 a[248:251], a[252:255], v[72:75], a[248:251]
    buffer_load_dwordx4 v4, s[12:15], s28 offen offset:0 nt lds
    v_mfma_f32_16x16x32_bf16 v[36:39], a[220:223], a[64:67], 0
    ds_read_b128 a[172:175], v24 offset:50944
    v_fma_f32 v18, v42, s26, v12
    v_mfma_f32_16x16x32_bf16 v[36:39], a[216:219], a[68:71], v[36:39]
    v_exp_f32 v18, v18
    v_mfma_f32_16x16x32_bf16 v[36:39], a[212:215], a[72:75], v[36:39]
    v_fma_f32 v19, v43, s26, v12
    v_cvt_pk_bf16_f32 v82, v16, v17
    v_mfma_f32_16x16x32_bf16 v[36:39], a[208:211], a[76:79], v[36:39]
    v_exp_f32 v19, v19
    v_mfma_f32_16x16x32_bf16 v[36:39], a[204:207], a[80:83], v[36:39]
    ds_read_b128 a[232:235], v24 offset:51008
    v_fma_f32 v16, v32, s26, v13
    v_mfma_f32_16x16x32_bf16 v[36:39], a[200:203], a[84:87], v[36:39]
    v_exp_f32 v16, v16
    v_mfma_f32_16x16x32_bf16 v[36:39], a[196:199], a[88:91], v[36:39]
    v_fma_f32 v17, v33, s26, v13
    v_cvt_pk_bf16_f32 v83, v18, v19
    v_mfma_f32_16x16x32_bf16 v[36:39], a[192:195], a[92:95], v[36:39]
    v_exp_f32 v17, v17
    v_mfma_f32_16x16x32_bf16 v[40:43], a[192:195], a[124:127], 0
    ds_read_b128 a[228:231], v24 offset:51072
    v_fma_f32 v18, v34, s26, v13
    v_mfma_f32_16x16x32_bf16 v[40:43], a[196:199], a[120:123], v[40:43]
    v_exp_f32 v18, v18
    v_mfma_f32_16x16x32_bf16 v[40:43], a[200:203], a[116:119], v[40:43]
    v_fma_f32 v19, v35, s26, v13
    v_cvt_pk_bf16_f32 v86, v16, v17
    v_mfma_f32_16x16x32_bf16 v[40:43], a[204:207], a[112:115], v[40:43]
    v_exp_f32 v19, v19
    v_mfma_f32_16x16x32_bf16 v[40:43], a[208:211], a[108:111], v[40:43]
    ds_read_b128 a[224:227], v24 offset:51136
    v_fma_f32 v16, v36, s26, v14
    v_mfma_f32_16x16x32_bf16 v[40:43], a[212:215], a[104:107], v[40:43]
    v_exp_f32 v16, v16
    v_mfma_f32_16x16x32_bf16 v[40:43], a[216:219], a[100:103], v[40:43]
    v_fma_f32 v17, v37, s26, v14
    v_cvt_pk_bf16_f32 v87, v18, v19
    v_mfma_f32_16x16x32_bf16 v[40:43], a[220:223], a[96:99], v[40:43]
    s_add_u32 m0, s25, 118304
    v_exp_f32 v17, v17
    v_mfma_f32_16x16x32_bf16 a[236:239], a[252:255], v[80:83], a[236:239]
    s_waitcnt lgkmcnt(1)
    buffer_load_dwordx4 v4, s[12:15], s28 offen offset:1024 nt lds
    v_mfma_f32_16x16x32_bf16 v[32:35], a[188:191], a[0:3], 0
    ds_read_b128 a[192:195], v24 offset:51200
    v_fma_f32 v18, v38, s26, v14
    v_mfma_f32_16x16x32_bf16 v[32:35], a[184:187], a[4:7], v[32:35]
    v_exp_f32 v18, v18
    v_mfma_f32_16x16x32_bf16 v[32:35], a[180:183], a[8:11], v[32:35]
    v_fma_f32 v19, v39, s26, v14
    v_cvt_pk_bf16_f32 v90, v16, v17
    v_mfma_f32_16x16x32_bf16 v[32:35], a[176:179], a[12:15], v[32:35]
    v_exp_f32 v19, v19
    v_mfma_f32_16x16x32_bf16 v[32:35], a[172:175], a[16:19], v[32:35]
    ds_read_b128 a[196:199], v24 offset:51264
    v_fma_f32 v16, v40, s26, v15
    v_mfma_f32_16x16x32_bf16 v[32:35], a[232:235], a[20:23], v[32:35]
    v_exp_f32 v16, v16
    v_mfma_f32_16x16x32_bf16 v[32:35], a[228:231], a[24:27], v[32:35]
    s_waitcnt lgkmcnt(2)
    v_fma_f32 v17, v41, s26, v15
    v_cvt_pk_bf16_f32 v91, v18, v19
    v_mfma_f32_16x16x32_bf16 v[32:35], a[224:227], a[28:31], v[32:35]
    v_exp_f32 v17, v17
    v_mfma_f32_16x16x32_bf16 v[36:39], a[224:227], a[60:63], 0
    ds_read_b128 a[200:203], v24 offset:51328
    v_fma_f32 v18, v42, s26, v15
    v_mfma_f32_16x16x32_bf16 v[36:39], a[228:231], a[56:59], v[36:39]
    v_exp_f32 v18, v18
    v_mfma_f32_16x16x32_bf16 v[36:39], a[232:235], a[52:55], v[36:39]
    v_fma_f32 v19, v43, s26, v15
    v_cvt_pk_bf16_f32 v94, v16, v17
    v_mfma_f32_16x16x32_bf16 v[36:39], a[172:175], a[48:51], v[36:39]
    v_exp_f32 v19, v19
    v_mfma_f32_16x16x32_bf16 v[36:39], a[176:179], a[44:47], v[36:39]
    ds_read_b128 a[204:207], v24 offset:51392
    v_fma_f32 v16, v32, s26, v12
    v_mfma_f32_16x16x32_bf16 v[36:39], a[180:183], a[40:43], v[36:39]
    v_exp_f32 v16, v16
    v_mfma_f32_16x16x32_bf16 v[36:39], a[184:187], a[36:39], v[36:39]
    v_fma_f32 v17, v33, s26, v12
    v_cvt_pk_bf16_f32 v95, v18, v19
    v_mfma_f32_16x16x32_bf16 v[36:39], a[188:191], a[32:35], v[36:39]
    s_add_u32 m0, s25, 118336
    v_exp_f32 v17, v17
    v_mfma_f32_16x16x32_bf16 a[240:243], a[252:255], v[84:87], a[240:243]
    buffer_load_dwordx4 v4, s[12:15], s28 offen offset:2048 nt lds
    v_mfma_f32_16x16x32_bf16 v[40:43], a[188:191], a[64:67], 0
    ds_read_b128 a[208:211], v24 offset:51456
    v_fma_f32 v18, v34, s26, v12
    v_mfma_f32_16x16x32_bf16 v[40:43], a[184:187], a[68:71], v[40:43]
    v_exp_f32 v18, v18
    v_mfma_f32_16x16x32_bf16 v[40:43], a[180:183], a[72:75], v[40:43]
    v_fma_f32 v19, v35, s26, v12
    v_cvt_pk_bf16_f32 v96, v16, v17
    v_mfma_f32_16x16x32_bf16 v[40:43], a[176:179], a[76:79], v[40:43]
    v_exp_f32 v19, v19
    v_mfma_f32_16x16x32_bf16 v[40:43], a[172:175], a[80:83], v[40:43]
    ds_read_b128 a[212:215], v24 offset:51520
    v_fma_f32 v16, v36, s26, v13
    v_mfma_f32_16x16x32_bf16 v[40:43], a[232:235], a[84:87], v[40:43]
    v_exp_f32 v16, v16
    v_mfma_f32_16x16x32_bf16 v[40:43], a[228:231], a[88:91], v[40:43]
    v_fma_f32 v17, v37, s26, v13
    v_cvt_pk_bf16_f32 v97, v18, v19
    v_mfma_f32_16x16x32_bf16 v[40:43], a[224:227], a[92:95], v[40:43]
    v_exp_f32 v17, v17
    v_mfma_f32_16x16x32_bf16 v[32:35], a[224:227], a[124:127], 0
    ds_read_b128 a[216:219], v24 offset:51584
    v_fma_f32 v18, v38, s26, v13
    v_mfma_f32_16x16x32_bf16 v[32:35], a[228:231], a[120:123], v[32:35]
    v_exp_f32 v18, v18
    v_mfma_f32_16x16x32_bf16 v[32:35], a[232:235], a[116:119], v[32:35]
    v_fma_f32 v19, v39, s26, v13
    v_cvt_pk_bf16_f32 v100, v16, v17
    v_mfma_f32_16x16x32_bf16 v[32:35], a[172:175], a[112:115], v[32:35]
    v_exp_f32 v19, v19
    v_mfma_f32_16x16x32_bf16 v[32:35], a[176:179], a[108:111], v[32:35]
    ds_read_b128 a[220:223], v24 offset:51648
    v_fma_f32 v16, v40, s26, v14
    v_mfma_f32_16x16x32_bf16 v[32:35], a[180:183], a[104:107], v[32:35]
    v_exp_f32 v16, v16
    v_mfma_f32_16x16x32_bf16 v[32:35], a[184:187], a[100:103], v[32:35]
    v_fma_f32 v17, v41, s26, v14
    v_cvt_pk_bf16_f32 v101, v18, v19
    v_mfma_f32_16x16x32_bf16 v[32:35], a[188:191], a[96:99], v[32:35]
    s_add_u32 m0, s25, 118368
    v_exp_f32 v17, v17
    v_mfma_f32_16x16x32_bf16 a[244:247], a[252:255], v[88:91], a[244:247]
    s_waitcnt lgkmcnt(1)
    buffer_load_dwordx4 v4, s[12:15], s28 offen offset:3072 nt lds
    v_mfma_f32_16x16x32_bf16 v[36:39], a[192:195], a[0:3], 0
    ds_read_b128 a[224:227], v25 offset:16896
    v_fma_f32 v18, v42, s26, v14
    v_mfma_f32_16x16x32_bf16 v[36:39], a[196:199], a[4:7], v[36:39]
    v_exp_f32 v18, v18
    v_mfma_f32_16x16x32_bf16 v[36:39], a[200:203], a[8:11], v[36:39]
    v_fma_f32 v19, v43, s26, v14
    v_cvt_pk_bf16_f32 v104, v16, v17
    v_mfma_f32_16x16x32_bf16 v[36:39], a[204:207], a[12:15], v[36:39]
    v_exp_f32 v19, v19
    v_mfma_f32_16x16x32_bf16 v[36:39], a[208:211], a[16:19], v[36:39]
    ds_read_b128 a[228:231], v25 offset:16960
    v_fma_f32 v16, v32, s26, v15
    v_mfma_f32_16x16x32_bf16 v[36:39], a[212:215], a[20:23], v[36:39]
    v_exp_f32 v16, v16
    v_mfma_f32_16x16x32_bf16 v[36:39], a[216:219], a[24:27], v[36:39]
    s_waitcnt lgkmcnt(2)
    v_fma_f32 v17, v33, s26, v15
    v_cvt_pk_bf16_f32 v105, v18, v19
    v_mfma_f32_16x16x32_bf16 v[36:39], a[220:223], a[28:31], v[36:39]
    v_exp_f32 v17, v17
    v_mfma_f32_16x16x32_bf16 v[40:43], a[220:223], a[60:63], 0
    ds_read_b128 a[232:235], v25 offset:17024
    v_fma_f32 v18, v34, s26, v15
    v_mfma_f32_16x16x32_bf16 v[40:43], a[216:219], a[56:59], v[40:43]
    v_exp_f32 v18, v18
    v_mfma_f32_16x16x32_bf16 v[40:43], a[212:215], a[52:55], v[40:43]
    v_fma_f32 v19, v35, s26, v15
    v_cvt_pk_bf16_f32 v108, v16, v17
    v_mfma_f32_16x16x32_bf16 v[40:43], a[208:211], a[48:51], v[40:43]
    v_exp_f32 v19, v19
    v_mfma_f32_16x16x32_bf16 v[40:43], a[204:207], a[44:47], v[40:43]
    ds_read_b128 a[172:175], v25 offset:17088
    v_fma_f32 v16, v36, s26, v12
    v_mfma_f32_16x16x32_bf16 v[40:43], a[200:203], a[40:43], v[40:43]
    v_exp_f32 v16, v16
    v_mfma_f32_16x16x32_bf16 v[40:43], a[196:199], a[36:39], v[40:43]
    s_xor_b32 s28, s96, 180224
    v_fma_f32 v17, v37, s26, v12
    v_cvt_pk_bf16_f32 v109, v18, v19
    v_mfma_f32_16x16x32_bf16 v[40:43], a[192:195], a[32:35], v[40:43]
    s_add_u32 m0, s25, 135168
    v_exp_f32 v17, v17
    v_mfma_f32_16x16x32_bf16 a[248:251], a[252:255], v[92:95], a[248:251]
    buffer_load_dwordx4 v4, s[12:15], s28 offen offset:0 nt lds
    v_mfma_f32_16x16x32_bf16 v[32:35], a[192:195], a[64:67], 0
    ds_read_b128 a[176:179], v25 offset:17152
    v_fma_f32 v18, v38, s26, v12
    v_mfma_f32_16x16x32_bf16 v[32:35], a[196:199], a[68:71], v[32:35]
    v_exp_f32 v18, v18
    v_mfma_f32_16x16x32_bf16 v[32:35], a[200:203], a[72:75], v[32:35]
    v_fma_f32 v19, v39, s26, v12
    v_cvt_pk_bf16_f32 v98, v16, v17
    v_mfma_f32_16x16x32_bf16 v[32:35], a[204:207], a[76:79], v[32:35]
    v_exp_f32 v19, v19
    v_mfma_f32_16x16x32_bf16 v[32:35], a[208:211], a[80:83], v[32:35]
    ds_read_b128 a[180:183], v25 offset:17216
    v_fma_f32 v16, v40, s26, v13
    v_mfma_f32_16x16x32_bf16 v[32:35], a[212:215], a[84:87], v[32:35]
    v_exp_f32 v16, v16
    v_mfma_f32_16x16x32_bf16 v[32:35], a[216:219], a[88:91], v[32:35]
    s_xor_b32 s101, s30, 65536
    v_fma_f32 v17, v41, s26, v13
    v_cvt_pk_bf16_f32 v99, v18, v19
    v_mfma_f32_16x16x32_bf16 v[32:35], a[220:223], a[92:95], v[32:35]
    buffer_load_dword v11, v10, s[16:19], s101 offen offset:0
    v_exp_f32 v17, v17
    v_mfma_f32_16x16x32_bf16 v[36:39], a[220:223], a[124:127], 0
    ds_read_b128 a[184:187], v25 offset:17280
    v_fma_f32 v18, v42, s26, v13
    v_mfma_f32_16x16x32_bf16 v[36:39], a[216:219], a[120:123], v[36:39]
    v_exp_f32 v18, v18
    v_mfma_f32_16x16x32_bf16 v[36:39], a[212:215], a[116:119], v[36:39]
    v_fma_f32 v19, v43, s26, v13
    v_cvt_pk_bf16_f32 v102, v16, v17
    v_mfma_f32_16x16x32_bf16 v[36:39], a[208:211], a[112:115], v[36:39]
    v_exp_f32 v19, v19
    v_mfma_f32_16x16x32_bf16 v[36:39], a[204:207], a[108:111], v[36:39]
    ds_read_b128 a[188:191], v25 offset:17344
    v_fma_f32 v16, v32, s26, v14
    v_mfma_f32_16x16x32_bf16 v[36:39], a[200:203], a[104:107], v[36:39]
    v_exp_f32 v16, v16
    v_mfma_f32_16x16x32_bf16 v[36:39], a[196:199], a[100:103], v[36:39]
    v_fma_f32 v17, v33, s26, v14
    v_cvt_pk_bf16_f32 v103, v18, v19
    v_mfma_f32_16x16x32_bf16 v[36:39], a[192:195], a[96:99], v[36:39]
    s_add_u32 m0, s25, 135200
    v_exp_f32 v17, v17
    v_mfma_f32_16x16x32_bf16 a[236:239], a[252:255], v[96:99], a[236:239]
    s_waitcnt lgkmcnt(1)
    buffer_load_dwordx4 v4, s[12:15], s28 offen offset:1024 nt lds
    v_mfma_f32_16x16x32_bf16 v[40:43], a[224:227], a[0:3], 0
    ds_read_b128 a[220:223], v25 offset:17408
    v_fma_f32 v18, v34, s26, v14
    v_mfma_f32_16x16x32_bf16 v[40:43], a[228:231], a[4:7], v[40:43]
    v_exp_f32 v18, v18
    v_mfma_f32_16x16x32_bf16 v[40:43], a[232:235], a[8:11], v[40:43]
    v_fma_f32 v19, v35, s26, v14
    v_cvt_pk_bf16_f32 v106, v16, v17
    v_mfma_f32_16x16x32_bf16 v[40:43], a[172:175], a[12:15], v[40:43]
    v_exp_f32 v19, v19
    v_mfma_f32_16x16x32_bf16 v[40:43], a[176:179], a[16:19], v[40:43]
    ds_read_b128 a[216:219], v25 offset:17472
    v_fma_f32 v16, v36, s26, v15
    v_mfma_f32_16x16x32_bf16 v[40:43], a[180:183], a[20:23], v[40:43]
    v_exp_f32 v16, v16
    v_mfma_f32_16x16x32_bf16 v[40:43], a[184:187], a[24:27], v[40:43]
    s_waitcnt lgkmcnt(2)
    v_fma_f32 v17, v37, s26, v15
    v_cvt_pk_bf16_f32 v107, v18, v19
    v_mfma_f32_16x16x32_bf16 v[40:43], a[188:191], a[28:31], v[40:43]
    v_exp_f32 v17, v17
    v_mfma_f32_16x16x32_bf16 v[32:35], a[188:191], a[60:63], 0
    ds_read_b128 a[212:215], v25 offset:17536
    v_fma_f32 v18, v38, s26, v15
    v_mfma_f32_16x16x32_bf16 v[32:35], a[184:187], a[56:59], v[32:35]
    v_exp_f32 v18, v18
    v_mfma_f32_16x16x32_bf16 v[32:35], a[180:183], a[52:55], v[32:35]
    v_fma_f32 v19, v39, s26, v15
    v_cvt_pk_bf16_f32 v110, v16, v17
    v_mfma_f32_16x16x32_bf16 v[32:35], a[176:179], a[48:51], v[32:35]
    v_exp_f32 v19, v19
    v_mfma_f32_16x16x32_bf16 v[32:35], a[172:175], a[44:47], v[32:35]
    ds_read_b128 a[208:211], v25 offset:17600
    v_fma_f32 v16, v40, s26, v12
    v_mfma_f32_16x16x32_bf16 v[32:35], a[232:235], a[40:43], v[32:35]
    v_exp_f32 v16, v16
    v_mfma_f32_16x16x32_bf16 v[32:35], a[228:231], a[36:39], v[32:35]
    v_fma_f32 v17, v41, s26, v12
    v_cvt_pk_bf16_f32 v111, v18, v19
    v_mfma_f32_16x16x32_bf16 v[32:35], a[224:227], a[32:35], v[32:35]
    s_add_u32 m0, s25, 135232
    v_exp_f32 v17, v17
    v_mfma_f32_16x16x32_bf16 a[240:243], a[252:255], v[100:103], a[240:243]
    buffer_load_dwordx4 v4, s[12:15], s28 offen offset:2048 nt lds
    v_mfma_f32_16x16x32_bf16 v[36:39], a[224:227], a[64:67], 0
    ds_read_b128 a[204:207], v25 offset:17664
    v_fma_f32 v18, v42, s26, v12
    v_mfma_f32_16x16x32_bf16 v[36:39], a[228:231], a[68:71], v[36:39]
    v_exp_f32 v18, v18
    v_mfma_f32_16x16x32_bf16 v[36:39], a[232:235], a[72:75], v[36:39]
    v_fma_f32 v19, v43, s26, v12
    v_cvt_pk_bf16_f32 v112, v16, v17
    v_mfma_f32_16x16x32_bf16 v[36:39], a[172:175], a[76:79], v[36:39]
    v_exp_f32 v19, v19
    v_mfma_f32_16x16x32_bf16 v[36:39], a[176:179], a[80:83], v[36:39]
    ds_read_b128 a[200:203], v25 offset:17728
    v_fma_f32 v16, v32, s26, v13
    v_mfma_f32_16x16x32_bf16 v[36:39], a[180:183], a[84:87], v[36:39]
    v_exp_f32 v16, v16
    v_mfma_f32_16x16x32_bf16 v[36:39], a[184:187], a[88:91], v[36:39]
    v_fma_f32 v17, v33, s26, v13
    v_cvt_pk_bf16_f32 v113, v18, v19
    v_mfma_f32_16x16x32_bf16 v[36:39], a[188:191], a[92:95], v[36:39]
    v_exp_f32 v17, v17
    v_mfma_f32_16x16x32_bf16 v[40:43], a[188:191], a[124:127], 0
    ds_read_b128 a[196:199], v25 offset:17792
    v_fma_f32 v18, v34, s26, v13
    v_mfma_f32_16x16x32_bf16 v[40:43], a[184:187], a[120:123], v[40:43]
    v_exp_f32 v18, v18
    v_mfma_f32_16x16x32_bf16 v[40:43], a[180:183], a[116:119], v[40:43]
    v_fma_f32 v19, v35, s26, v13
    v_cvt_pk_bf16_f32 v116, v16, v17
    v_mfma_f32_16x16x32_bf16 v[40:43], a[176:179], a[112:115], v[40:43]
    v_exp_f32 v19, v19
    v_mfma_f32_16x16x32_bf16 v[40:43], a[172:175], a[108:111], v[40:43]
    ds_read_b128 a[192:195], v25 offset:17856
    v_fma_f32 v16, v36, s26, v14
    v_mfma_f32_16x16x32_bf16 v[40:43], a[232:235], a[104:107], v[40:43]
    v_exp_f32 v16, v16
    v_mfma_f32_16x16x32_bf16 v[40:43], a[228:231], a[100:103], v[40:43]
    v_fma_f32 v17, v37, s26, v14
    v_cvt_pk_bf16_f32 v117, v18, v19
    v_mfma_f32_16x16x32_bf16 v[40:43], a[224:227], a[96:99], v[40:43]
    s_add_u32 m0, s25, 135264
    v_exp_f32 v17, v17
    v_mfma_f32_16x16x32_bf16 a[244:247], a[252:255], v[104:107], a[244:247]
    s_waitcnt vmcnt(9) lgkmcnt(1)
    buffer_load_dwordx4 v4, s[12:15], s28 offen offset:3072 nt lds
    v_mfma_f32_16x16x32_bf16 v[32:35], a[220:223], a[0:3], 0
    s_barrier
    ds_read_b128 a[188:191], v25 offset:33792
    v_fma_f32 v18, v38, s26, v14
    v_mfma_f32_16x16x32_bf16 v[32:35], a[216:219], a[4:7], v[32:35]
    v_exp_f32 v18, v18
    v_mfma_f32_16x16x32_bf16 v[32:35], a[212:215], a[8:11], v[32:35]
    v_fma_f32 v19, v39, s26, v14
    v_cvt_pk_bf16_f32 v120, v16, v17
    v_mfma_f32_16x16x32_bf16 v[32:35], a[208:211], a[12:15], v[32:35]
    v_exp_f32 v19, v19
    v_mfma_f32_16x16x32_bf16 v[32:35], a[204:207], a[16:19], v[32:35]
    ds_read_b128 a[184:187], v25 offset:33856
    v_fma_f32 v16, v40, s26, v15
    v_mfma_f32_16x16x32_bf16 v[32:35], a[200:203], a[20:23], v[32:35]
    v_exp_f32 v16, v16
    v_mfma_f32_16x16x32_bf16 v[32:35], a[196:199], a[24:27], v[32:35]
    s_waitcnt lgkmcnt(2)
    v_fma_f32 v17, v41, s26, v15
    v_cvt_pk_bf16_f32 v121, v18, v19
    v_mfma_f32_16x16x32_bf16 v[32:35], a[192:195], a[28:31], v[32:35]
    v_exp_f32 v17, v17
    v_mfma_f32_16x16x32_bf16 v[36:39], a[192:195], a[60:63], 0
    ds_read_b128 a[180:183], v25 offset:33920
    v_fma_f32 v18, v42, s26, v15
    v_mfma_f32_16x16x32_bf16 v[36:39], a[196:199], a[56:59], v[36:39]
    v_exp_f32 v18, v18
    v_mfma_f32_16x16x32_bf16 v[36:39], a[200:203], a[52:55], v[36:39]
    v_fma_f32 v19, v43, s26, v15
    v_cvt_pk_bf16_f32 v124, v16, v17
    v_mfma_f32_16x16x32_bf16 v[36:39], a[204:207], a[48:51], v[36:39]
    v_exp_f32 v19, v19
    v_mfma_f32_16x16x32_bf16 v[36:39], a[208:211], a[44:47], v[36:39]
    ds_read_b128 a[176:179], v25 offset:33984
    v_fma_f32 v16, v32, s26, v12
    v_mfma_f32_16x16x32_bf16 v[36:39], a[212:215], a[40:43], v[36:39]
    v_exp_f32 v16, v16
    v_mfma_f32_16x16x32_bf16 v[36:39], a[216:219], a[36:39], v[36:39]
    s_xor_b32 s28, s96, 196608
    v_fma_f32 v17, v33, s26, v12
    v_cvt_pk_bf16_f32 v125, v18, v19
    v_mfma_f32_16x16x32_bf16 v[36:39], a[220:223], a[32:35], v[36:39]
    s_add_u32 m0, s25, 33792
    v_exp_f32 v17, v17
    v_mfma_f32_16x16x32_bf16 a[248:251], a[252:255], v[108:111], a[248:251]
    buffer_load_dwordx4 v4, s[12:15], s28 offen offset:0 nt lds
    v_mfma_f32_16x16x32_bf16 v[40:43], a[220:223], a[64:67], 0
    ds_read_b128 a[172:175], v25 offset:34048
    v_fma_f32 v18, v34, s26, v12
    v_mfma_f32_16x16x32_bf16 v[40:43], a[216:219], a[68:71], v[40:43]
    v_exp_f32 v18, v18
    v_mfma_f32_16x16x32_bf16 v[40:43], a[212:215], a[72:75], v[40:43]
    v_fma_f32 v19, v35, s26, v12
    v_cvt_pk_bf16_f32 v114, v16, v17
    v_mfma_f32_16x16x32_bf16 v[40:43], a[208:211], a[76:79], v[40:43]
    v_exp_f32 v19, v19
    v_mfma_f32_16x16x32_bf16 v[40:43], a[204:207], a[80:83], v[40:43]
    ds_read_b128 a[232:235], v25 offset:34112
    v_fma_f32 v16, v36, s26, v13
    v_mfma_f32_16x16x32_bf16 v[40:43], a[200:203], a[84:87], v[40:43]
    v_exp_f32 v16, v16
    v_mfma_f32_16x16x32_bf16 v[40:43], a[196:199], a[88:91], v[40:43]
    v_fma_f32 v17, v37, s26, v13
    v_cvt_pk_bf16_f32 v115, v18, v19
    v_mfma_f32_16x16x32_bf16 v[40:43], a[192:195], a[92:95], v[40:43]
    v_exp_f32 v17, v17
    v_mfma_f32_16x16x32_bf16 v[32:35], a[192:195], a[124:127], 0
    ds_read_b128 a[228:231], v25 offset:34176
    v_fma_f32 v18, v38, s26, v13
    v_mfma_f32_16x16x32_bf16 v[32:35], a[196:199], a[120:123], v[32:35]
    v_exp_f32 v18, v18
    v_mfma_f32_16x16x32_bf16 v[32:35], a[200:203], a[116:119], v[32:35]
    v_fma_f32 v19, v39, s26, v13
    v_cvt_pk_bf16_f32 v118, v16, v17
    v_mfma_f32_16x16x32_bf16 v[32:35], a[204:207], a[112:115], v[32:35]
    v_exp_f32 v19, v19
    v_mfma_f32_16x16x32_bf16 v[32:35], a[208:211], a[108:111], v[32:35]
    ds_read_b128 a[224:227], v25 offset:34240
    v_fma_f32 v16, v40, s26, v14
    v_mfma_f32_16x16x32_bf16 v[32:35], a[212:215], a[104:107], v[32:35]
    v_exp_f32 v16, v16
    v_mfma_f32_16x16x32_bf16 v[32:35], a[216:219], a[100:103], v[32:35]
    v_fma_f32 v17, v41, s26, v14
    v_cvt_pk_bf16_f32 v119, v18, v19
    v_mfma_f32_16x16x32_bf16 v[32:35], a[220:223], a[96:99], v[32:35]
    s_add_u32 m0, s25, 33824
    v_exp_f32 v17, v17
    v_mfma_f32_16x16x32_bf16 a[236:239], a[252:255], v[112:115], a[236:239]
    s_waitcnt lgkmcnt(1)
    buffer_load_dwordx4 v4, s[12:15], s28 offen offset:1024 nt lds
    v_mfma_f32_16x16x32_bf16 v[36:39], a[188:191], a[0:3], 0
    ds_read_b128 a[192:195], v25 offset:34304
    v_fma_f32 v18, v42, s26, v14
    v_mfma_f32_16x16x32_bf16 v[36:39], a[184:187], a[4:7], v[36:39]
    v_exp_f32 v18, v18
    v_mfma_f32_16x16x32_bf16 v[36:39], a[180:183], a[8:11], v[36:39]
    v_fma_f32 v19, v43, s26, v14
    v_cvt_pk_bf16_f32 v122, v16, v17
    v_mfma_f32_16x16x32_bf16 v[36:39], a[176:179], a[12:15], v[36:39]
    v_exp_f32 v19, v19
    v_mfma_f32_16x16x32_bf16 v[36:39], a[172:175], a[16:19], v[36:39]
    ds_read_b128 a[196:199], v25 offset:34368
    v_fma_f32 v16, v32, s26, v15
    v_mfma_f32_16x16x32_bf16 v[36:39], a[232:235], a[20:23], v[36:39]
    s_add_u32 m0, s25, 33856
    v_exp_f32 v16, v16
    v_mfma_f32_16x16x32_bf16 v[36:39], a[228:231], a[24:27], v[36:39]
    s_waitcnt lgkmcnt(2)
    v_fma_f32 v17, v33, s26, v15
    v_cvt_pk_bf16_f32 v123, v18, v19
    v_mfma_f32_16x16x32_bf16 v[36:39], a[224:227], a[28:31], v[36:39]
    buffer_load_dwordx4 v4, s[12:15], s28 offen offset:2048 nt lds
    v_exp_f32 v17, v17
    v_mfma_f32_16x16x32_bf16 v[40:43], a[224:227], a[60:63], 0
L_pad3:
    s_cbranch_vccnz L_pad7
    ds_read_b128 a[200:203], v25 offset:34432
    v_fma_f32 v18, v34, s26, v15
    v_mfma_f32_16x16x32_bf16 v[40:43], a[228:231], a[56:59], v[40:43]
    v_exp_f32 v18, v18
    v_mfma_f32_16x16x32_bf16 v[40:43], a[232:235], a[52:55], v[40:43]
    v_fma_f32 v19, v35, s26, v15
    v_cvt_pk_bf16_f32 v126, v16, v17
    v_mfma_f32_16x16x32_bf16 v[40:43], a[172:175], a[48:51], v[40:43]
    v_exp_f32 v19, v19
    v_mfma_f32_16x16x32_bf16 v[40:43], a[176:179], a[44:47], v[40:43]
    ds_read_b128 a[204:207], v25 offset:34496
    v_fma_f32 v16, v36, s26, v12
    v_mfma_f32_16x16x32_bf16 v[40:43], a[180:183], a[40:43], v[40:43]
    v_exp_f32 v16, v16
    v_mfma_f32_16x16x32_bf16 v[40:43], a[184:187], a[36:39], v[40:43]
    v_fma_f32 v17, v37, s26, v12
    v_cvt_pk_bf16_f32 v127, v18, v19
    v_mfma_f32_16x16x32_bf16 v[40:43], a[188:191], a[32:35], v[40:43]
    s_add_u32 m0, s25, 33888
    v_exp_f32 v17, v17
    v_mfma_f32_16x16x32_bf16 a[240:243], a[252:255], v[116:119], a[240:243]
    buffer_load_dwordx4 v4, s[12:15], s28 offen offset:3072 nt lds
    v_mfma_f32_16x16x32_bf16 v[32:35], a[188:191], a[64:67], 0
    ds_read_b128 a[208:211], v25 offset:34560
    v_fma_f32 v18, v38, s26, v12
    v_mfma_f32_16x16x32_bf16 v[32:35], a[184:187], a[68:71], v[32:35]
    v_exp_f32 v18, v18
    v_mfma_f32_16x16x32_bf16 v[32:35], a[180:183], a[72:75], v[32:35]
    v_fma_f32 v19, v39, s26, v12
    v_cvt_pk_bf16_f32 v128, v16, v17
    v_mfma_f32_16x16x32_bf16 v[32:35], a[176:179], a[76:79], v[32:35]
    v_exp_f32 v19, v19
    v_mfma_f32_16x16x32_bf16 v[32:35], a[172:175], a[80:83], v[32:35]
    ds_read_b128 a[212:215], v25 offset:34624
    v_fma_f32 v16, v40, s26, v13
    v_mfma_f32_16x16x32_bf16 v[32:35], a[232:235], a[84:87], v[32:35]
    v_exp_f32 v16, v16
    v_mfma_f32_16x16x32_bf16 v[32:35], a[228:231], a[88:91], v[32:35]
    s_xor_b32 s101, s30, 98304
    v_fma_f32 v17, v41, s26, v13
    v_cvt_pk_bf16_f32 v129, v18, v19
    v_mfma_f32_16x16x32_bf16 v[32:35], a[224:227], a[92:95], v[32:35]
    buffer_load_dword v11, v10, s[16:19], s101 offen offset:0
    v_exp_f32 v17, v17
    v_mfma_f32_16x16x32_bf16 v[36:39], a[224:227], a[124:127], 0
    ds_read_b128 a[216:219], v25 offset:34688
    v_fma_f32 v18, v42, s26, v13
    v_mfma_f32_16x16x32_bf16 v[36:39], a[228:231], a[120:123], v[36:39]
    v_exp_f32 v18, v18
    v_mfma_f32_16x16x32_bf16 v[36:39], a[232:235], a[116:119], v[36:39]
    v_fma_f32 v19, v43, s26, v13
    v_cvt_pk_bf16_f32 v132, v16, v17
    v_mfma_f32_16x16x32_bf16 v[36:39], a[172:175], a[112:115], v[36:39]
    v_exp_f32 v19, v19
    v_mfma_f32_16x16x32_bf16 v[36:39], a[176:179], a[108:111], v[36:39]
    ds_read_b128 a[220:223], v25 offset:34752
    v_fma_f32 v16, v32, s26, v14
    v_mfma_f32_16x16x32_bf16 v[36:39], a[180:183], a[104:107], v[36:39]
    v_exp_f32 v16, v16
    v_mfma_f32_16x16x32_bf16 v[36:39], a[184:187], a[100:103], v[36:39]
    s_xor_b32 s28, s96, 212992
    v_fma_f32 v17, v33, s26, v14
    v_cvt_pk_bf16_f32 v133, v18, v19
    v_mfma_f32_16x16x32_bf16 v[36:39], a[188:191], a[96:99], v[36:39]
    s_add_u32 m0, s25, 16896
    v_exp_f32 v17, v17
    v_mfma_f32_16x16x32_bf16 a[244:247], a[252:255], v[120:123], a[244:247]
    s_waitcnt lgkmcnt(1)
    buffer_load_dwordx4 v4, s[12:15], s28 offen offset:0 nt lds
    v_mfma_f32_16x16x32_bf16 v[40:43], a[192:195], a[0:3], 0
    ds_read_b128 a[224:227], v24 offset:0
    v_fma_f32 v18, v34, s26, v14
    v_mfma_f32_16x16x32_bf16 v[40:43], a[196:199], a[4:7], v[40:43]
    v_exp_f32 v18, v18
    v_mfma_f32_16x16x32_bf16 v[40:43], a[200:203], a[8:11], v[40:43]
    v_fma_f32 v19, v35, s26, v14
    v_cvt_pk_bf16_f32 v136, v16, v17
    v_mfma_f32_16x16x32_bf16 v[40:43], a[204:207], a[12:15], v[40:43]
    v_exp_f32 v19, v19
    v_mfma_f32_16x16x32_bf16 v[40:43], a[208:211], a[16:19], v[40:43]
    ds_read_b128 a[228:231], v24 offset:64
    v_fma_f32 v16, v36, s26, v15
    v_mfma_f32_16x16x32_bf16 v[40:43], a[212:215], a[20:23], v[40:43]
    v_exp_f32 v16, v16
    v_mfma_f32_16x16x32_bf16 v[40:43], a[216:219], a[24:27], v[40:43]
    s_waitcnt lgkmcnt(2)
    v_fma_f32 v17, v37, s26, v15
    v_cvt_pk_bf16_f32 v137, v18, v19
    v_mfma_f32_16x16x32_bf16 v[40:43], a[220:223], a[28:31], v[40:43]
    v_exp_f32 v17, v17
    v_mfma_f32_16x16x32_bf16 v[32:35], a[220:223], a[60:63], 0
    ds_read_b128 a[232:235], v24 offset:128
    v_fma_f32 v18, v38, s26, v15
    v_mfma_f32_16x16x32_bf16 v[32:35], a[216:219], a[56:59], v[32:35]
    v_exp_f32 v18, v18
    v_mfma_f32_16x16x32_bf16 v[32:35], a[212:215], a[52:55], v[32:35]
    v_fma_f32 v19, v39, s26, v15
    v_cvt_pk_bf16_f32 v140, v16, v17
    v_mfma_f32_16x16x32_bf16 v[32:35], a[208:211], a[48:51], v[32:35]
    v_exp_f32 v19, v19
    v_mfma_f32_16x16x32_bf16 v[32:35], a[204:207], a[44:47], v[32:35]
    ds_read_b128 a[172:175], v24 offset:192
    v_fma_f32 v16, v40, s26, v12
    v_mfma_f32_16x16x32_bf16 v[32:35], a[200:203], a[40:43], v[32:35]
    v_exp_f32 v16, v16
    v_mfma_f32_16x16x32_bf16 v[32:35], a[196:199], a[36:39], v[32:35]
    v_fma_f32 v17, v41, s26, v12
    v_cvt_pk_bf16_f32 v141, v18, v19
    v_mfma_f32_16x16x32_bf16 v[32:35], a[192:195], a[32:35], v[32:35]
    s_add_u32 m0, s25, 16928
    v_exp_f32 v17, v17
    v_mfma_f32_16x16x32_bf16 a[248:251], a[252:255], v[124:127], a[248:251]
    buffer_load_dwordx4 v4, s[12:15], s28 offen offset:1024 nt lds
    v_mfma_f32_16x16x32_bf16 v[36:39], a[192:195], a[64:67], 0
    ds_read_b128 a[176:179], v24 offset:256
    v_fma_f32 v18, v42, s26, v12
    v_mfma_f32_16x16x32_bf16 v[36:39], a[196:199], a[68:71], v[36:39]
    v_exp_f32 v18, v18
    v_mfma_f32_16x16x32_bf16 v[36:39], a[200:203], a[72:75], v[36:39]
    v_fma_f32 v19, v43, s26, v12
    v_cvt_pk_bf16_f32 v130, v16, v17
    v_mfma_f32_16x16x32_bf16 v[36:39], a[204:207], a[76:79], v[36:39]
    v_exp_f32 v19, v19
    v_mfma_f32_16x16x32_bf16 v[36:39], a[208:211], a[80:83], v[36:39]
    ds_read_b128 a[180:183], v24 offset:320
    v_fma_f32 v16, v32, s26, v13
    v_mfma_f32_16x16x32_bf16 v[36:39], a[212:215], a[84:87], v[36:39]
    v_exp_f32 v16, v16
    v_mfma_f32_16x16x32_bf16 v[36:39], a[216:219], a[88:91], v[36:39]
    v_fma_f32 v17, v33, s26, v13
    v_cvt_pk_bf16_f32 v131, v18, v19
    v_mfma_f32_16x16x32_bf16 v[36:39], a[220:223], a[92:95], v[36:39]
    v_exp_f32 v17, v17
    v_mfma_f32_16x16x32_bf16 v[40:43], a[220:223], a[124:127], 0
    ds_read_b128 a[184:187], v24 offset:384
    v_fma_f32 v18, v34, s26, v13
    v_mfma_f32_16x16x32_bf16 v[40:43], a[216:219], a[120:123], v[40:43]
    v_exp_f32 v18, v18
    v_mfma_f32_16x16x32_bf16 v[40:43], a[212:215], a[116:119], v[40:43]
    v_fma_f32 v19, v35, s26, v13
    v_cvt_pk_bf16_f32 v134, v16, v17
    v_mfma_f32_16x16x32_bf16 v[40:43], a[208:211], a[112:115], v[40:43]
    v_exp_f32 v19, v19
    v_mfma_f32_16x16x32_bf16 v[40:43], a[204:207], a[108:111], v[40:43]
    ds_read_b128 a[188:191], v24 offset:448
    v_fma_f32 v16, v36, s26, v14
    v_mfma_f32_16x16x32_bf16 v[40:43], a[200:203], a[104:107], v[40:43]
    v_exp_f32 v16, v16
    v_mfma_f32_16x16x32_bf16 v[40:43], a[196:199], a[100:103], v[40:43]
    v_fma_f32 v17, v37, s26, v14
    v_cvt_pk_bf16_f32 v135, v18, v19
    v_mfma_f32_16x16x32_bf16 v[40:43], a[192:195], a[96:99], v[40:43]
    s_add_u32 m0, s25, 16960
    v_exp_f32 v17, v17
    v_mfma_f32_16x16x32_bf16 a[236:239], a[252:255], v[128:131], a[236:239]
    s_waitcnt lgkmcnt(1)
    buffer_load_dwordx4 v4, s[12:15], s28 offen offset:2048 nt lds
    v_mfma_f32_16x16x32_bf16 v[32:35], a[224:227], a[0:3], 0
    ds_read_b128 a[220:223], v24 offset:512
    v_fma_f32 v18, v38, s26, v14
    v_mfma_f32_16x16x32_bf16 v[32:35], a[228:231], a[4:7], v[32:35]
    v_exp_f32 v18, v18
    v_mfma_f32_16x16x32_bf16 v[32:35], a[232:235], a[8:11], v[32:35]
    v_fma_f32 v19, v39, s26, v14
    v_cvt_pk_bf16_f32 v138, v16, v17
    v_mfma_f32_16x16x32_bf16 v[32:35], a[172:175], a[12:15], v[32:35]
    v_exp_f32 v19, v19
    v_mfma_f32_16x16x32_bf16 v[32:35], a[176:179], a[16:19], v[32:35]
    ds_read_b128 a[216:219], v24 offset:576
    v_fma_f32 v16, v40, s26, v15
    v_mfma_f32_16x16x32_bf16 v[32:35], a[180:183], a[20:23], v[32:35]
    v_exp_f32 v16, v16
    v_mfma_f32_16x16x32_bf16 v[32:35], a[184:187], a[24:27], v[32:35]
    s_waitcnt lgkmcnt(2)
    v_fma_f32 v17, v41, s26, v15
    v_cvt_pk_bf16_f32 v139, v18, v19
    v_mfma_f32_16x16x32_bf16 v[32:35], a[188:191], a[28:31], v[32:35]
    v_exp_f32 v17, v17
    v_mfma_f32_16x16x32_bf16 v[36:39], a[188:191], a[60:63], 0
    ds_read_b128 a[212:215], v24 offset:640
    v_fma_f32 v18, v42, s26, v15
    v_mfma_f32_16x16x32_bf16 v[36:39], a[184:187], a[56:59], v[36:39]
    v_exp_f32 v18, v18
    v_mfma_f32_16x16x32_bf16 v[36:39], a[180:183], a[52:55], v[36:39]
    v_fma_f32 v19, v43, s26, v15
    v_cvt_pk_bf16_f32 v142, v16, v17
    v_mfma_f32_16x16x32_bf16 v[36:39], a[176:179], a[48:51], v[36:39]
    v_exp_f32 v19, v19
    v_mfma_f32_16x16x32_bf16 v[36:39], a[172:175], a[44:47], v[36:39]
    ds_read_b128 a[208:211], v24 offset:704
    v_fma_f32 v16, v32, s26, v12
    v_mfma_f32_16x16x32_bf16 v[36:39], a[232:235], a[40:43], v[36:39]
    v_exp_f32 v16, v16
    v_mfma_f32_16x16x32_bf16 v[36:39], a[228:231], a[36:39], v[36:39]
    v_fma_f32 v17, v33, s26, v12
    v_cvt_pk_bf16_f32 v143, v18, v19
    v_mfma_f32_16x16x32_bf16 v[36:39], a[224:227], a[32:35], v[36:39]
    s_add_u32 m0, s25, 16992
    v_exp_f32 v17, v17
    v_mfma_f32_16x16x32_bf16 a[240:243], a[252:255], v[132:135], a[240:243]
    buffer_load_dwordx4 v4, s[12:15], s28 offen offset:3072 nt lds
    v_mfma_f32_16x16x32_bf16 v[40:43], a[224:227], a[64:67], 0
    ds_read_b128 a[204:207], v24 offset:768
    v_fma_f32 v18, v34, s26, v12
    v_mfma_f32_16x16x32_bf16 v[40:43], a[228:231], a[68:71], v[40:43]
    v_exp_f32 v18, v18
    v_mfma_f32_16x16x32_bf16 v[40:43], a[232:235], a[72:75], v[40:43]
    v_fma_f32 v19, v35, s26, v12
    v_cvt_pk_bf16_f32 v144, v16, v17
    v_mfma_f32_16x16x32_bf16 v[40:43], a[172:175], a[76:79], v[40:43]
    v_exp_f32 v19, v19
    v_mfma_f32_16x16x32_bf16 v[40:43], a[176:179], a[80:83], v[40:43]
    ds_read_b128 a[200:203], v24 offset:832
    v_fma_f32 v16, v36, s26, v13
    v_mfma_f32_16x16x32_bf16 v[40:43], a[180:183], a[84:87], v[40:43]
    v_exp_f32 v16, v16
    v_mfma_f32_16x16x32_bf16 v[40:43], a[184:187], a[88:91], v[40:43]
    s_xor_b32 s101, s30, 131072
    v_fma_f32 v17, v37, s26, v13
    v_cvt_pk_bf16_f32 v145, v18, v19
    v_mfma_f32_16x16x32_bf16 v[40:43], a[188:191], a[92:95], v[40:43]
    buffer_load_dword v11, v10, s[16:19], s101 offen offset:0
    v_exp_f32 v17, v17
    v_mfma_f32_16x16x32_bf16 v[32:35], a[188:191], a[124:127], 0
    ds_read_b128 a[196:199], v24 offset:896
    v_fma_f32 v18, v38, s26, v13
    v_mfma_f32_16x16x32_bf16 v[32:35], a[184:187], a[120:123], v[32:35]
    v_exp_f32 v18, v18
    v_mfma_f32_16x16x32_bf16 v[32:35], a[180:183], a[116:119], v[32:35]
    v_fma_f32 v19, v39, s26, v13
    v_cvt_pk_bf16_f32 v148, v16, v17
    v_mfma_f32_16x16x32_bf16 v[32:35], a[176:179], a[112:115], v[32:35]
    v_exp_f32 v19, v19
    v_mfma_f32_16x16x32_bf16 v[32:35], a[172:175], a[108:111], v[32:35]
    ds_read_b128 a[192:195], v24 offset:960
    v_fma_f32 v16, v40, s26, v14
    v_mfma_f32_16x16x32_bf16 v[32:35], a[232:235], a[104:107], v[32:35]
    v_exp_f32 v16, v16
    v_mfma_f32_16x16x32_bf16 v[32:35], a[228:231], a[100:103], v[32:35]
    s_xor_b32 s28, s96, 229376
    v_fma_f32 v17, v41, s26, v14
    v_cvt_pk_bf16_f32 v149, v18, v19
    v_mfma_f32_16x16x32_bf16 v[32:35], a[224:227], a[96:99], v[32:35]
    s_add_u32 m0, s25, 50688
    v_exp_f32 v17, v17
    v_mfma_f32_16x16x32_bf16 a[244:247], a[252:255], v[136:139], a[244:247]
    s_waitcnt vmcnt(10) lgkmcnt(1)
    buffer_load_dwordx4 v4, s[12:15], s28 offen offset:0 nt lds
    v_mfma_f32_16x16x32_bf16 v[36:39], a[220:223], a[0:3], 0
    s_barrier
    ds_read_b128 a[188:191], v25 offset:50688
    v_fma_f32 v18, v42, s26, v14
    v_mfma_f32_16x16x32_bf16 v[36:39], a[216:219], a[4:7], v[36:39]
    v_exp_f32 v18, v18
    v_mfma_f32_16x16x32_bf16 v[36:39], a[212:215], a[8:11], v[36:39]
    v_fma_f32 v19, v43, s26, v14
    v_cvt_pk_bf16_f32 v152, v16, v17
    v_mfma_f32_16x16x32_bf16 v[36:39], a[208:211], a[12:15], v[36:39]
    v_exp_f32 v19, v19
    v_mfma_f32_16x16x32_bf16 v[36:39], a[204:207], a[16:19], v[36:39]
    ds_read_b128 a[184:187], v25 offset:50752
    v_fma_f32 v16, v32, s26, v15
    v_mfma_f32_16x16x32_bf16 v[36:39], a[200:203], a[20:23], v[36:39]
    s_add_u32 m0, s25, 50720
    v_exp_f32 v16, v16
    v_mfma_f32_16x16x32_bf16 v[36:39], a[196:199], a[24:27], v[36:39]
    s_waitcnt lgkmcnt(2)
    v_fma_f32 v17, v33, s26, v15
    v_cvt_pk_bf16_f32 v153, v18, v19
    v_mfma_f32_16x16x32_bf16 v[36:39], a[192:195], a[28:31], v[36:39]
    buffer_load_dwordx4 v4, s[12:15], s28 offen offset:1024 nt lds
    v_exp_f32 v17, v17
    v_mfma_f32_16x16x32_bf16 v[40:43], a[192:195], a[60:63], 0
    ds_read_b128 a[180:183], v25 offset:50816
    v_fma_f32 v18, v34, s26, v15
    v_mfma_f32_16x16x32_bf16 v[40:43], a[196:199], a[56:59], v[40:43]
    v_exp_f32 v18, v18
    v_mfma_f32_16x16x32_bf16 v[40:43], a[200:203], a[52:55], v[40:43]
    v_fma_f32 v19, v35, s26, v15
    v_cvt_pk_bf16_f32 v156, v16, v17
    v_mfma_f32_16x16x32_bf16 v[40:43], a[204:207], a[48:51], v[40:43]
    v_exp_f32 v19, v19
    v_mfma_f32_16x16x32_bf16 v[40:43], a[208:211], a[44:47], v[40:43]
    ds_read_b128 a[176:179], v25 offset:50880
    v_fma_f32 v16, v36, s26, v12
    v_mfma_f32_16x16x32_bf16 v[40:43], a[212:215], a[40:43], v[40:43]
    v_exp_f32 v16, v16
    v_mfma_f32_16x16x32_bf16 v[40:43], a[216:219], a[36:39], v[40:43]
    v_fma_f32 v17, v37, s26, v12
    v_cvt_pk_bf16_f32 v157, v18, v19
    v_mfma_f32_16x16x32_bf16 v[40:43], a[220:223], a[32:35], v[40:43]
    s_add_u32 m0, s25, 50752
    v_exp_f32 v17, v17
    v_mfma_f32_16x16x32_bf16 a[248:251], a[252:255], v[140:143], a[248:251]
    buffer_load_dwordx4 v4, s[12:15], s28 offen offset:2048 nt lds
    v_mfma_f32_16x16x32_bf16 v[32:35], a[220:223], a[64:67], 0
    ds_read_b128 a[172:175], v25 offset:50944
    v_fma_f32 v18, v38, s26, v12
    v_mfma_f32_16x16x32_bf16 v[32:35], a[216:219], a[68:71], v[32:35]
    v_exp_f32 v18, v18
    v_mfma_f32_16x16x32_bf16 v[32:35], a[212:215], a[72:75], v[32:35]
    v_fma_f32 v19, v39, s26, v12
    v_cvt_pk_bf16_f32 v146, v16, v17
    v_mfma_f32_16x16x32_bf16 v[32:35], a[208:211], a[76:79], v[32:35]
    v_exp_f32 v19, v19
    v_mfma_f32_16x16x32_bf16 v[32:35], a[204:207], a[80:83], v[32:35]
    ds_read_b128 a[232:235], v25 offset:51008
    v_fma_f32 v16, v40, s26, v13
    v_mfma_f32_16x16x32_bf16 v[32:35], a[200:203], a[84:87], v[32:35]
    v_exp_f32 v16, v16
    v_mfma_f32_16x16x32_bf16 v[32:35], a[196:199], a[88:91], v[32:35]
    v_fma_f32 v17, v41, s26, v13
    v_cvt_pk_bf16_f32 v147, v18, v19
    v_mfma_f32_16x16x32_bf16 v[32:35], a[192:195], a[92:95], v[32:35]
    v_exp_f32 v17, v17
    v_mfma_f32_16x16x32_bf16 v[36:39], a[192:195], a[124:127], 0
    ds_read_b128 a[228:231], v25 offset:51072
    v_fma_f32 v18, v42, s26, v13
    v_mfma_f32_16x16x32_bf16 v[36:39], a[196:199], a[120:123], v[36:39]
    v_exp_f32 v18, v18
    v_mfma_f32_16x16x32_bf16 v[36:39], a[200:203], a[116:119], v[36:39]
    v_fma_f32 v19, v43, s26, v13
    v_cvt_pk_bf16_f32 v150, v16, v17
    v_mfma_f32_16x16x32_bf16 v[36:39], a[204:207], a[112:115], v[36:39]
    v_exp_f32 v19, v19
    v_mfma_f32_16x16x32_bf16 v[36:39], a[208:211], a[108:111], v[36:39]
    ds_read_b128 a[224:227], v25 offset:51136
    v_fma_f32 v16, v32, s26, v14
    v_mfma_f32_16x16x32_bf16 v[36:39], a[212:215], a[104:107], v[36:39]
    v_exp_f32 v16, v16
    v_mfma_f32_16x16x32_bf16 v[36:39], a[216:219], a[100:103], v[36:39]
    v_fma_f32 v17, v33, s26, v14
    v_cvt_pk_bf16_f32 v151, v18, v19
    v_mfma_f32_16x16x32_bf16 v[36:39], a[220:223], a[96:99], v[36:39]
    s_add_u32 m0, s25, 50784
    v_exp_f32 v17, v17
    v_mfma_f32_16x16x32_bf16 a[236:239], a[252:255], v[144:147], a[236:239]
    s_waitcnt lgkmcnt(1)
    buffer_load_dwordx4 v4, s[12:15], s28 offen offset:3072 nt lds
    v_mfma_f32_16x16x32_bf16 v[40:43], a[188:191], a[0:3], 0
    ds_read_b128 a[192:195], v25 offset:51200
    v_fma_f32 v18, v34, s26, v14
    v_mfma_f32_16x16x32_bf16 v[40:43], a[184:187], a[4:7], v[40:43]
    v_exp_f32 v18, v18
    v_mfma_f32_16x16x32_bf16 v[40:43], a[180:183], a[8:11], v[40:43]
    v_fma_f32 v19, v35, s26, v14
    v_cvt_pk_bf16_f32 v154, v16, v17
    v_mfma_f32_16x16x32_bf16 v[40:43], a[176:179], a[12:15], v[40:43]
    v_exp_f32 v19, v19
    v_mfma_f32_16x16x32_bf16 v[40:43], a[172:175], a[16:19], v[40:43]
    ds_read_b128 a[196:199], v25 offset:51264
    v_fma_f32 v16, v36, s26, v15
    v_mfma_f32_16x16x32_bf16 v[40:43], a[232:235], a[20:23], v[40:43]
    v_exp_f32 v16, v16
    v_mfma_f32_16x16x32_bf16 v[40:43], a[228:231], a[24:27], v[40:43]
    s_waitcnt lgkmcnt(2)
    v_fma_f32 v17, v37, s26, v15
    v_cvt_pk_bf16_f32 v155, v18, v19
    v_mfma_f32_16x16x32_bf16 v[40:43], a[224:227], a[28:31], v[40:43]
    v_exp_f32 v17, v17
    v_mfma_f32_16x16x32_bf16 v[32:35], a[224:227], a[60:63], 0
    ds_read_b128 a[200:203], v25 offset:51328
    v_fma_f32 v18, v38, s26, v15
    v_mfma_f32_16x16x32_bf16 v[32:35], a[228:231], a[56:59], v[32:35]
    v_exp_f32 v18, v18
    v_mfma_f32_16x16x32_bf16 v[32:35], a[232:235], a[52:55], v[32:35]
    v_fma_f32 v19, v39, s26, v15
    v_cvt_pk_bf16_f32 v158, v16, v17
    v_mfma_f32_16x16x32_bf16 v[32:35], a[172:175], a[48:51], v[32:35]
    v_exp_f32 v19, v19
    v_mfma_f32_16x16x32_bf16 v[32:35], a[176:179], a[44:47], v[32:35]
    ds_read_b128 a[204:207], v25 offset:51392
    v_fma_f32 v16, v40, s26, v12
    v_mfma_f32_16x16x32_bf16 v[32:35], a[180:183], a[40:43], v[32:35]
    v_exp_f32 v16, v16
    v_mfma_f32_16x16x32_bf16 v[32:35], a[184:187], a[36:39], v[32:35]
    s_xor_b32 s28, s96, 245760
    v_fma_f32 v17, v41, s26, v12
    v_cvt_pk_bf16_f32 v159, v18, v19
    v_mfma_f32_16x16x32_bf16 v[32:35], a[188:191], a[32:35], v[32:35]
    s_add_u32 m0, s25, 67584
    v_exp_f32 v17, v17
    v_mfma_f32_16x16x32_bf16 a[240:243], a[252:255], v[148:151], a[240:243]
    buffer_load_dwordx4 v4, s[12:15], s28 offen offset:0 nt lds
    v_mfma_f32_16x16x32_bf16 v[36:39], a[188:191], a[64:67], 0
    ds_read_b128 a[208:211], v25 offset:51456
    v_fma_f32 v18, v42, s26, v12
    v_mfma_f32_16x16x32_bf16 v[36:39], a[184:187], a[68:71], v[36:39]
    v_exp_f32 v18, v18
    v_mfma_f32_16x16x32_bf16 v[36:39], a[180:183], a[72:75], v[36:39]
    v_fma_f32 v19, v43, s26, v12
    v_cvt_pk_bf16_f32 v160, v16, v17
    v_mfma_f32_16x16x32_bf16 v[36:39], a[176:179], a[76:79], v[36:39]
    v_exp_f32 v19, v19
    v_mfma_f32_16x16x32_bf16 v[36:39], a[172:175], a[80:83], v[36:39]
    ds_read_b128 a[212:215], v25 offset:51520
    v_fma_f32 v16, v32, s26, v13
    v_mfma_f32_16x16x32_bf16 v[36:39], a[232:235], a[84:87], v[36:39]
    v_exp_f32 v16, v16
    v_mfma_f32_16x16x32_bf16 v[36:39], a[228:231], a[88:91], v[36:39]
    v_fma_f32 v17, v33, s26, v13
    v_cvt_pk_bf16_f32 v161, v18, v19
    v_mfma_f32_16x16x32_bf16 v[36:39], a[224:227], a[92:95], v[36:39]
    v_exp_f32 v17, v17
    v_mfma_f32_16x16x32_bf16 v[40:43], a[224:227], a[124:127], 0
    ds_read_b128 a[216:219], v25 offset:51584
    v_fma_f32 v18, v34, s26, v13
    v_mfma_f32_16x16x32_bf16 v[40:43], a[228:231], a[120:123], v[40:43]
    v_exp_f32 v18, v18
    v_mfma_f32_16x16x32_bf16 v[40:43], a[232:235], a[116:119], v[40:43]
    v_fma_f32 v19, v35, s26, v13
    v_cvt_pk_bf16_f32 v164, v16, v17
    v_mfma_f32_16x16x32_bf16 v[40:43], a[172:175], a[112:115], v[40:43]
    v_exp_f32 v19, v19
    v_mfma_f32_16x16x32_bf16 v[40:43], a[176:179], a[108:111], v[40:43]
    ds_read_b128 a[220:223], v25 offset:51648
    v_fma_f32 v16, v36, s26, v14
    v_mfma_f32_16x16x32_bf16 v[40:43], a[180:183], a[104:107], v[40:43]
    v_exp_f32 v16, v16
    v_mfma_f32_16x16x32_bf16 v[40:43], a[184:187], a[100:103], v[40:43]
    v_fma_f32 v17, v37, s26, v14
    v_cvt_pk_bf16_f32 v165, v18, v19
    v_mfma_f32_16x16x32_bf16 v[40:43], a[188:191], a[96:99], v[40:43]
    s_add_u32 m0, s25, 67616
    v_exp_f32 v17, v17
    v_mfma_f32_16x16x32_bf16 a[244:247], a[252:255], v[152:155], a[244:247]
    s_waitcnt lgkmcnt(1)
    buffer_load_dwordx4 v4, s[12:15], s28 offen offset:1024 nt lds
    v_mfma_f32_16x16x32_bf16 v[32:35], a[192:195], a[0:3], 0
    ds_read_b128 a[224:227], v26 offset:0
    v_fma_f32 v18, v38, s26, v14
    v_mfma_f32_16x16x32_bf16 v[32:35], a[196:199], a[4:7], v[32:35]
    v_exp_f32 v18, v18
    v_mfma_f32_16x16x32_bf16 v[32:35], a[200:203], a[8:11], v[32:35]
    v_fma_f32 v19, v39, s26, v14
    v_cvt_pk_bf16_f32 v168, v16, v17
    v_mfma_f32_16x16x32_bf16 v[32:35], a[204:207], a[12:15], v[32:35]
    v_exp_f32 v19, v19
    v_mfma_f32_16x16x32_bf16 v[32:35], a[208:211], a[16:19], v[32:35]
    ds_read_b128 a[228:231], v26 offset:64
    v_fma_f32 v16, v40, s26, v15
    v_mfma_f32_16x16x32_bf16 v[32:35], a[212:215], a[20:23], v[32:35]
    s_xor_b32 s101, s30, 163840
    v_exp_f32 v16, v16
    v_mfma_f32_16x16x32_bf16 v[32:35], a[216:219], a[24:27], v[32:35]
    s_waitcnt lgkmcnt(2)
    v_fma_f32 v17, v41, s26, v15
    v_cvt_pk_bf16_f32 v169, v18, v19
    v_mfma_f32_16x16x32_bf16 v[32:35], a[220:223], a[28:31], v[32:35]
    buffer_load_dword v11, v10, s[16:19], s101 offen offset:0
    v_exp_f32 v17, v17
    v_mfma_f32_16x16x32_bf16 v[36:39], a[220:223], a[60:63], 0
    ds_read_b128 a[232:235], v26 offset:128
    v_fma_f32 v18, v42, s26, v15
    v_mfma_f32_16x16x32_bf16 v[36:39], a[216:219], a[56:59], v[36:39]
    v_exp_f32 v18, v18
    v_mfma_f32_16x16x32_bf16 v[36:39], a[212:215], a[52:55], v[36:39]
    v_fma_f32 v19, v43, s26, v15
    v_cvt_pk_bf16_f32 v172, v16, v17
    v_mfma_f32_16x16x32_bf16 v[36:39], a[208:211], a[48:51], v[36:39]
    v_exp_f32 v19, v19
    v_mfma_f32_16x16x32_bf16 v[36:39], a[204:207], a[44:47], v[36:39]
    ds_read_b128 a[172:175], v26 offset:192
    v_fma_f32 v16, v32, s26, v12
    v_mfma_f32_16x16x32_bf16 v[36:39], a[200:203], a[40:43], v[36:39]
    v_exp_f32 v16, v16
    v_mfma_f32_16x16x32_bf16 v[36:39], a[196:199], a[36:39], v[36:39]
    v_fma_f32 v17, v33, s26, v12
    v_cvt_pk_bf16_f32 v173, v18, v19
    v_mfma_f32_16x16x32_bf16 v[36:39], a[192:195], a[32:35], v[36:39]
    s_add_u32 m0, s25, 67648
    v_exp_f32 v17, v17
    v_mfma_f32_16x16x32_bf16 a[248:251], a[252:255], v[156:159], a[248:251]
    buffer_load_dwordx4 v4, s[12:15], s28 offen offset:2048 nt lds
    v_mfma_f32_16x16x32_bf16 v[40:43], a[192:195], a[64:67], 0
    ds_read_b128 a[176:179], v26 offset:256
    v_fma_f32 v18, v34, s26, v12
    v_mfma_f32_16x16x32_bf16 v[40:43], a[196:199], a[68:71], v[40:43]
    v_exp_f32 v18, v18
    v_mfma_f32_16x16x32_bf16 v[40:43], a[200:203], a[72:75], v[40:43]
    v_fma_f32 v19, v35, s26, v12
    v_cvt_pk_bf16_f32 v162, v16, v17
    v_mfma_f32_16x16x32_bf16 v[40:43], a[204:207], a[76:79], v[40:43]
    v_exp_f32 v19, v19
    v_mfma_f32_16x16x32_bf16 v[40:43], a[208:211], a[80:83], v[40:43]
    ds_read_b128 a[180:183], v26 offset:320
    v_fma_f32 v16, v36, s26, v13
    v_mfma_f32_16x16x32_bf16 v[40:43], a[212:215], a[84:87], v[40:43]
    v_exp_f32 v16, v16
    v_mfma_f32_16x16x32_bf16 v[40:43], a[216:219], a[88:91], v[40:43]
    v_fma_f32 v17, v37, s26, v13
    v_cvt_pk_bf16_f32 v163, v18, v19
    v_mfma_f32_16x16x32_bf16 v[40:43], a[220:223], a[92:95], v[40:43]
    v_exp_f32 v17, v17
    v_mfma_f32_16x16x32_bf16 v[32:35], a[220:223], a[124:127], 0
    ds_read_b128 a[184:187], v26 offset:384
    v_fma_f32 v18, v38, s26, v13
    v_mfma_f32_16x16x32_bf16 v[32:35], a[216:219], a[120:123], v[32:35]
    v_exp_f32 v18, v18
    v_mfma_f32_16x16x32_bf16 v[32:35], a[212:215], a[116:119], v[32:35]
    v_fma_f32 v19, v39, s26, v13
    v_cvt_pk_bf16_f32 v166, v16, v17
    v_mfma_f32_16x16x32_bf16 v[32:35], a[208:211], a[112:115], v[32:35]
    v_exp_f32 v19, v19
    v_mfma_f32_16x16x32_bf16 v[32:35], a[204:207], a[108:111], v[32:35]
    ds_read_b128 a[188:191], v26 offset:448
    v_fma_f32 v16, v40, s26, v14
    v_mfma_f32_16x16x32_bf16 v[32:35], a[200:203], a[104:107], v[32:35]
    v_exp_f32 v16, v16
    v_mfma_f32_16x16x32_bf16 v[32:35], a[196:199], a[100:103], v[32:35]
    v_fma_f32 v17, v41, s26, v14
    v_cvt_pk_bf16_f32 v167, v18, v19
    v_mfma_f32_16x16x32_bf16 v[32:35], a[192:195], a[96:99], v[32:35]
    s_add_u32 m0, s25, 67680
    v_exp_f32 v17, v17
    v_mfma_f32_16x16x32_bf16 a[236:239], a[252:255], v[160:163], a[236:239]
    s_waitcnt lgkmcnt(1)
    buffer_load_dwordx4 v4, s[12:15], s28 offen offset:3072 nt lds
    v_mfma_f32_16x16x32_bf16 v[36:39], a[224:227], a[0:3], 0
    ds_read_b128 a[220:223], v26 offset:512
    v_fma_f32 v18, v42, s26, v14
    v_mfma_f32_16x16x32_bf16 v[36:39], a[228:231], a[4:7], v[36:39]
    v_exp_f32 v18, v18
    v_mfma_f32_16x16x32_bf16 v[36:39], a[232:235], a[8:11], v[36:39]
    v_fma_f32 v19, v43, s26, v14
    v_cvt_pk_bf16_f32 v170, v16, v17
    v_mfma_f32_16x16x32_bf16 v[36:39], a[172:175], a[12:15], v[36:39]
    v_exp_f32 v19, v19
    v_mfma_f32_16x16x32_bf16 v[36:39], a[176:179], a[16:19], v[36:39]
    s_xor_b32 s28, s98, 0
    ds_read_b128 a[216:219], v26 offset:576
    v_fma_f32 v16, v32, s26, v15
    v_mfma_f32_16x16x32_bf16 v[36:39], a[180:183], a[20:23], v[36:39]
    s_add_u32 m0, s25, 84480
    v_exp_f32 v16, v16
    v_mfma_f32_16x16x32_bf16 v[36:39], a[184:187], a[24:27], v[36:39]
    s_waitcnt lgkmcnt(2)
    v_fma_f32 v17, v33, s26, v15
    v_cvt_pk_bf16_f32 v171, v18, v19
    v_mfma_f32_16x16x32_bf16 v[36:39], a[188:191], a[28:31], v[36:39]
    buffer_load_dwordx4 v5, s[16:19], s28 offen offset:0 lds
    v_exp_f32 v17, v17
    v_mfma_f32_16x16x32_bf16 v[40:43], a[188:191], a[60:63], 0
    ds_read_b128 a[212:215], v26 offset:640
    v_fma_f32 v18, v34, s26, v15
    v_mfma_f32_16x16x32_bf16 v[40:43], a[184:187], a[56:59], v[40:43]
    v_exp_f32 v18, v18
    v_mfma_f32_16x16x32_bf16 v[40:43], a[180:183], a[52:55], v[40:43]
    v_fma_f32 v19, v35, s26, v15
    v_cvt_pk_bf16_f32 v174, v16, v17
    v_mfma_f32_16x16x32_bf16 v[40:43], a[176:179], a[48:51], v[40:43]
    v_exp_f32 v19, v19
    v_mfma_f32_16x16x32_bf16 v[40:43], a[172:175], a[44:47], v[40:43]
    ds_read_b128 a[208:211], v26 offset:704
    v_fma_f32 v16, v36, s26, v12
    v_mfma_f32_16x16x32_bf16 v[40:43], a[232:235], a[40:43], v[40:43]
    v_exp_f32 v16, v16
    v_mfma_f32_16x16x32_bf16 v[40:43], a[228:231], a[36:39], v[40:43]
    v_fma_f32 v17, v37, s26, v12
    v_cvt_pk_bf16_f32 v175, v18, v19
    v_mfma_f32_16x16x32_bf16 v[40:43], a[224:227], a[32:35], v[40:43]
    s_add_u32 m0, s25, 84488
    v_exp_f32 v17, v17
    v_mfma_f32_16x16x32_bf16 a[240:243], a[252:255], v[164:167], a[240:243]
    buffer_load_dwordx4 v5, s[16:19], s28 offen offset:1024 lds
    v_mfma_f32_16x16x32_bf16 v[32:35], a[224:227], a[64:67], 0
L_pad4:
    s_cbranch_vccnz L_pad8
    ds_read_b128 a[204:207], v26 offset:768
    v_fma_f32 v18, v38, s26, v12
    v_mfma_f32_16x16x32_bf16 v[32:35], a[228:231], a[68:71], v[32:35]
    v_exp_f32 v18, v18
    v_mfma_f32_16x16x32_bf16 v[32:35], a[232:235], a[72:75], v[32:35]
    v_fma_f32 v19, v39, s26, v12
    v_cvt_pk_bf16_f32 v176, v16, v17
    v_mfma_f32_16x16x32_bf16 v[32:35], a[172:175], a[76:79], v[32:35]
    v_exp_f32 v19, v19
    v_mfma_f32_16x16x32_bf16 v[32:35], a[176:179], a[80:83], v[32:35]
    ds_read_b128 a[200:203], v26 offset:832
    v_fma_f32 v16, v40, s26, v13
    v_mfma_f32_16x16x32_bf16 v[32:35], a[180:183], a[84:87], v[32:35]
    v_exp_f32 v16, v16
    v_mfma_f32_16x16x32_bf16 v[32:35], a[184:187], a[88:91], v[32:35]
    v_fma_f32 v17, v41, s26, v13
    v_cvt_pk_bf16_f32 v177, v18, v19
    v_mfma_f32_16x16x32_bf16 v[32:35], a[188:191], a[92:95], v[32:35]
    v_exp_f32 v17, v17
    v_mfma_f32_16x16x32_bf16 v[36:39], a[188:191], a[124:127], 0
    ds_read_b128 a[196:199], v26 offset:896
    v_fma_f32 v18, v42, s26, v13
    v_mfma_f32_16x16x32_bf16 v[36:39], a[184:187], a[120:123], v[36:39]
    v_exp_f32 v18, v18
    v_mfma_f32_16x16x32_bf16 v[36:39], a[180:183], a[116:119], v[36:39]
    v_fma_f32 v19, v43, s26, v13
    v_cvt_pk_bf16_f32 v180, v16, v17
    v_mfma_f32_16x16x32_bf16 v[36:39], a[176:179], a[112:115], v[36:39]
    v_exp_f32 v19, v19
    v_mfma_f32_16x16x32_bf16 v[36:39], a[172:175], a[108:111], v[36:39]
    ds_read_b128 a[192:195], v26 offset:960
    v_fma_f32 v16, v32, s26, v14
    v_mfma_f32_16x16x32_bf16 v[36:39], a[232:235], a[104:107], v[36:39]
    v_exp_f32 v16, v16
    v_mfma_f32_16x16x32_bf16 v[36:39], a[228:231], a[100:103], v[36:39]
    v_fma_f32 v17, v33, s26, v14
    v_cvt_pk_bf16_f32 v181, v18, v19
    v_mfma_f32_16x16x32_bf16 v[36:39], a[224:227], a[96:99], v[36:39]
    s_add_u32 m0, s25, 84544
    v_exp_f32 v17, v17
    v_mfma_f32_16x16x32_bf16 a[244:247], a[252:255], v[168:171], a[244:247]
    s_waitcnt vmcnt(12) lgkmcnt(1)
    buffer_load_dwordx4 v5, s[16:19], s28 offen offset:2048 lds
    v_mfma_f32_16x16x32_bf16 v[40:43], a[220:223], a[0:3], 0
    s_barrier
    ds_read_b128 a[188:191], v24 offset:33792
    v_fma_f32 v18, v34, s26, v14
    v_mfma_f32_16x16x32_bf16 v[40:43], a[216:219], a[4:7], v[40:43]
    v_exp_f32 v18, v18
    v_mfma_f32_16x16x32_bf16 v[40:43], a[212:215], a[8:11], v[40:43]
    v_fma_f32 v19, v35, s26, v14
    v_cvt_pk_bf16_f32 v184, v16, v17
    v_mfma_f32_16x16x32_bf16 v[40:43], a[208:211], a[12:15], v[40:43]
    v_exp_f32 v19, v19
    v_mfma_f32_16x16x32_bf16 v[40:43], a[204:207], a[16:19], v[40:43]
    ds_read_b128 a[184:187], v24 offset:33856
    v_fma_f32 v16, v36, s26, v15
    v_mfma_f32_16x16x32_bf16 v[40:43], a[200:203], a[20:23], v[40:43]
    s_xor_b32 s101, s30, 196608
    v_exp_f32 v16, v16
    v_mfma_f32_16x16x32_bf16 v[40:43], a[196:199], a[24:27], v[40:43]
    s_waitcnt lgkmcnt(2)
    v_fma_f32 v17, v37, s26, v15
    v_cvt_pk_bf16_f32 v185, v18, v19
    v_mfma_f32_16x16x32_bf16 v[40:43], a[192:195], a[28:31], v[40:43]
    buffer_load_dword v11, v10, s[16:19], s101 offen offset:0
    v_exp_f32 v17, v17
    v_mfma_f32_16x16x32_bf16 v[32:35], a[192:195], a[60:63], 0
    ds_read_b128 a[180:183], v24 offset:33920
    v_fma_f32 v18, v38, s26, v15
    v_mfma_f32_16x16x32_bf16 v[32:35], a[196:199], a[56:59], v[32:35]
    v_exp_f32 v18, v18
    v_mfma_f32_16x16x32_bf16 v[32:35], a[200:203], a[52:55], v[32:35]
    v_fma_f32 v19, v39, s26, v15
    v_cvt_pk_bf16_f32 v188, v16, v17
    v_mfma_f32_16x16x32_bf16 v[32:35], a[204:207], a[48:51], v[32:35]
    v_exp_f32 v19, v19
    v_mfma_f32_16x16x32_bf16 v[32:35], a[208:211], a[44:47], v[32:35]
    ds_read_b128 a[176:179], v24 offset:33984
    v_fma_f32 v16, v40, s26, v12
    v_mfma_f32_16x16x32_bf16 v[32:35], a[212:215], a[40:43], v[32:35]
    v_exp_f32 v16, v16
    v_mfma_f32_16x16x32_bf16 v[32:35], a[216:219], a[36:39], v[32:35]
    v_fma_f32 v17, v41, s26, v12
    v_cvt_pk_bf16_f32 v189, v18, v19
    v_mfma_f32_16x16x32_bf16 v[32:35], a[220:223], a[32:35], v[32:35]
    s_add_u32 m0, s25, 84552
    v_exp_f32 v17, v17
    v_mfma_f32_16x16x32_bf16 a[248:251], a[252:255], v[172:175], a[248:251]
    buffer_load_dwordx4 v5, s[16:19], s28 offen offset:3072 lds
    v_mfma_f32_16x16x32_bf16 v[36:39], a[220:223], a[64:67], 0
    ds_read_b128 a[172:175], v24 offset:34048
    v_fma_f32 v18, v42, s26, v12
    v_mfma_f32_16x16x32_bf16 v[36:39], a[216:219], a[68:71], v[36:39]
    v_exp_f32 v18, v18
    v_mfma_f32_16x16x32_bf16 v[36:39], a[212:215], a[72:75], v[36:39]
    v_fma_f32 v19, v43, s26, v12
    v_cvt_pk_bf16_f32 v178, v16, v17
    v_mfma_f32_16x16x32_bf16 v[36:39], a[208:211], a[76:79], v[36:39]
    v_exp_f32 v19, v19
    v_mfma_f32_16x16x32_bf16 v[36:39], a[204:207], a[80:83], v[36:39]
    ds_read_b128 a[232:235], v24 offset:34112
    v_fma_f32 v16, v32, s26, v13
    v_mfma_f32_16x16x32_bf16 v[36:39], a[200:203], a[84:87], v[36:39]
    v_exp_f32 v16, v16
    v_mfma_f32_16x16x32_bf16 v[36:39], a[196:199], a[88:91], v[36:39]
    v_fma_f32 v17, v33, s26, v13
    v_cvt_pk_bf16_f32 v179, v18, v19
    v_mfma_f32_16x16x32_bf16 v[36:39], a[192:195], a[92:95], v[36:39]
    v_exp_f32 v17, v17
    v_mfma_f32_16x16x32_bf16 v[40:43], a[192:195], a[124:127], 0
    ds_read_b128 a[228:231], v24 offset:34176
    v_fma_f32 v18, v34, s26, v13
    v_mfma_f32_16x16x32_bf16 v[40:43], a[196:199], a[120:123], v[40:43]
    v_exp_f32 v18, v18
    v_mfma_f32_16x16x32_bf16 v[40:43], a[200:203], a[116:119], v[40:43]
    v_fma_f32 v19, v35, s26, v13
    v_cvt_pk_bf16_f32 v182, v16, v17
    v_mfma_f32_16x16x32_bf16 v[40:43], a[204:207], a[112:115], v[40:43]
    v_exp_f32 v19, v19
    v_mfma_f32_16x16x32_bf16 v[40:43], a[208:211], a[108:111], v[40:43]
    ds_read_b128 a[224:227], v24 offset:34240
    v_fma_f32 v16, v36, s26, v14
    v_mfma_f32_16x16x32_bf16 v[40:43], a[212:215], a[104:107], v[40:43]
    v_exp_f32 v16, v16
    v_mfma_f32_16x16x32_bf16 v[40:43], a[216:219], a[100:103], v[40:43]
    s_xor_b32 s28, s98, 65536
    v_fma_f32 v17, v37, s26, v14
    v_cvt_pk_bf16_f32 v183, v18, v19
    v_mfma_f32_16x16x32_bf16 v[40:43], a[220:223], a[96:99], v[40:43]
    s_add_u32 m0, s25, 101376
    v_exp_f32 v17, v17
    v_mfma_f32_16x16x32_bf16 a[236:239], a[252:255], v[176:179], a[236:239]
    s_waitcnt lgkmcnt(1)
    buffer_load_dwordx4 v5, s[16:19], s28 offen offset:0 lds
    v_mfma_f32_16x16x32_bf16 v[32:35], a[188:191], a[0:3], 0
    ds_read_b128 a[192:195], v24 offset:34304
    v_fma_f32 v18, v38, s26, v14
    v_mfma_f32_16x16x32_bf16 v[32:35], a[184:187], a[4:7], v[32:35]
    v_exp_f32 v18, v18
    v_mfma_f32_16x16x32_bf16 v[32:35], a[180:183], a[8:11], v[32:35]
    v_fma_f32 v19, v39, s26, v14
    v_cvt_pk_bf16_f32 v186, v16, v17
    v_mfma_f32_16x16x32_bf16 v[32:35], a[176:179], a[12:15], v[32:35]
    v_exp_f32 v19, v19
    v_mfma_f32_16x16x32_bf16 v[32:35], a[172:175], a[16:19], v[32:35]
    ds_read_b128 a[196:199], v24 offset:34368
    v_fma_f32 v16, v40, s26, v15
    v_mfma_f32_16x16x32_bf16 v[32:35], a[232:235], a[20:23], v[32:35]
    s_add_u32 m0, s25, 101384
    v_exp_f32 v16, v16
    v_mfma_f32_16x16x32_bf16 v[32:35], a[228:231], a[24:27], v[32:35]
    s_waitcnt lgkmcnt(2)
    v_fma_f32 v17, v41, s26, v15
    v_cvt_pk_bf16_f32 v187, v18, v19
    v_mfma_f32_16x16x32_bf16 v[32:35], a[224:227], a[28:31], v[32:35]
    buffer_load_dwordx4 v5, s[16:19], s28 offen offset:1024 lds
    v_exp_f32 v17, v17
    v_mfma_f32_16x16x32_bf16 v[36:39], a[224:227], a[60:63], 0
    ds_read_b128 a[200:203], v24 offset:34432
    v_fma_f32 v18, v42, s26, v15
    v_mfma_f32_16x16x32_bf16 v[36:39], a[228:231], a[56:59], v[36:39]
    v_exp_f32 v18, v18
    v_mfma_f32_16x16x32_bf16 v[36:39], a[232:235], a[52:55], v[36:39]
    v_fma_f32 v19, v43, s26, v15
    v_cvt_pk_bf16_f32 v190, v16, v17
    v_mfma_f32_16x16x32_bf16 v[36:39], a[172:175], a[48:51], v[36:39]
    v_exp_f32 v19, v19
    v_mfma_f32_16x16x32_bf16 v[36:39], a[176:179], a[44:47], v[36:39]
    ds_read_b128 a[204:207], v24 offset:34496
    v_fma_f32 v16, v32, s26, v12
    v_mfma_f32_16x16x32_bf16 v[36:39], a[180:183], a[40:43], v[36:39]
    v_exp_f32 v16, v16
    v_mfma_f32_16x16x32_bf16 v[36:39], a[184:187], a[36:39], v[36:39]
    v_fma_f32 v17, v33, s26, v12
    v_cvt_pk_bf16_f32 v191, v18, v19
    v_mfma_f32_16x16x32_bf16 v[36:39], a[188:191], a[32:35], v[36:39]
    s_add_u32 m0, s25, 101440
    v_exp_f32 v17, v17
    v_mfma_f32_16x16x32_bf16 a[240:243], a[252:255], v[180:183], a[240:243]
    buffer_load_dwordx4 v5, s[16:19], s28 offen offset:2048 lds
    v_mfma_f32_16x16x32_bf16 v[40:43], a[188:191], a[64:67], 0
    ds_read_b128 a[208:211], v24 offset:34560
    v_fma_f32 v18, v34, s26, v12
    v_mfma_f32_16x16x32_bf16 v[40:43], a[184:187], a[68:71], v[40:43]
    v_exp_f32 v18, v18
    v_mfma_f32_16x16x32_bf16 v[40:43], a[180:183], a[72:75], v[40:43]
    v_fma_f32 v19, v35, s26, v12
    v_cvt_pk_bf16_f32 v192, v16, v17
    v_mfma_f32_16x16x32_bf16 v[40:43], a[176:179], a[76:79], v[40:43]
    v_exp_f32 v19, v19
    v_mfma_f32_16x16x32_bf16 v[40:43], a[172:175], a[80:83], v[40:43]
    ds_read_b128 a[212:215], v24 offset:34624
    v_fma_f32 v16, v36, s26, v13
    v_mfma_f32_16x16x32_bf16 v[40:43], a[232:235], a[84:87], v[40:43]
    v_exp_f32 v16, v16
    v_mfma_f32_16x16x32_bf16 v[40:43], a[228:231], a[88:91], v[40:43]
    v_fma_f32 v17, v37, s26, v13
    v_cvt_pk_bf16_f32 v193, v18, v19
    v_mfma_f32_16x16x32_bf16 v[40:43], a[224:227], a[92:95], v[40:43]
    v_exp_f32 v17, v17
    v_mfma_f32_16x16x32_bf16 v[32:35], a[224:227], a[124:127], 0
    ds_read_b128 a[216:219], v24 offset:34688
    v_fma_f32 v18, v38, s26, v13
    v_mfma_f32_16x16x32_bf16 v[32:35], a[228:231], a[120:123], v[32:35]
    v_exp_f32 v18, v18
    v_mfma_f32_16x16x32_bf16 v[32:35], a[232:235], a[116:119], v[32:35]
    v_fma_f32 v19, v39, s26, v13
    v_cvt_pk_bf16_f32 v196, v16, v17
    v_mfma_f32_16x16x32_bf16 v[32:35], a[172:175], a[112:115], v[32:35]
    v_exp_f32 v19, v19
    v_mfma_f32_16x16x32_bf16 v[32:35], a[176:179], a[108:111], v[32:35]
    ds_read_b128 a[220:223], v24 offset:34752
    v_fma_f32 v16, v40, s26, v14
    v_mfma_f32_16x16x32_bf16 v[32:35], a[180:183], a[104:107], v[32:35]
    v_exp_f32 v16, v16
    v_mfma_f32_16x16x32_bf16 v[32:35], a[184:187], a[100:103], v[32:35]
    v_fma_f32 v17, v41, s26, v14
    v_cvt_pk_bf16_f32 v197, v18, v19
    v_mfma_f32_16x16x32_bf16 v[32:35], a[188:191], a[96:99], v[32:35]
    s_add_u32 m0, s25, 101448
    v_exp_f32 v17, v17
    v_mfma_f32_16x16x32_bf16 a[244:247], a[252:255], v[184:187], a[244:247]
    s_waitcnt lgkmcnt(1)
    buffer_load_dwordx4 v5, s[16:19], s28 offen offset:3072 lds
    v_mfma_f32_16x16x32_bf16 v[36:39], a[192:195], a[0:3], 0
    ds_read_b128 a[224:227], v24 offset:16896
    v_fma_f32 v18, v42, s26, v14
    v_mfma_f32_16x16x32_bf16 v[36:39], a[196:199], a[4:7], v[36:39]
    v_exp_f32 v18, v18
    v_mfma_f32_16x16x32_bf16 v[36:39], a[200:203], a[8:11], v[36:39]
    v_fma_f32 v19, v43, s26, v14
    v_cvt_pk_bf16_f32 v200, v16, v17
    v_mfma_f32_16x16x32_bf16 v[36:39], a[204:207], a[12:15], v[36:39]
    v_exp_f32 v19, v19
    v_mfma_f32_16x16x32_bf16 v[36:39], a[208:211], a[16:19], v[36:39]
    ds_read_b128 a[228:231], v24 offset:16960
    v_fma_f32 v16, v32, s26, v15
    v_mfma_f32_16x16x32_bf16 v[36:39], a[212:215], a[20:23], v[36:39]
    v_exp_f32 v16, v16
    v_mfma_f32_16x16x32_bf16 v[36:39], a[216:219], a[24:27], v[36:39]
    s_waitcnt lgkmcnt(2)
    v_fma_f32 v17, v33, s26, v15
    v_cvt_pk_bf16_f32 v201, v18, v19
    v_mfma_f32_16x16x32_bf16 v[36:39], a[220:223], a[28:31], v[36:39]
    v_exp_f32 v17, v17
    v_mfma_f32_16x16x32_bf16 v[40:43], a[220:223], a[60:63], 0
    ds_read_b128 a[232:235], v24 offset:17024
    v_fma_f32 v18, v34, s26, v15
    v_mfma_f32_16x16x32_bf16 v[40:43], a[216:219], a[56:59], v[40:43]
    v_exp_f32 v18, v18
    v_mfma_f32_16x16x32_bf16 v[40:43], a[212:215], a[52:55], v[40:43]
    v_fma_f32 v19, v35, s26, v15
    v_cvt_pk_bf16_f32 v204, v16, v17
    v_mfma_f32_16x16x32_bf16 v[40:43], a[208:211], a[48:51], v[40:43]
    v_exp_f32 v19, v19
    v_mfma_f32_16x16x32_bf16 v[40:43], a[204:207], a[44:47], v[40:43]
    ds_read_b128 a[172:175], v24 offset:17088
    v_fma_f32 v16, v36, s26, v12
    v_mfma_f32_16x16x32_bf16 v[40:43], a[200:203], a[40:43], v[40:43]
    v_exp_f32 v16, v16
    v_mfma_f32_16x16x32_bf16 v[40:43], a[196:199], a[36:39], v[40:43]
    s_xor_b32 s28, s98, 131072
    v_fma_f32 v17, v37, s26, v12
    v_cvt_pk_bf16_f32 v205, v18, v19
    v_mfma_f32_16x16x32_bf16 v[40:43], a[192:195], a[32:35], v[40:43]
    s_add_u32 m0, s25, 0
    v_exp_f32 v17, v17
    v_mfma_f32_16x16x32_bf16 a[248:251], a[252:255], v[188:191], a[248:251]
    buffer_load_dwordx4 v5, s[16:19], s28 offen offset:0 lds
    v_mfma_f32_16x16x32_bf16 v[32:35], a[192:195], a[64:67], 0
    ds_read_b128 a[176:179], v24 offset:17152
    v_fma_f32 v18, v38, s26, v12
    v_mfma_f32_16x16x32_bf16 v[32:35], a[196:199], a[68:71], v[32:35]
    v_exp_f32 v18, v18
    v_mfma_f32_16x16x32_bf16 v[32:35], a[200:203], a[72:75], v[32:35]
    v_fma_f32 v19, v39, s26, v12
    v_cvt_pk_bf16_f32 v194, v16, v17
    v_mfma_f32_16x16x32_bf16 v[32:35], a[204:207], a[76:79], v[32:35]
    v_exp_f32 v19, v19
    v_mfma_f32_16x16x32_bf16 v[32:35], a[208:211], a[80:83], v[32:35]
    ds_read_b128 a[180:183], v24 offset:17216
    v_fma_f32 v16, v40, s26, v13
    v_mfma_f32_16x16x32_bf16 v[32:35], a[212:215], a[84:87], v[32:35]
    v_exp_f32 v16, v16
    v_mfma_f32_16x16x32_bf16 v[32:35], a[216:219], a[88:91], v[32:35]
    s_xor_b32 s101, s30, 229376
    v_fma_f32 v17, v41, s26, v13
    v_cvt_pk_bf16_f32 v195, v18, v19
    v_mfma_f32_16x16x32_bf16 v[32:35], a[220:223], a[92:95], v[32:35]
    buffer_load_dword v11, v10, s[16:19], s101 offen offset:0
    v_exp_f32 v17, v17
    v_mfma_f32_16x16x32_bf16 v[36:39], a[220:223], a[124:127], 0
    ds_read_b128 a[184:187], v24 offset:17280
    v_fma_f32 v18, v42, s26, v13
    v_mfma_f32_16x16x32_bf16 v[36:39], a[216:219], a[120:123], v[36:39]
    v_exp_f32 v18, v18
    v_mfma_f32_16x16x32_bf16 v[36:39], a[212:215], a[116:119], v[36:39]
    v_fma_f32 v19, v43, s26, v13
    v_cvt_pk_bf16_f32 v198, v16, v17
    v_mfma_f32_16x16x32_bf16 v[36:39], a[208:211], a[112:115], v[36:39]
    v_exp_f32 v19, v19
    v_mfma_f32_16x16x32_bf16 v[36:39], a[204:207], a[108:111], v[36:39]
    ds_read_b128 a[188:191], v24 offset:17344
    v_fma_f32 v16, v32, s26, v14
    v_mfma_f32_16x16x32_bf16 v[36:39], a[200:203], a[104:107], v[36:39]
    v_exp_f32 v16, v16
    v_mfma_f32_16x16x32_bf16 v[36:39], a[196:199], a[100:103], v[36:39]
    v_fma_f32 v17, v33, s26, v14
    v_cvt_pk_bf16_f32 v199, v18, v19
    v_mfma_f32_16x16x32_bf16 v[36:39], a[192:195], a[96:99], v[36:39]
    s_add_u32 m0, s25, 8
    v_exp_f32 v17, v17
    v_mfma_f32_16x16x32_bf16 a[236:239], a[252:255], v[192:195], a[236:239]
    s_waitcnt lgkmcnt(1)
    buffer_load_dwordx4 v5, s[16:19], s28 offen offset:1024 lds
    v_mfma_f32_16x16x32_bf16 v[40:43], a[224:227], a[0:3], 0
    ds_read_b128 a[220:223], v24 offset:17408
    v_fma_f32 v18, v34, s26, v14
    v_mfma_f32_16x16x32_bf16 v[40:43], a[228:231], a[4:7], v[40:43]
    v_exp_f32 v18, v18
    v_mfma_f32_16x16x32_bf16 v[40:43], a[232:235], a[8:11], v[40:43]
    v_fma_f32 v19, v35, s26, v14
    v_cvt_pk_bf16_f32 v202, v16, v17
    v_mfma_f32_16x16x32_bf16 v[40:43], a[172:175], a[12:15], v[40:43]
    v_exp_f32 v19, v19
    v_mfma_f32_16x16x32_bf16 v[40:43], a[176:179], a[16:19], v[40:43]
    ds_read_b128 a[216:219], v24 offset:17472
    v_fma_f32 v16, v36, s26, v15
    v_mfma_f32_16x16x32_bf16 v[40:43], a[180:183], a[20:23], v[40:43]
    s_add_u32 m0, s25, 64
    v_exp_f32 v16, v16
    v_mfma_f32_16x16x32_bf16 v[40:43], a[184:187], a[24:27], v[40:43]
    s_waitcnt lgkmcnt(2)
    v_fma_f32 v17, v37, s26, v15
    v_cvt_pk_bf16_f32 v203, v18, v19
    v_mfma_f32_16x16x32_bf16 v[40:43], a[188:191], a[28:31], v[40:43]
    buffer_load_dwordx4 v5, s[16:19], s28 offen offset:2048 lds
    v_exp_f32 v17, v17
    v_mfma_f32_16x16x32_bf16 v[32:35], a[188:191], a[60:63], 0
    ds_read_b128 a[212:215], v24 offset:17536
    v_fma_f32 v18, v38, s26, v15
    v_mfma_f32_16x16x32_bf16 v[32:35], a[184:187], a[56:59], v[32:35]
    v_exp_f32 v18, v18
    v_mfma_f32_16x16x32_bf16 v[32:35], a[180:183], a[52:55], v[32:35]
    v_fma_f32 v19, v39, s26, v15
    v_cvt_pk_bf16_f32 v206, v16, v17
    v_mfma_f32_16x16x32_bf16 v[32:35], a[176:179], a[48:51], v[32:35]
    v_exp_f32 v19, v19
    v_mfma_f32_16x16x32_bf16 v[32:35], a[172:175], a[44:47], v[32:35]
    ds_read_b128 a[208:211], v24 offset:17600
    v_fma_f32 v16, v40, s26, v12
    v_mfma_f32_16x16x32_bf16 v[32:35], a[232:235], a[40:43], v[32:35]
    v_exp_f32 v16, v16
    v_mfma_f32_16x16x32_bf16 v[32:35], a[228:231], a[36:39], v[32:35]
    v_fma_f32 v17, v41, s26, v12
    v_cvt_pk_bf16_f32 v207, v18, v19
    v_mfma_f32_16x16x32_bf16 v[32:35], a[224:227], a[32:35], v[32:35]
    s_add_u32 m0, s25, 72
    v_exp_f32 v17, v17
    v_mfma_f32_16x16x32_bf16 a[240:243], a[252:255], v[196:199], a[240:243]
    buffer_load_dwordx4 v5, s[16:19], s28 offen offset:3072 lds
    v_mfma_f32_16x16x32_bf16 v[36:39], a[224:227], a[64:67], 0
    ds_read_b128 a[204:207], v24 offset:17664
    v_fma_f32 v18, v42, s26, v12
    v_mfma_f32_16x16x32_bf16 v[36:39], a[228:231], a[68:71], v[36:39]
    v_exp_f32 v18, v18
    v_mfma_f32_16x16x32_bf16 v[36:39], a[232:235], a[72:75], v[36:39]
    v_fma_f32 v19, v43, s26, v12
    v_cvt_pk_bf16_f32 v208, v16, v17
    v_mfma_f32_16x16x32_bf16 v[36:39], a[172:175], a[76:79], v[36:39]
    v_exp_f32 v19, v19
    v_mfma_f32_16x16x32_bf16 v[36:39], a[176:179], a[80:83], v[36:39]
    ds_read_b128 a[200:203], v24 offset:17728
    v_fma_f32 v16, v32, s26, v13
    v_mfma_f32_16x16x32_bf16 v[36:39], a[180:183], a[84:87], v[36:39]
    v_exp_f32 v16, v16
    v_mfma_f32_16x16x32_bf16 v[36:39], a[184:187], a[88:91], v[36:39]
    v_fma_f32 v17, v33, s26, v13
    v_cvt_pk_bf16_f32 v209, v18, v19
    v_mfma_f32_16x16x32_bf16 v[36:39], a[188:191], a[92:95], v[36:39]
    v_exp_f32 v17, v17
    v_mfma_f32_16x16x32_bf16 v[40:43], a[188:191], a[124:127], 0
    ds_read_b128 a[196:199], v24 offset:17792
    v_fma_f32 v18, v34, s26, v13
    v_mfma_f32_16x16x32_bf16 v[40:43], a[184:187], a[120:123], v[40:43]
    v_exp_f32 v18, v18
    v_mfma_f32_16x16x32_bf16 v[40:43], a[180:183], a[116:119], v[40:43]
    v_fma_f32 v19, v35, s26, v13
    v_cvt_pk_bf16_f32 v212, v16, v17
    v_mfma_f32_16x16x32_bf16 v[40:43], a[176:179], a[112:115], v[40:43]
    v_exp_f32 v19, v19
    v_mfma_f32_16x16x32_bf16 v[40:43], a[172:175], a[108:111], v[40:43]
    ds_read_b128 a[192:195], v24 offset:17856
    v_fma_f32 v16, v36, s26, v14
    v_mfma_f32_16x16x32_bf16 v[40:43], a[232:235], a[104:107], v[40:43]
    v_exp_f32 v16, v16
    v_mfma_f32_16x16x32_bf16 v[40:43], a[228:231], a[100:103], v[40:43]
    s_xor_b32 s28, s98, 196608
    v_fma_f32 v17, v37, s26, v14
    v_cvt_pk_bf16_f32 v213, v18, v19
    v_mfma_f32_16x16x32_bf16 v[40:43], a[224:227], a[96:99], v[40:43]
    s_add_u32 m0, s25, 118272
    v_exp_f32 v17, v17
    v_mfma_f32_16x16x32_bf16 a[244:247], a[252:255], v[200:203], a[244:247]
    s_waitcnt vmcnt(14) lgkmcnt(1)
    buffer_load_dwordx4 v5, s[16:19], s28 offen offset:0 lds
    v_mfma_f32_16x16x32_bf16 v[32:35], a[220:223], a[0:3], 0
    s_barrier
    ds_read_b128 a[188:191], v24 offset:50688
    v_fma_f32 v18, v38, s26, v14
    v_mfma_f32_16x16x32_bf16 v[32:35], a[216:219], a[4:7], v[32:35]
    v_exp_f32 v18, v18
    v_mfma_f32_16x16x32_bf16 v[32:35], a[212:215], a[8:11], v[32:35]
    v_fma_f32 v19, v39, s26, v14
    v_cvt_pk_bf16_f32 v216, v16, v17
    v_mfma_f32_16x16x32_bf16 v[32:35], a[208:211], a[12:15], v[32:35]
    v_exp_f32 v19, v19
    v_mfma_f32_16x16x32_bf16 v[32:35], a[204:207], a[16:19], v[32:35]
    ds_read_b128 a[184:187], v24 offset:50752
    v_fma_f32 v16, v40, s26, v15
    v_mfma_f32_16x16x32_bf16 v[32:35], a[200:203], a[20:23], v[32:35]
    v_exp_f32 v16, v16
    v_mfma_f32_16x16x32_bf16 v[32:35], a[196:199], a[24:27], v[32:35]
    s_waitcnt lgkmcnt(2)
    v_fma_f32 v17, v41, s26, v15
    v_cvt_pk_bf16_f32 v217, v18, v19
    v_mfma_f32_16x16x32_bf16 v[32:35], a[192:195], a[28:31], v[32:35]
    v_exp_f32 v17, v17
    v_mfma_f32_16x16x32_bf16 v[36:39], a[192:195], a[60:63], 0
    ds_read_b128 a[180:183], v24 offset:50816
    v_fma_f32 v18, v42, s26, v15
    v_mfma_f32_16x16x32_bf16 v[36:39], a[196:199], a[56:59], v[36:39]
    v_exp_f32 v18, v18
    v_mfma_f32_16x16x32_bf16 v[36:39], a[200:203], a[52:55], v[36:39]
    v_fma_f32 v19, v43, s26, v15
    v_cvt_pk_bf16_f32 v220, v16, v17
    v_mfma_f32_16x16x32_bf16 v[36:39], a[204:207], a[48:51], v[36:39]
    v_exp_f32 v19, v19
    v_mfma_f32_16x16x32_bf16 v[36:39], a[208:211], a[44:47], v[36:39]
    ds_read_b128 a[176:179], v24 offset:50880
    v_fma_f32 v16, v32, s26, v12
    v_mfma_f32_16x16x32_bf16 v[36:39], a[212:215], a[40:43], v[36:39]
    v_exp_f32 v16, v16
    v_mfma_f32_16x16x32_bf16 v[36:39], a[216:219], a[36:39], v[36:39]
    v_fma_f32 v17, v33, s26, v12
    v_cvt_pk_bf16_f32 v221, v18, v19
    v_mfma_f32_16x16x32_bf16 v[36:39], a[220:223], a[32:35], v[36:39]
    s_add_u32 m0, s25, 118280
    v_exp_f32 v17, v17
    v_mfma_f32_16x16x32_bf16 a[248:251], a[252:255], v[204:207], a[248:251]
    buffer_load_dwordx4 v5, s[16:19], s28 offen offset:1024 lds
    v_mfma_f32_16x16x32_bf16 v[40:43], a[220:223], a[64:67], 0
    ds_read_b128 a[172:175], v24 offset:50944
    v_fma_f32 v18, v34, s26, v12
    v_mfma_f32_16x16x32_bf16 v[40:43], a[216:219], a[68:71], v[40:43]
    v_exp_f32 v18, v18
    v_mfma_f32_16x16x32_bf16 v[40:43], a[212:215], a[72:75], v[40:43]
    v_fma_f32 v19, v35, s26, v12
    v_cvt_pk_bf16_f32 v210, v16, v17
    v_mfma_f32_16x16x32_bf16 v[40:43], a[208:211], a[76:79], v[40:43]
    v_exp_f32 v19, v19
    v_mfma_f32_16x16x32_bf16 v[40:43], a[204:207], a[80:83], v[40:43]
    ds_read_b128 a[232:235], v24 offset:51008
    v_fma_f32 v16, v36, s26, v13
    v_mfma_f32_16x16x32_bf16 v[40:43], a[200:203], a[84:87], v[40:43]
    v_exp_f32 v16, v16
    v_mfma_f32_16x16x32_bf16 v[40:43], a[196:199], a[88:91], v[40:43]
    v_fma_f32 v17, v37, s26, v13
    v_cvt_pk_bf16_f32 v211, v18, v19
    v_mfma_f32_16x16x32_bf16 v[40:43], a[192:195], a[92:95], v[40:43]
    v_exp_f32 v17, v17
    v_mfma_f32_16x16x32_bf16 v[32:35], a[192:195], a[124:127], 0
    ds_read_b128 a[228:231], v24 offset:51072
    v_fma_f32 v18, v38, s26, v13
    v_mfma_f32_16x16x32_bf16 v[32:35], a[196:199], a[120:123], v[32:35]
    v_exp_f32 v18, v18
    v_mfma_f32_16x16x32_bf16 v[32:35], a[200:203], a[116:119], v[32:35]
    v_fma_f32 v19, v39, s26, v13
    v_cvt_pk_bf16_f32 v214, v16, v17
    v_mfma_f32_16x16x32_bf16 v[32:35], a[204:207], a[112:115], v[32:35]
    v_exp_f32 v19, v19
    v_mfma_f32_16x16x32_bf16 v[32:35], a[208:211], a[108:111], v[32:35]
    ds_read_b128 a[224:227], v24 offset:51136
    v_fma_f32 v16, v40, s26, v14
    v_mfma_f32_16x16x32_bf16 v[32:35], a[212:215], a[104:107], v[32:35]
    v_exp_f32 v16, v16
    v_mfma_f32_16x16x32_bf16 v[32:35], a[216:219], a[100:103], v[32:35]
    v_fma_f32 v17, v41, s26, v14
    v_cvt_pk_bf16_f32 v215, v18, v19
    v_mfma_f32_16x16x32_bf16 v[32:35], a[220:223], a[96:99], v[32:35]
    s_add_u32 m0, s25, 118336
    v_exp_f32 v17, v17
    v_mfma_f32_16x16x32_bf16 a[236:239], a[252:255], v[208:211], a[236:239]
    s_waitcnt lgkmcnt(1)
    buffer_load_dwordx4 v5, s[16:19], s28 offen offset:2048 lds
    v_mfma_f32_16x16x32_bf16 v[36:39], a[188:191], a[0:3], 0
    ds_read_b128 a[192:195], v24 offset:51200
    v_fma_f32 v18, v42, s26, v14
    v_mfma_f32_16x16x32_bf16 v[36:39], a[184:187], a[4:7], v[36:39]
    v_exp_f32 v18, v18
    v_mfma_f32_16x16x32_bf16 v[36:39], a[180:183], a[8:11], v[36:39]
    v_fma_f32 v19, v43, s26, v14
    v_cvt_pk_bf16_f32 v218, v16, v17
    v_mfma_f32_16x16x32_bf16 v[36:39], a[176:179], a[12:15], v[36:39]
    v_exp_f32 v19, v19
    v_mfma_f32_16x16x32_bf16 v[36:39], a[172:175], a[16:19], v[36:39]
    ds_read_b128 a[196:199], v24 offset:51264
    v_fma_f32 v16, v32, s26, v15
    v_mfma_f32_16x16x32_bf16 v[36:39], a[232:235], a[20:23], v[36:39]
    s_add_u32 m0, s25, 118344
    v_exp_f32 v16, v16
    v_mfma_f32_16x16x32_bf16 v[36:39], a[228:231], a[24:27], v[36:39]
    s_waitcnt lgkmcnt(2)
    v_fma_f32 v17, v33, s26, v15
    v_cvt_pk_bf16_f32 v219, v18, v19
    v_mfma_f32_16x16x32_bf16 v[36:39], a[224:227], a[28:31], v[36:39]
    buffer_load_dwordx4 v5, s[16:19], s28 offen offset:3072 lds
    v_exp_f32 v17, v17
    v_mfma_f32_16x16x32_bf16 v[40:43], a[224:227], a[60:63], 0
    ds_read_b128 a[200:203], v24 offset:51328
    v_fma_f32 v18, v34, s26, v15
    v_mfma_f32_16x16x32_bf16 v[40:43], a[228:231], a[56:59], v[40:43]
    v_exp_f32 v18, v18
    v_mfma_f32_16x16x32_bf16 v[40:43], a[232:235], a[52:55], v[40:43]
    v_fma_f32 v19, v35, s26, v15
    v_cvt_pk_bf16_f32 v222, v16, v17
    v_mfma_f32_16x16x32_bf16 v[40:43], a[172:175], a[48:51], v[40:43]
    v_exp_f32 v19, v19
    v_mfma_f32_16x16x32_bf16 v[40:43], a[176:179], a[44:47], v[40:43]
    ds_read_b128 a[204:207], v24 offset:51392
    v_fma_f32 v16, v36, s26, v12
    v_mfma_f32_16x16x32_bf16 v[40:43], a[180:183], a[40:43], v[40:43]
    v_exp_f32 v16, v16
    v_mfma_f32_16x16x32_bf16 v[40:43], a[184:187], a[36:39], v[40:43]
    s_xor_b32 s28, s98, 128
    v_fma_f32 v17, v37, s26, v12
    v_cvt_pk_bf16_f32 v223, v18, v19
    v_mfma_f32_16x16x32_bf16 v[40:43], a[188:191], a[32:35], v[40:43]
    s_add_u32 m0, s25, 33792
    v_exp_f32 v17, v17
    v_mfma_f32_16x16x32_bf16 a[240:243], a[252:255], v[212:215], a[240:243]
    buffer_load_dwordx4 v5, s[16:19], s28 offen offset:0 lds
    v_mfma_f32_16x16x32_bf16 v[32:35], a[188:191], a[64:67], 0
    ds_read_b128 a[208:211], v24 offset:51456
    v_fma_f32 v18, v38, s26, v12
    v_mfma_f32_16x16x32_bf16 v[32:35], a[184:187], a[68:71], v[32:35]
    v_exp_f32 v18, v18
    v_mfma_f32_16x16x32_bf16 v[32:35], a[180:183], a[72:75], v[32:35]
    v_fma_f32 v19, v39, s26, v12
    v_cvt_pk_bf16_f32 v224, v16, v17
    v_mfma_f32_16x16x32_bf16 v[32:35], a[176:179], a[76:79], v[32:35]
    v_exp_f32 v19, v19
    v_mfma_f32_16x16x32_bf16 v[32:35], a[172:175], a[80:83], v[32:35]
    ds_read_b128 a[212:215], v24 offset:51520
    v_fma_f32 v16, v40, s26, v13
    v_mfma_f32_16x16x32_bf16 v[32:35], a[232:235], a[84:87], v[32:35]
    v_exp_f32 v16, v16
    v_mfma_f32_16x16x32_bf16 v[32:35], a[228:231], a[88:91], v[32:35]
    v_fma_f32 v17, v41, s26, v13
    v_cvt_pk_bf16_f32 v225, v18, v19
    v_mfma_f32_16x16x32_bf16 v[32:35], a[224:227], a[92:95], v[32:35]
    v_exp_f32 v17, v17
    v_mfma_f32_16x16x32_bf16 v[36:39], a[224:227], a[124:127], 0
    ds_read_b128 a[216:219], v24 offset:51584
    v_fma_f32 v18, v42, s26, v13
    v_mfma_f32_16x16x32_bf16 v[36:39], a[228:231], a[120:123], v[36:39]
L_pad5:
    s_cbranch_vccnz L_pad9
    v_exp_f32 v18, v18
    v_mfma_f32_16x16x32_bf16 v[36:39], a[232:235], a[116:119], v[36:39]
    v_fma_f32 v19, v43, s26, v13
    v_cvt_pk_bf16_f32 v228, v16, v17
    v_mfma_f32_16x16x32_bf16 v[36:39], a[172:175], a[112:115], v[36:39]
    v_exp_f32 v19, v19
    v_mfma_f32_16x16x32_bf16 v[36:39], a[176:179], a[108:111], v[36:39]
    ds_read_b128 a[220:223], v24 offset:51648
    v_fma_f32 v16, v32, s26, v14
    v_mfma_f32_16x16x32_bf16 v[36:39], a[180:183], a[104:107], v[36:39]
    v_exp_f32 v16, v16
    v_mfma_f32_16x16x32_bf16 v[36:39], a[184:187], a[100:103], v[36:39]
    v_fma_f32 v17, v33, s26, v14
    v_cvt_pk_bf16_f32 v229, v18, v19
    v_mfma_f32_16x16x32_bf16 v[36:39], a[188:191], a[96:99], v[36:39]
    s_add_u32 m0, s25, 33800
    v_exp_f32 v17, v17
    v_mfma_f32_16x16x32_bf16 a[244:247], a[252:255], v[216:219], a[244:247]
    s_waitcnt lgkmcnt(1)
    buffer_load_dwordx4 v5, s[16:19], s28 offen offset:1024 lds
    v_mfma_f32_16x16x32_bf16 v[40:43], a[192:195], a[0:3], 0
    ds_read_b128 a[224:227], v25 offset:0
    v_fma_f32 v18, v34, s26, v14
    v_mfma_f32_16x16x32_bf16 v[40:43], a[196:199], a[4:7], v[40:43]
    v_exp_f32 v18, v18
    v_mfma_f32_16x16x32_bf16 v[40:43], a[200:203], a[8:11], v[40:43]
    v_fma_f32 v19, v35, s26, v14
    v_cvt_pk_bf16_f32 v232, v16, v17
    v_mfma_f32_16x16x32_bf16 v[40:43], a[204:207], a[12:15], v[40:43]
    v_exp_f32 v19, v19
    v_mfma_f32_16x16x32_bf16 v[40:43], a[208:211], a[16:19], v[40:43]
    ds_read_b128 a[228:231], v25 offset:64
    v_fma_f32 v16, v36, s26, v15
    v_mfma_f32_16x16x32_bf16 v[40:43], a[212:215], a[20:23], v[40:43]
    v_exp_f32 v16, v16
    v_mfma_f32_16x16x32_bf16 v[40:43], a[216:219], a[24:27], v[40:43]
    s_waitcnt lgkmcnt(2)
    v_fma_f32 v17, v37, s26, v15
    v_cvt_pk_bf16_f32 v233, v18, v19
    v_mfma_f32_16x16x32_bf16 v[40:43], a[220:223], a[28:31], v[40:43]
    v_exp_f32 v17, v17
    v_mfma_f32_16x16x32_bf16 v[32:35], a[220:223], a[60:63], 0
    ds_read_b128 a[232:235], v25 offset:128
    v_fma_f32 v18, v38, s26, v15
    v_mfma_f32_16x16x32_bf16 v[32:35], a[216:219], a[56:59], v[32:35]
    v_exp_f32 v18, v18
    v_mfma_f32_16x16x32_bf16 v[32:35], a[212:215], a[52:55], v[32:35]
    v_fma_f32 v19, v39, s26, v15
    v_cvt_pk_bf16_f32 v236, v16, v17
    v_mfma_f32_16x16x32_bf16 v[32:35], a[208:211], a[48:51], v[32:35]
    v_exp_f32 v19, v19
    v_mfma_f32_16x16x32_bf16 v[32:35], a[204:207], a[44:47], v[32:35]
    ds_read_b128 a[172:175], v25 offset:192
    v_fma_f32 v16, v40, s26, v12
    v_mfma_f32_16x16x32_bf16 v[32:35], a[200:203], a[40:43], v[32:35]
    v_exp_f32 v16, v16
    v_mfma_f32_16x16x32_bf16 v[32:35], a[196:199], a[36:39], v[32:35]
    v_fma_f32 v17, v41, s26, v12
    v_cvt_pk_bf16_f32 v237, v18, v19
    v_mfma_f32_16x16x32_bf16 v[32:35], a[192:195], a[32:35], v[32:35]
    s_add_u32 m0, s25, 33856
    v_exp_f32 v17, v17
    v_mfma_f32_16x16x32_bf16 a[248:251], a[252:255], v[220:223], a[248:251]
    buffer_load_dwordx4 v5, s[16:19], s28 offen offset:2048 lds
    v_mfma_f32_16x16x32_bf16 v[36:39], a[192:195], a[64:67], 0
    ds_read_b128 a[176:179], v25 offset:256
    v_fma_f32 v18, v42, s26, v12
    v_mfma_f32_16x16x32_bf16 v[36:39], a[196:199], a[68:71], v[36:39]
    v_exp_f32 v18, v18
    v_mfma_f32_16x16x32_bf16 v[36:39], a[200:203], a[72:75], v[36:39]
    v_fma_f32 v19, v43, s26, v12
    v_cvt_pk_bf16_f32 v226, v16, v17
    v_mfma_f32_16x16x32_bf16 v[36:39], a[204:207], a[76:79], v[36:39]
    v_exp_f32 v19, v19
    v_mfma_f32_16x16x32_bf16 v[36:39], a[208:211], a[80:83], v[36:39]
    ds_read_b128 a[180:183], v25 offset:320
    v_fma_f32 v16, v32, s26, v13
    v_mfma_f32_16x16x32_bf16 v[36:39], a[212:215], a[84:87], v[36:39]
    v_exp_f32 v16, v16
    v_mfma_f32_16x16x32_bf16 v[36:39], a[216:219], a[88:91], v[36:39]
    v_fma_f32 v17, v33, s26, v13
    v_cvt_pk_bf16_f32 v227, v18, v19
    v_mfma_f32_16x16x32_bf16 v[36:39], a[220:223], a[92:95], v[36:39]
    v_exp_f32 v17, v17
    v_mfma_f32_16x16x32_bf16 v[40:43], a[220:223], a[124:127], 0
    ds_read_b128 a[184:187], v25 offset:384
    v_fma_f32 v18, v34, s26, v13
    v_mfma_f32_16x16x32_bf16 v[40:43], a[216:219], a[120:123], v[40:43]
    v_exp_f32 v18, v18
    v_mfma_f32_16x16x32_bf16 v[40:43], a[212:215], a[116:119], v[40:43]
    v_fma_f32 v19, v35, s26, v13
    v_cvt_pk_bf16_f32 v230, v16, v17
    v_mfma_f32_16x16x32_bf16 v[40:43], a[208:211], a[112:115], v[40:43]
    v_exp_f32 v19, v19
    v_mfma_f32_16x16x32_bf16 v[40:43], a[204:207], a[108:111], v[40:43]
    ds_read_b128 a[188:191], v25 offset:448
    v_fma_f32 v16, v36, s26, v14
    v_mfma_f32_16x16x32_bf16 v[40:43], a[200:203], a[104:107], v[40:43]
    v_exp_f32 v16, v16
    v_mfma_f32_16x16x32_bf16 v[40:43], a[196:199], a[100:103], v[40:43]
    v_fma_f32 v17, v37, s26, v14
    v_cvt_pk_bf16_f32 v231, v18, v19
    v_mfma_f32_16x16x32_bf16 v[40:43], a[192:195], a[96:99], v[40:43]
    s_add_u32 m0, s25, 33864
    v_exp_f32 v17, v17
    v_mfma_f32_16x16x32_bf16 a[236:239], a[252:255], v[224:227], a[236:239]
    s_waitcnt lgkmcnt(1)
    buffer_load_dwordx4 v5, s[16:19], s28 offen offset:3072 lds
    v_mfma_f32_16x16x32_bf16 v[32:35], a[224:227], a[0:3], 0
    ds_read_b128 a[220:223], v25 offset:512
    v_fma_f32 v18, v38, s26, v14
    v_mfma_f32_16x16x32_bf16 v[32:35], a[228:231], a[4:7], v[32:35]
    v_exp_f32 v18, v18
    v_mfma_f32_16x16x32_bf16 v[32:35], a[232:235], a[8:11], v[32:35]
    v_fma_f32 v19, v39, s26, v14
    v_cvt_pk_bf16_f32 v234, v16, v17
    v_mfma_f32_16x16x32_bf16 v[32:35], a[172:175], a[12:15], v[32:35]
    v_exp_f32 v19, v19
    v_mfma_f32_16x16x32_bf16 v[32:35], a[176:179], a[16:19], v[32:35]
    ds_read_b128 a[216:219], v25 offset:576
    v_fma_f32 v16, v40, s26, v15
    v_mfma_f32_16x16x32_bf16 v[32:35], a[180:183], a[20:23], v[32:35]
    s_xor_b32 s28, s98, 65664
    v_exp_f32 v16, v16
    v_mfma_f32_16x16x32_bf16 v[32:35], a[184:187], a[24:27], v[32:35]
    s_waitcnt lgkmcnt(2)
    v_fma_f32 v17, v41, s26, v15
    v_cvt_pk_bf16_f32 v235, v18, v19
    v_mfma_f32_16x16x32_bf16 v[32:35], a[188:191], a[28:31], v[32:35]
    s_add_u32 m0, s25, 135168
    v_exp_f32 v17, v17
    v_mfma_f32_16x16x32_bf16 a[240:243], a[252:255], v[228:231], a[240:243]
    buffer_load_dwordx4 v5, s[16:19], s28 offen offset:0 lds
    v_mfma_f32_16x16x32_bf16 v[36:39], a[188:191], a[60:63], 0
    ds_read_b128 a[212:215], v25 offset:640
    v_fma_f32 v18, v42, s26, v15
    v_mfma_f32_16x16x32_bf16 v[36:39], a[184:187], a[56:59], v[36:39]
    v_exp_f32 v18, v18
    v_mfma_f32_16x16x32_bf16 v[36:39], a[180:183], a[52:55], v[36:39]
    v_fma_f32 v19, v43, s26, v15
    v_cvt_pk_bf16_f32 v238, v16, v17
    v_mfma_f32_16x16x32_bf16 v[36:39], a[176:179], a[48:51], v[36:39]
    v_exp_f32 v19, v19
    v_mfma_f32_16x16x32_bf16 v[36:39], a[172:175], a[44:47], v[36:39]
    ds_read_b128 a[208:211], v25 offset:704
    v_fma_f32 v16, v32, s26, v12
    v_mfma_f32_16x16x32_bf16 v[36:39], a[232:235], a[40:43], v[36:39]
    v_exp_f32 v16, v16
    v_mfma_f32_16x16x32_bf16 v[36:39], a[228:231], a[36:39], v[36:39]
    v_fma_f32 v17, v33, s26, v12
    v_cvt_pk_bf16_f32 v239, v18, v19
    v_mfma_f32_16x16x32_bf16 v[36:39], a[224:227], a[32:35], v[36:39]
    s_add_u32 m0, s25, 135176
    v_exp_f32 v17, v17
    v_mfma_f32_16x16x32_bf16 a[244:247], a[252:255], v[232:235], a[244:247]
    buffer_load_dwordx4 v5, s[16:19], s28 offen offset:1024 lds
    v_mfma_f32_16x16x32_bf16 v[40:43], a[224:227], a[64:67], 0
    ds_read_b128 a[204:207], v25 offset:768
    v_fma_f32 v18, v34, s26, v12
    v_mfma_f32_16x16x32_bf16 v[40:43], a[228:231], a[68:71], v[40:43]
    v_exp_f32 v18, v18
    v_mfma_f32_16x16x32_bf16 v[40:43], a[232:235], a[72:75], v[40:43]
    v_fma_f32 v19, v35, s26, v12
    v_cvt_pk_bf16_f32 v240, v16, v17
    v_mfma_f32_16x16x32_bf16 v[40:43], a[172:175], a[76:79], v[40:43]
    v_exp_f32 v19, v19
    v_mfma_f32_16x16x32_bf16 v[40:43], a[176:179], a[80:83], v[40:43]
    ds_read_b128 a[200:203], v25 offset:832
    v_fma_f32 v16, v36, s26, v13
    v_mfma_f32_16x16x32_bf16 v[40:43], a[180:183], a[84:87], v[40:43]
    v_exp_f32 v16, v16
    v_mfma_f32_16x16x32_bf16 v[40:43], a[184:187], a[88:91], v[40:43]
    v_fma_f32 v17, v37, s26, v13
    v_cvt_pk_bf16_f32 v241, v18, v19
    v_mfma_f32_16x16x32_bf16 v[40:43], a[188:191], a[92:95], v[40:43]
    s_add_u32 m0, s25, 135232
    v_exp_f32 v17, v17
    v_mfma_f32_16x16x32_bf16 a[248:251], a[252:255], v[236:239], a[248:251]
    buffer_load_dwordx4 v5, s[16:19], s28 offen offset:2048 lds
    v_mfma_f32_16x16x32_bf16 v[32:35], a[188:191], a[124:127], 0
    ds_read_b128 a[196:199], v25 offset:896
    v_fma_f32 v18, v38, s26, v13
    v_mfma_f32_16x16x32_bf16 v[32:35], a[184:187], a[120:123], v[32:35]
    v_exp_f32 v18, v18
    v_mfma_f32_16x16x32_bf16 v[32:35], a[180:183], a[116:119], v[32:35]
    v_fma_f32 v19, v39, s26, v13
    v_cvt_pk_bf16_f32 v244, v16, v17
    v_mfma_f32_16x16x32_bf16 v[32:35], a[176:179], a[112:115], v[32:35]
    v_exp_f32 v19, v19
    v_mfma_f32_16x16x32_bf16 v[32:35], a[172:175], a[108:111], v[32:35]
    ds_read_b128 a[192:195], v25 offset:960
    v_fma_f32 v16, v40, s26, v14
    v_mfma_f32_16x16x32_bf16 v[32:35], a[232:235], a[104:107], v[32:35]
    v_exp_f32 v16, v16
    v_mfma_f32_16x16x32_bf16 v[32:35], a[228:231], a[100:103], v[32:35]
    v_fma_f32 v17, v41, s26, v14
    v_cvt_pk_bf16_f32 v245, v18, v19
    v_mfma_f32_16x16x32_bf16 v[32:35], a[224:227], a[96:99], v[32:35]
    s_waitcnt lgkmcnt(2)
    v_exp_f32 v17, v17
    v_fma_f32 v18, v42, s26, v14
    v_mfma_f32_16x16x32_bf16 v[36:39], a[220:223], a[0:3], 0
    v_exp_f32 v18, v18
    v_mfma_f32_16x16x32_bf16 v[36:39], a[216:219], a[4:7], v[36:39]
    v_fma_f32 v19, v43, s26, v14
    v_cvt_pk_bf16_f32 v248, v16, v17
    v_mfma_f32_16x16x32_bf16 v[36:39], a[212:215], a[8:11], v[36:39]
    v_exp_f32 v19, v19
    v_mfma_f32_16x16x32_bf16 v[36:39], a[208:211], a[12:15], v[36:39]
    v_fma_f32 v16, v32, s26, v15
    v_mfma_f32_16x16x32_bf16 v[36:39], a[204:207], a[16:19], v[36:39]
    s_waitcnt vmcnt(7) lgkmcnt(0)
    v_exp_f32 v16, v16
    v_mfma_f32_16x16x32_bf16 v[36:39], a[200:203], a[20:23], v[36:39]
    s_barrier
    ds_read_b64_tr_b16 a[188:189], v2 offset:16896
    v_fma_f32 v17, v33, s26, v15
    v_mfma_f32_16x16x32_bf16 v[36:39], a[196:199], a[24:27], v[36:39]
    ds_read_b64_tr_b16 a[190:191], v2 offset:17408
    v_cvt_pk_bf16_f32 v249, v18, v19
    v_mfma_f32_16x16x32_bf16 v[36:39], a[192:195], a[28:31], v[36:39]
    ds_read_b64_tr_b16 a[184:185], v2 offset:21120
    v_exp_f32 v17, v17
    v_fma_f32 v18, v34, s26, v15
    v_exp_f32 v18, v18
    v_mfma_f32_16x16x32_bf16 v[40:43], a[192:195], a[60:63], 0
    ds_read_b64_tr_b16 a[186:187], v2 offset:21632
    v_fma_f32 v19, v35, s26, v15
    v_mfma_f32_16x16x32_bf16 v[40:43], a[196:199], a[56:59], v[40:43]
    ds_read_b64_tr_b16 a[180:181], v2 offset:25344
    v_cvt_pk_bf16_f32 v252, v16, v17
    v_mfma_f32_16x16x32_bf16 v[40:43], a[200:203], a[52:55], v[40:43]
    ds_read_b64_tr_b16 a[182:183], v2 offset:25856
    v_exp_f32 v19, v19
    v_mfma_f32_16x16x32_bf16 v[40:43], a[204:207], a[48:51], v[40:43]
    ds_read_b64_tr_b16 a[176:177], v2 offset:29568
    v_fma_f32 v16, v36, s26, v12
    v_mfma_f32_16x16x32_bf16 v[40:43], a[208:211], a[44:47], v[40:43]
    ds_read_b64_tr_b16 a[178:179], v2 offset:30080
    v_exp_f32 v16, v16
    v_mfma_f32_16x16x32_bf16 v[40:43], a[212:215], a[40:43], v[40:43]
    ds_read_b64_tr_b16 a[172:173], v2 offset:33792
    v_fma_f32 v17, v37, s26, v12
    v_mfma_f32_16x16x32_bf16 v[40:43], a[216:219], a[36:39], v[40:43]
    ds_read_b64_tr_b16 a[174:175], v2 offset:34304
    v_cvt_pk_bf16_f32 v253, v18, v19
    v_mfma_f32_16x16x32_bf16 v[40:43], a[220:223], a[32:35], v[40:43]
    ds_read_b64_tr_b16 a[232:233], v2 offset:38016
    v_exp_f32 v17, v17
    v_mfma_f32_16x16x32_bf16 v[32:35], a[220:223], a[64:67], 0
    ds_read_b64_tr_b16 a[234:235], v2 offset:38528
    v_fma_f32 v18, v38, s26, v12
    v_mfma_f32_16x16x32_bf16 v[32:35], a[216:219], a[68:71], v[32:35]
    ds_read_b64_tr_b16 a[228:229], v2 offset:42240
    v_exp_f32 v18, v18
    v_mfma_f32_16x16x32_bf16 v[32:35], a[212:215], a[72:75], v[32:35]
    ds_read_b64_tr_b16 a[230:231], v2 offset:42752
    v_fma_f32 v19, v39, s26, v12
    v_mfma_f32_16x16x32_bf16 v[32:35], a[208:211], a[76:79], v[32:35]
    ds_read_b64_tr_b16 a[224:225], v2 offset:46464
    v_cvt_pk_bf16_f32 v242, v16, v17
    v_mfma_f32_16x16x32_bf16 v[32:35], a[204:207], a[80:83], v[32:35]
    ds_read_b64_tr_b16 a[226:227], v2 offset:46976
    v_exp_f32 v19, v19
    v_mfma_f32_16x16x32_bf16 v[32:35], a[200:203], a[84:87], v[32:35]
    ds_read_b64_tr_b16 a[0:1], v1 offset:0
    v_fma_f32 v16, v40, s26, v13
    v_mfma_f32_16x16x32_bf16 v[32:35], a[196:199], a[88:91], v[32:35]
    ds_read_b64_tr_b16 a[2:3], v1 offset:512
    v_mfma_f32_16x16x32_bf16 v[32:35], a[192:195], a[92:95], v[32:35]
    ds_read_b64_tr_b16 a[4:5], v1 offset:4224
    v_exp_f32 v16, v16
    v_mfma_f32_16x16x32_bf16 v[36:39], a[192:195], a[124:127], 0
    ds_read_b64_tr_b16 a[6:7], v1 offset:4736
    v_fma_f32 v17, v41, s26, v13
    v_mfma_f32_16x16x32_bf16 v[36:39], a[196:199], a[120:123], v[36:39]
    ds_read_b64_tr_b16 a[8:9], v1 offset:8448
    v_cvt_pk_bf16_f32 v243, v18, v19
    v_mfma_f32_16x16x32_bf16 v[36:39], a[200:203], a[116:119], v[36:39]
    ds_read_b64_tr_b16 a[10:11], v1 offset:8960
    v_exp_f32 v17, v17
    v_mfma_f32_16x16x32_bf16 v[36:39], a[204:207], a[112:115], v[36:39]
    ds_read_b64_tr_b16 a[12:13], v1 offset:12672
    v_fma_f32 v18, v42, s26, v13
    v_mfma_f32_16x16x32_bf16 v[36:39], a[208:211], a[108:111], v[36:39]
    ds_read_b64_tr_b16 a[14:15], v1 offset:13184
    v_exp_f32 v18, v18
    v_mfma_f32_16x16x32_bf16 v[36:39], a[212:215], a[104:107], v[36:39]
    ds_read_b64_tr_b16 a[16:17], v2 offset:50688
    v_fma_f32 v19, v43, s26, v13
    v_mfma_f32_16x16x32_bf16 v[36:39], a[216:219], a[100:103], v[36:39]
    ds_read_b64_tr_b16 a[18:19], v2 offset:51200
    v_cvt_pk_bf16_f32 v246, v16, v17
    v_mfma_f32_16x16x32_bf16 v[36:39], a[220:223], a[96:99], v[36:39]
    s_add_u32 m0, s25, 135240
    ds_read_b64_tr_b16 a[20:21], v2 offset:54912
    v_exp_f32 v19, v19
    v_mfma_f32_16x16x32_bf16 a[236:239], a[252:255], v[240:243], a[236:239]
    s_waitcnt lgkmcnt(7)
    buffer_load_dwordx4 v5, s[16:19], s28 offen offset:3072 lds
    v_mfma_f32_16x16x32_bf16 v[40:43], a[188:191], a[128:131], 0
    ds_read_b64_tr_b16 a[22:23], v2 offset:55424
    v_fma_f32 v16, v32, s26, v14
    v_mfma_f32_16x16x32_bf16 v[40:43], a[184:187], a[132:135], v[40:43]
    ds_read_b64_tr_b16 a[24:25], v2 offset:59136
    v_exp_f32 v16, v16
    v_mfma_f32_16x16x32_bf16 v[40:43], a[180:183], a[136:139], v[40:43]
    ds_read_b64_tr_b16 a[26:27], v2 offset:59648
    v_fma_f32 v17, v33, s26, v14
    v_mfma_f32_16x16x32_bf16 v[40:43], a[176:179], a[140:143], v[40:43]
    ds_read_b64_tr_b16 a[28:29], v2 offset:63360
    v_cvt_pk_bf16_f32 v247, v18, v19
    v_mfma_f32_16x16x32_bf16 v[40:43], a[172:175], v[48:51], v[40:43]
    ds_read_b64_tr_b16 a[30:31], v2 offset:63872
    v_mfma_f32_16x16x32_bf16 v[40:43], a[232:235], v[80:83], v[40:43]
    v_exp_f32 v17, v17
    v_mfma_f32_16x16x32_bf16 v[40:43], a[228:231], v[96:99], v[40:43]
    ds_read_b64_tr_b16 a[60:61], v2 offset:16904
    v_fma_f32 v18, v34, s26, v14
    v_mfma_f32_16x16x32_bf16 v[40:43], a[224:227], v[112:115], v[40:43]
    v_exp_f32 v18, v18
    v_mfma_f32_16x16x32_bf16 a[240:243], a[252:255], v[244:247], a[240:243]
    v_fma_f32 v19, v35, s26, v14
    v_cvt_pk_bf16_f32 v250, v16, v17
    v_mfma_f32_16x16x32_bf16 v[40:43], a[0:3], v[128:131], v[40:43]
    ds_read_b64_tr_b16 a[62:63], v2 offset:17416
    v_mfma_f32_16x16x32_bf16 v[40:43], a[4:7], v[144:147], v[40:43]
    s_waitcnt lgkmcnt(4)
    v_exp_f32 v19, v19
    v_mfma_f32_16x16x32_bf16 v[40:43], a[8:11], v[160:163], v[40:43]
    ds_read_b64_tr_b16 a[56:57], v2 offset:21128
    v_fma_f32 v16, v36, s26, v15
    v_mfma_f32_16x16x32_bf16 v[40:43], a[12:15], v[176:179], v[40:43]
    s_xor_b32 s28, s98, 131200
    v_exp_f32 v16, v16
    v_mfma_f32_16x16x32_bf16 v[40:43], a[16:19], v[192:195], v[40:43]
    s_add_u32 m0, s25, 16896
    ds_read_b64_tr_b16 a[58:59], v2 offset:21640
    v_fma_f32 v17, v37, s26, v15
    v_mfma_f32_16x16x32_bf16 v[40:43], a[20:23], v[208:211], v[40:43]
    buffer_load_dwordx4 v5, s[16:19], s28 offen offset:0 lds
    v_mfma_f32_16x16x32_bf16 v[40:43], a[24:27], v[224:227], v[40:43]
    s_waitcnt lgkmcnt(3)
    ds_read_b64_tr_b16 a[52:53], v2 offset:25352
    v_cvt_pk_bf16_f32 v251, v18, v19
    v_mfma_f32_16x16x32_bf16 v[40:43], a[28:31], v[240:243], v[40:43]
    v_exp_f32 v17, v17
    v_mfma_f32_16x16x32_bf16 a[244:247], a[252:255], v[248:251], a[244:247]
    v_fma_f32 v18, v38, s26, v15
    v_mfma_f32_16x16x32_bf16 v[32:35], a[188:191], a[144:147], 0
    ds_read_b64_tr_b16 a[54:55], v2 offset:25864
    v_mfma_f32_16x16x32_bf16 v[32:35], a[184:187], a[148:151], v[32:35]
    v_exp_f32 v18, v18
    v_mfma_f32_16x16x32_bf16 v[32:35], a[180:183], a[152:155], v[32:35]
    s_add_u32 m0, s25, 16904
    ds_read_b64_tr_b16 a[48:49], v2 offset:29576
    v_fma_f32 v19, v39, s26, v15
    v_mfma_f32_16x16x32_bf16 v[32:35], a[176:179], a[156:159], v[32:35]
    buffer_load_dwordx4 v5, s[16:19], s28 offen offset:1024 lds
    v_mfma_f32_16x16x32_bf16 v[32:35], a[172:175], v[52:55], v[32:35]
    ds_read_b64_tr_b16 a[50:51], v2 offset:30088
    v_cvt_pk_bf16_f32 v254, v16, v17
    v_mfma_f32_16x16x32_bf16 v[32:35], a[232:235], v[84:87], v[32:35]
    v_exp_f32 v19, v19
    v_mfma_f32_16x16x32_bf16 v[32:35], a[228:231], v[100:103], v[32:35]
    ds_read_b64_tr_b16 a[44:45], v2 offset:33800
    v_cvt_pk_bf16_f32 v255, v18, v19
    v_mfma_f32_16x16x32_bf16 v[32:35], a[224:227], v[116:119], v[32:35]
    v_accvgpr_read_b32 v24, a236
    v_mfma_f32_16x16x32_bf16 a[248:251], a[252:255], v[252:255], a[248:251]
    v_rcp_f32 v24, v24
    v_mfma_f32_16x16x32_bf16 v[32:35], a[0:3], v[132:135], v[32:35]
    s_add_u32 m0, s25, 16960
    ds_read_b64_tr_b16 a[46:47], v2 offset:34312
    v_mul_f32 v40, v24, v40
    v_mfma_f32_16x16x32_bf16 v[32:35], a[4:7], v[148:151], v[32:35]
    buffer_load_dwordx4 v5, s[16:19], s28 offen offset:2048 lds
    v_mfma_f32_16x16x32_bf16 v[32:35], a[8:11], v[164:167], v[32:35]
    ds_read_b64_tr_b16 a[40:41], v2 offset:38024
    v_mul_f32 v41, v24, v41
    v_mfma_f32_16x16x32_bf16 v[32:35], a[12:15], v[180:183], v[32:35]
    v_mul_f32 v42, v24, v42
    v_mul_f32 v43, v24, v43
    v_mfma_f32_16x16x32_bf16 v[32:35], a[16:19], v[196:199], v[32:35]
    ds_read_b64_tr_b16 a[42:43], v2 offset:38536
    v_cvt_pk_bf16_f32 v28, v40, v41
    v_mfma_f32_16x16x32_bf16 v[32:35], a[20:23], v[212:215], v[32:35]
    v_cvt_pk_bf16_f32 v29, v42, v43
    v_accvgpr_read_b32 v25, a240
    v_mfma_f32_16x16x32_bf16 v[32:35], a[24:27], v[228:231], v[32:35]
    ds_read_b64_tr_b16 a[36:37], v2 offset:42248
    v_mfma_f32_16x16x32_bf16 v[32:35], a[28:31], v[244:247], v[32:35]
    v_rcp_f32 v25, v25
    v_mfma_f32_16x16x32_bf16 v[36:39], a[188:191], a[160:163], 0
    ds_read_b64_tr_b16 a[38:39], v2 offset:42760
    v_mfma_f32_16x16x32_bf16 v[36:39], a[184:187], a[164:167], v[36:39]
    v_mfma_f32_16x16x32_bf16 v[36:39], a[180:183], a[168:171], v[36:39]
    ds_read_b64_tr_b16 a[32:33], v2 offset:46472
    v_mfma_f32_16x16x32_bf16 v[36:39], a[176:179], v[44:47], v[36:39]
    v_mfma_f32_16x16x32_bf16 v[36:39], a[172:175], v[56:59], v[36:39]
    ds_read_b64_tr_b16 a[34:35], v2 offset:46984
    v_mfma_f32_16x16x32_bf16 v[36:39], a[232:235], v[88:91], v[36:39]
    v_mul_f32 v32, v25, v32
    v_mul_f32 v33, v25, v33
    v_mfma_f32_16x16x32_bf16 v[36:39], a[228:231], v[104:107], v[36:39]
    ds_read_b64_tr_b16 a[64:65], v1 offset:8
    v_mul_f32 v34, v25, v34
    v_mfma_f32_16x16x32_bf16 v[36:39], a[224:227], v[120:123], v[36:39]
    v_mul_f32 v35, v25, v35
    v_cvt_pk_bf16_f32 v20, v32, v33
    v_mfma_f32_16x16x32_bf16 v[36:39], a[0:3], v[136:139], v[36:39]
    ds_read_b64_tr_b16 a[66:67], v1 offset:520
    v_cvt_pk_bf16_f32 v21, v34, v35
    v_mfma_f32_16x16x32_bf16 v[36:39], a[4:7], v[152:155], v[36:39]
    v_accvgpr_read_b32 v26, a244
    v_mfma_f32_16x16x32_bf16 v[36:39], a[8:11], v[168:171], v[36:39]
    ds_read_b64_tr_b16 a[68:69], v1 offset:4232
    v_mfma_f32_16x16x32_bf16 v[36:39], a[12:15], v[184:187], v[36:39]
    v_rcp_f32 v26, v26
    v_mfma_f32_16x16x32_bf16 v[36:39], a[16:19], v[200:203], v[36:39]
    s_add_u32 m0, s25, 16968
    ds_read_b64_tr_b16 a[70:71], v1 offset:4744
    v_mfma_f32_16x16x32_bf16 v[36:39], a[20:23], v[216:219], v[36:39]
    buffer_load_dwordx4 v5, s[16:19], s28 offen offset:3072 lds
    v_mfma_f32_16x16x32_bf16 v[36:39], a[24:27], v[232:235], v[36:39]
    ds_read_b64_tr_b16 a[72:73], v1 offset:8456
    v_mfma_f32_16x16x32_bf16 v[36:39], a[28:31], v[248:251], v[36:39]
    v_mfma_f32_16x16x32_bf16 v[40:43], a[188:191], v[60:63], 0
    ds_read_b64_tr_b16 a[74:75], v1 offset:8968
    v_mfma_f32_16x16x32_bf16 v[40:43], a[184:187], v[64:67], v[40:43]
    s_xor_b32 s28, s98, 196736
    v_mfma_f32_16x16x32_bf16 v[40:43], a[180:183], v[68:71], v[40:43]
    s_add_u32 m0, s25, 50688
    ds_read_b64_tr_b16 a[76:77], v1 offset:12680
    v_mfma_f32_16x16x32_bf16 v[40:43], a[176:179], v[72:75], v[40:43]
    buffer_load_dwordx4 v5, s[16:19], s28 offen offset:0 lds
    v_mfma_f32_16x16x32_bf16 v[40:43], a[172:175], v[76:79], v[40:43]
    ds_read_b64_tr_b16 a[78:79], v1 offset:13192
    v_mfma_f32_16x16x32_bf16 v[40:43], a[232:235], v[92:95], v[40:43]
    v_mul_f32 v36, v26, v36
    v_mul_f32 v37, v26, v37
    v_mfma_f32_16x16x32_bf16 v[40:43], a[228:231], v[108:111], v[40:43]
    ds_read_b64_tr_b16 a[80:81], v2 offset:50696
    v_mul_f32 v38, v26, v38
    v_mfma_f32_16x16x32_bf16 v[40:43], a[224:227], v[124:127], v[40:43]
    v_mul_f32 v39, v26, v39
    v_cvt_pk_bf16_f32 v16, v36, v37
    v_mfma_f32_16x16x32_bf16 v[40:43], a[0:3], v[140:143], v[40:43]
    s_add_u32 m0, s25, 50696
    ds_read_b64_tr_b16 a[82:83], v2 offset:51208
    v_cvt_pk_bf16_f32 v17, v38, v39
    v_mfma_f32_16x16x32_bf16 v[40:43], a[4:7], v[156:159], v[40:43]
    buffer_load_dwordx4 v5, s[16:19], s28 offen offset:1024 lds
    v_mfma_f32_16x16x32_bf16 v[40:43], a[8:11], v[172:175], v[40:43]
    ds_read_b64_tr_b16 a[84:85], v2 offset:54920
    v_accvgpr_read_b32 v27, a248
    v_mfma_f32_16x16x32_bf16 v[40:43], a[12:15], v[188:191], v[40:43]
    v_rcp_f32 v27, v27
    v_mfma_f32_16x16x32_bf16 v[40:43], a[16:19], v[204:207], v[40:43]
    ds_read_b64_tr_b16 a[86:87], v2 offset:55432
    v_mfma_f32_16x16x32_bf16 v[40:43], a[20:23], v[220:223], v[40:43]
    v_mfma_f32_16x16x32_bf16 v[40:43], a[24:27], v[236:239], v[40:43]
    ds_read_b64_tr_b16 a[88:89], v2 offset:59144
    v_mfma_f32_16x16x32_bf16 v[40:43], a[28:31], v[252:255], v[40:43]
    s_waitcnt lgkmcnt(4)
    v_mfma_f32_16x16x32_bf16 v[32:35], a[60:63], a[128:131], 0
    ds_read_b64_tr_b16 a[90:91], v2 offset:59656
    v_mfma_f32_16x16x32_bf16 v[32:35], a[56:59], a[132:135], v[32:35]
    v_min3_f32 v10, v24, v25, v26
    v_mfma_f32_16x16x32_bf16 v[32:35], a[52:55], a[136:139], v[32:35]
    ds_read_b64_tr_b16 a[92:93], v2 offset:63368
    v_mfma_f32_16x16x32_bf16 v[32:35], a[48:51], a[140:143], v[32:35]
    v_min_f32 v10, v10, v27
    v_mfma_f32_16x16x32_bf16 v[32:35], a[44:47], v[48:51], v[32:35]
    ds_read_b64_tr_b16 a[94:95], v2 offset:63880
    v_mfma_f32_16x16x32_bf16 v[32:35], a[40:43], v[80:83], v[32:35]
    v_cmp_gt_f32_e64 s[94:95], s31, v10
    v_mul_f32 v40, v27, v40
    v_mfma_f32_16x16x32_bf16 v[32:35], a[36:39], v[96:99], v[32:35]
    ds_read_b64_tr_b16 a[192:193], v2 offset:16960
    v_mul_f32 v41, v27, v41
    v_mfma_f32_16x16x32_bf16 v[32:35], a[32:35], v[112:115], v[32:35]
    v_mul_f32 v42, v27, v42
    v_mul_f32 v43, v27, v43
    v_mfma_f32_16x16x32_bf16 v[32:35], a[64:67], v[128:131], v[32:35]
    ds_read_b64_tr_b16 a[194:195], v2 offset:17472
    v_cvt_pk_bf16_f32 v12, v40, v41
    v_mfma_f32_16x16x32_bf16 v[32:35], a[68:71], v[144:147], v[32:35]
    s_or_b32 s38, s94, s95
    v_cvt_pk_bf16_f32 v13, v42, v43
    v_mfma_f32_16x16x32_bf16 v[32:35], a[72:75], v[160:163], v[32:35]
    ds_read_b64_tr_b16 a[124:125], v2 offset:21184
    v_mfma_f32_16x16x32_bf16 v[32:35], a[76:79], v[176:179], v[32:35]
    s_waitcnt lgkmcnt(4)
    v_mov_b32 v10, s38
    v_mfma_f32_16x16x32_bf16 v[32:35], a[80:83], v[192:195], v[32:35]
    ds_read_b64_tr_b16 a[126:127], v2 offset:21696
    v_mfma_f32_16x16x32_bf16 v[32:35], a[84:87], v[208:211], v[32:35]
    ds_write_b32 v9, v10 offset:0
    v_mfma_f32_16x16x32_bf16 v[32:35], a[88:91], v[224:227], v[32:35]
    s_waitcnt lgkmcnt(4)
    ds_read_b64_tr_b16 a[196:197], v2 offset:25408
    v_mfma_f32_16x16x32_bf16 v[32:35], a[92:95], v[240:243], v[32:35]
    v_lshlrev_b32 v10, 2, v0
    v_mfma_f32_16x16x32_bf16 v[36:39], a[92:95], v[244:247], 0
    ds_read_b64_tr_b16 a[198:199], v2 offset:25920
    v_mfma_f32_16x16x32_bf16 v[36:39], a[88:91], v[228:231], v[36:39]
    v_and_b32 v10, 12, v10
    v_mfma_f32_16x16x32_bf16 v[36:39], a[84:87], v[212:215], v[36:39]
    s_add_u32 m0, s25, 50752
    ds_read_b64_tr_b16 a[120:121], v2 offset:29632
    v_mfma_f32_16x16x32_bf16 v[36:39], a[80:83], v[196:199], v[36:39]
    buffer_load_dwordx4 v5, s[16:19], s28 offen offset:2048 lds
    v_mfma_f32_16x16x32_bf16 v[36:39], a[76:79], v[180:183], v[36:39]
    ds_read_b64_tr_b16 a[122:123], v2 offset:30144
    v_mfma_f32_16x16x32_bf16 v[36:39], a[72:75], v[164:167], v[36:39]
    v_add_u32 v10, 152064, v10
    v_mul_f32 v32, v24, v32
    v_mfma_f32_16x16x32_bf16 v[36:39], a[68:71], v[148:151], v[36:39]
    ds_read_b64_tr_b16 a[200:201], v2 offset:33856
    v_mul_f32 v33, v24, v33
    v_mfma_f32_16x16x32_bf16 v[36:39], a[64:67], v[132:135], v[36:39]
    v_mul_f32 v34, v24, v34
    v_mul_f32 v35, v24, v35
    v_mfma_f32_16x16x32_bf16 v[36:39], a[32:35], v[116:119], v[36:39]
    s_add_u32 m0, s25, 50760
    ds_read_b64_tr_b16 a[202:203], v2 offset:34368
    v_cvt_pk_bf16_f32 v30, v32, v33
    v_mfma_f32_16x16x32_bf16 v[36:39], a[36:39], v[100:103], v[36:39]
    buffer_load_dwordx4 v5, s[16:19], s28 offen offset:3072 lds
    v_mfma_f32_16x16x32_bf16 v[36:39], a[40:43], v[84:87], v[36:39]
    ds_read_b64_tr_b16 a[116:117], v2 offset:38080
    v_cvt_pk_bf16_f32 v31, v34, v35
    v_mfma_f32_16x16x32_bf16 v[36:39], a[44:47], v[52:55], v[36:39]
    v_mfma_f32_16x16x32_bf16 v[36:39], a[48:51], a[156:159], v[36:39]
    ds_read_b64_tr_b16 a[118:119], v2 offset:38592
    v_mfma_f32_16x16x32_bf16 v[36:39], a[52:55], a[152:155], v[36:39]
    v_mfma_f32_16x16x32_bf16 v[36:39], a[56:59], a[148:151], v[36:39]
    s_xor_b32 s100, s99, 0
    ds_read_b64_tr_b16 a[204:205], v2 offset:42304
    v_mfma_f32_16x16x32_bf16 v[36:39], a[60:63], a[144:147], v[36:39]
    buffer_store_dwordx4 v[28:31], v8, s[20:23], s100 offen offset:0 sc1 nt
    v_mfma_f32_16x16x32_bf16 v[40:43], a[60:63], a[160:163], 0
    ds_read_b64_tr_b16 a[206:207], v2 offset:42816
    v_mfma_f32_16x16x32_bf16 v[40:43], a[56:59], a[164:167], v[40:43]
    v_mfma_f32_16x16x32_bf16 v[40:43], a[52:55], a[168:171], v[40:43]
    ds_read_b64_tr_b16 a[112:113], v2 offset:46528
    v_mfma_f32_16x16x32_bf16 v[40:43], a[48:51], v[44:47], v[40:43]
    v_mfma_f32_16x16x32_bf16 v[40:43], a[44:47], v[56:59], v[40:43]
    ds_read_b64_tr_b16 a[114:115], v2 offset:47040
    v_mfma_f32_16x16x32_bf16 v[40:43], a[40:43], v[88:91], v[40:43]
    v_mul_f32 v36, v25, v36
    v_mul_f32 v37, v25, v37
    v_mfma_f32_16x16x32_bf16 v[40:43], a[36:39], v[104:107], v[40:43]
    ds_read_b64_tr_b16 a[208:209], v1 offset:64
    v_mul_f32 v38, v25, v38
    v_mfma_f32_16x16x32_bf16 v[40:43], a[32:35], v[120:123], v[40:43]
    v_mul_f32 v39, v25, v39
    v_cvt_pk_bf16_f32 v22, v36, v37
    v_mfma_f32_16x16x32_bf16 v[40:43], a[64:67], v[136:139], v[40:43]
    ds_read_b64_tr_b16 a[210:211], v1 offset:576
    v_cvt_pk_bf16_f32 v23, v38, v39
    v_mfma_f32_16x16x32_bf16 v[40:43], a[68:71], v[152:155], v[40:43]
L_pad6:
    s_cbranch_vccnz L_warm_done
    v_mfma_f32_16x16x32_bf16 v[40:43], a[72:75], v[168:171], v[40:43]
    ds_read_b64_tr_b16 a[108:109], v1 offset:4288
    v_mfma_f32_16x16x32_bf16 v[40:43], a[76:79], v[184:187], v[40:43]
    s_xor_b32 s28, s98, 256
    v_mfma_f32_16x16x32_bf16 v[40:43], a[80:83], v[200:203], v[40:43]
    s_add_u32 m0, s25, 67584
    ds_read_b64_tr_b16 a[110:111], v1 offset:4800
    v_mfma_f32_16x16x32_bf16 v[40:43], a[84:87], v[216:219], v[40:43]
    buffer_load_dwordx4 v5, s[16:19], s28 offen offset:0 lds
    v_mfma_f32_16x16x32_bf16 v[40:43], a[88:91], v[232:235], v[40:43]
    ds_read_b64_tr_b16 a[212:213], v1 offset:8512
    v_mfma_f32_16x16x32_bf16 v[40:43], a[92:95], v[248:251], v[40:43]
    v_mfma_f32_16x16x32_bf16 v[32:35], a[92:95], v[252:255], 0
    ds_read_b64_tr_b16 a[214:215], v1 offset:9024
    v_mfma_f32_16x16x32_bf16 v[32:35], a[88:91], v[236:239], v[32:35]
    v_mfma_f32_16x16x32_bf16 v[32:35], a[84:87], v[220:223], v[32:35]
    s_add_u32 m0, s25, 67592
    ds_read_b64_tr_b16 a[104:105], v1 offset:12736
    v_mfma_f32_16x16x32_bf16 v[32:35], a[80:83], v[204:207], v[32:35]
    buffer_load_dwordx4 v5, s[16:19], s28 offen offset:1024 lds
    v_mfma_f32_16x16x32_bf16 v[32:35], a[76:79], v[188:191], v[32:35]
    ds_read_b64_tr_b16 a[106:107], v1 offset:13248
    v_mfma_f32_16x16x32_bf16 v[32:35], a[72:75], v[172:175], v[32:35]
    v_mul_f32 v40, v26, v40
    v_mul_f32 v41, v26, v41
    v_mfma_f32_16x16x32_bf16 v[32:35], a[68:71], v[156:159], v[32:35]
    ds_read_b64_tr_b16 a[216:217], v2 offset:50752
    v_mul_f32 v42, v26, v42
    v_mfma_f32_16x16x32_bf16 v[32:35], a[64:67], v[140:143], v[32:35]
    v_mul_f32 v43, v26, v43
    v_cvt_pk_bf16_f32 v18, v40, v41
    v_mfma_f32_16x16x32_bf16 v[32:35], a[32:35], v[124:127], v[32:35]
    s_add_u32 m0, s25, 67648
    ds_read_b64_tr_b16 a[218:219], v2 offset:51264
    v_cvt_pk_bf16_f32 v19, v42, v43
    v_mfma_f32_16x16x32_bf16 v[32:35], a[36:39], v[108:111], v[32:35]
    buffer_load_dwordx4 v5, s[16:19], s28 offen offset:2048 lds
    v_mfma_f32_16x16x32_bf16 v[32:35], a[40:43], v[92:95], v[32:35]
    ds_read_b64_tr_b16 a[100:101], v2 offset:54976
    v_mfma_f32_16x16x32_bf16 v[32:35], a[44:47], v[76:79], v[32:35]
    v_mfma_f32_16x16x32_bf16 v[32:35], a[48:51], v[72:75], v[32:35]
    ds_read_b64_tr_b16 a[102:103], v2 offset:55488
    v_mfma_f32_16x16x32_bf16 v[32:35], a[52:55], v[68:71], v[32:35]
    v_mfma_f32_16x16x32_bf16 v[32:35], a[56:59], v[64:67], v[32:35]
    s_xor_b32 s100, s99, 8192
    ds_read_b64_tr_b16 a[220:221], v2 offset:59200
    v_mfma_f32_16x16x32_bf16 v[32:35], a[60:63], v[60:63], v[32:35]
    s_waitcnt lgkmcnt(4)
    buffer_store_dwordx4 v[20:23], v8, s[20:23], s100 offen offset:0 sc1 nt
    v_mfma_f32_16x16x32_bf16 v[36:39], a[192:195], a[128:131], 0
    ds_read_b64_tr_b16 a[222:223], v2 offset:59712
    v_mfma_f32_16x16x32_bf16 v[36:39], a[124:127], a[132:135], v[36:39]
    v_mfma_f32_16x16x32_bf16 v[36:39], a[196:199], a[136:139], v[36:39]
    ds_read_b64_tr_b16 a[96:97], v2 offset:63424
    v_mfma_f32_16x16x32_bf16 v[36:39], a[120:123], a[140:143], v[36:39]
    v_mfma_f32_16x16x32_bf16 v[36:39], a[200:203], v[48:51], v[36:39]
    ds_read_b64_tr_b16 a[98:99], v2 offset:63936
    v_mfma_f32_16x16x32_bf16 v[36:39], a[116:119], v[80:83], v[36:39]
    v_mul_f32 v32, v27, v32
    v_mul_f32 v33, v27, v33
    v_mfma_f32_16x16x32_bf16 v[36:39], a[204:207], v[96:99], v[36:39]
    ds_read_b64_tr_b16 a[188:189], v2 offset:16968
    v_mul_f32 v34, v27, v34
    v_mfma_f32_16x16x32_bf16 v[36:39], a[112:115], v[112:115], v[36:39]
    v_mul_f32 v35, v27, v35
    v_cvt_pk_bf16_f32 v14, v32, v33
    v_mfma_f32_16x16x32_bf16 v[36:39], a[208:211], v[128:131], v[36:39]
    ds_read_b64_tr_b16 a[190:191], v2 offset:17480
    v_cvt_pk_bf16_f32 v15, v34, v35
    v_mfma_f32_16x16x32_bf16 v[36:39], a[108:111], v[144:147], v[36:39]
    v_mfma_f32_16x16x32_bf16 v[36:39], a[212:215], v[160:163], v[36:39]
    ds_read_b64_tr_b16 a[184:185], v2 offset:21192
    v_mfma_f32_16x16x32_bf16 v[36:39], a[104:107], v[176:179], v[36:39]
    s_waitcnt lgkmcnt(4)
    v_mfma_f32_16x16x32_bf16 v[36:39], a[216:219], v[192:195], v[36:39]
    s_add_u32 m0, s25, 67656
    ds_read_b64_tr_b16 a[186:187], v2 offset:21704
    v_mfma_f32_16x16x32_bf16 v[36:39], a[100:103], v[208:211], v[36:39]
    buffer_load_dwordx4 v5, s[16:19], s28 offen offset:3072 lds
    v_mfma_f32_16x16x32_bf16 v[36:39], a[220:223], v[224:227], v[36:39]
    s_waitcnt lgkmcnt(3)
    ds_read_b64_tr_b16 a[180:181], v2 offset:25416
    v_mfma_f32_16x16x32_bf16 v[36:39], a[96:99], v[240:243], v[36:39]
    v_mfma_f32_16x16x32_bf16 v[40:43], a[96:99], v[244:247], 0
    ds_read_b64_tr_b16 a[182:183], v2 offset:25928
    v_mfma_f32_16x16x32_bf16 v[40:43], a[220:223], v[228:231], v[40:43]
    v_mfma_f32_16x16x32_bf16 v[40:43], a[100:103], v[212:215], v[40:43]
    ds_read_b64_tr_b16 a[176:177], v2 offset:29640
    v_mfma_f32_16x16x32_bf16 v[40:43], a[216:219], v[196:199], v[40:43]
    v_mfma_f32_16x16x32_bf16 v[40:43], a[104:107], v[180:183], v[40:43]
    ds_read_b64_tr_b16 a[178:179], v2 offset:30152
    v_mfma_f32_16x16x32_bf16 v[40:43], a[212:215], v[164:167], v[40:43]
    v_mul_f32 v36, v24, v36
    v_mul_f32 v37, v24, v37
    v_mfma_f32_16x16x32_bf16 v[40:43], a[108:111], v[148:151], v[40:43]
    ds_read_b64_tr_b16 a[172:173], v2 offset:33864
    v_mul_f32 v38, v24, v38
    v_mfma_f32_16x16x32_bf16 v[40:43], a[208:211], v[132:135], v[40:43]
    v_mul_f32 v39, v24, v39
    v_cvt_pk_bf16_f32 v28, v36, v37
    v_mfma_f32_16x16x32_bf16 v[40:43], a[112:115], v[116:119], v[40:43]
    ds_read_b64_tr_b16 a[174:175], v2 offset:34376
    v_cvt_pk_bf16_f32 v29, v38, v39
    v_mfma_f32_16x16x32_bf16 v[40:43], a[204:207], v[100:103], v[40:43]
    v_mfma_f32_16x16x32_bf16 v[40:43], a[116:119], v[84:87], v[40:43]
    ds_read_b64_tr_b16 a[232:233], v2 offset:38088
    v_mfma_f32_16x16x32_bf16 v[40:43], a[200:203], v[52:55], v[40:43]
    v_mfma_f32_16x16x32_bf16 v[40:43], a[120:123], a[156:159], v[40:43]
    ds_read_b64_tr_b16 a[234:235], v2 offset:38600
    v_mfma_f32_16x16x32_bf16 v[40:43], a[196:199], a[152:155], v[40:43]
    v_mfma_f32_16x16x32_bf16 v[40:43], a[124:127], a[148:151], v[40:43]
    s_xor_b32 s100, s99, 16384
    ds_read_b64_tr_b16 a[228:229], v2 offset:42312
    v_mfma_f32_16x16x32_bf16 v[40:43], a[192:195], a[144:147], v[40:43]
    buffer_store_dwordx4 v[16:19], v8, s[20:23], s100 offen offset:0 sc1 nt
    v_mfma_f32_16x16x32_bf16 v[32:35], a[192:195], a[160:163], 0
    ds_read_b64_tr_b16 a[230:231], v2 offset:42824
    v_mfma_f32_16x16x32_bf16 v[32:35], a[124:127], a[164:167], v[32:35]
    v_mfma_f32_16x16x32_bf16 v[32:35], a[196:199], a[168:171], v[32:35]
    ds_read_b64_tr_b16 a[224:225], v2 offset:46536
    v_mfma_f32_16x16x32_bf16 v[32:35], a[120:123], v[44:47], v[32:35]
    v_mfma_f32_16x16x32_bf16 v[32:35], a[200:203], v[56:59], v[32:35]
    ds_read_b64_tr_b16 a[226:227], v2 offset:47048
    v_mfma_f32_16x16x32_bf16 v[32:35], a[116:119], v[88:91], v[32:35]
    v_mul_f32 v40, v25, v40
    v_mul_f32 v41, v25, v41
    v_mfma_f32_16x16x32_bf16 v[32:35], a[204:207], v[104:107], v[32:35]
    ds_read_b64_tr_b16 a[0:1], v1 offset:72
    v_mul_f32 v42, v25, v42
    v_mfma_f32_16x16x32_bf16 v[32:35], a[112:115], v[120:123], v[32:35]
    v_mul_f32 v43, v25, v43
    v_cvt_pk_bf16_f32 v20, v40, v41
    v_mfma_f32_16x16x32_bf16 v[32:35], a[208:211], v[136:139], v[32:35]
    ds_read_b64_tr_b16 a[2:3], v1 offset:584
    v_cvt_pk_bf16_f32 v21, v42, v43
    v_mfma_f32_16x16x32_bf16 v[32:35], a[108:111], v[152:155], v[32:35]
    v_mfma_f32_16x16x32_bf16 v[32:35], a[212:215], v[168:171], v[32:35]
    ds_read_b64_tr_b16 a[4:5], v1 offset:4296
    v_mfma_f32_16x16x32_bf16 v[32:35], a[104:107], v[184:187], v[32:35]
    v_mfma_f32_16x16x32_bf16 v[32:35], a[216:219], v[200:203], v[32:35]
    ds_read_b64_tr_b16 a[6:7], v1 offset:4808
    v_mfma_f32_16x16x32_bf16 v[32:35], a[100:103], v[216:219], v[32:35]
    v_mfma_f32_16x16x32_bf16 v[32:35], a[220:223], v[232:235], v[32:35]
    ds_read_b64_tr_b16 a[8:9], v1 offset:8520
    v_mfma_f32_16x16x32_bf16 v[32:35], a[96:99], v[248:251], v[32:35]
    v_mfma_f32_16x16x32_bf16 v[36:39], a[96:99], v[252:255], 0
    ds_read_b64_tr_b16 a[10:11], v1 offset:9032
    v_mfma_f32_16x16x32_bf16 v[36:39], a[220:223], v[236:239], v[36:39]
    v_mfma_f32_16x16x32_bf16 v[36:39], a[100:103], v[220:223], v[36:39]
    ds_read_b64_tr_b16 a[12:13], v1 offset:12744
    v_mfma_f32_16x16x32_bf16 v[36:39], a[216:219], v[204:207], v[36:39]
    v_mfma_f32_16x16x32_bf16 v[36:39], a[104:107], v[188:191], v[36:39]
    ds_read_b64_tr_b16 a[14:15], v1 offset:13256
    v_mfma_f32_16x16x32_bf16 v[36:39], a[212:215], v[172:175], v[36:39]
    v_mul_f32 v32, v26, v32
    v_mul_f32 v33, v26, v33
    v_mfma_f32_16x16x32_bf16 v[36:39], a[108:111], v[156:159], v[36:39]
    ds_read_b64_tr_b16 a[16:17], v2 offset:50760
    v_mul_f32 v34, v26, v34
    v_mfma_f32_16x16x32_bf16 v[36:39], a[208:211], v[140:143], v[36:39]
    v_mul_f32 v35, v26, v35
    v_cvt_pk_bf16_f32 v16, v32, v33
    v_mfma_f32_16x16x32_bf16 v[36:39], a[112:115], v[124:127], v[36:39]
    ds_read_b64_tr_b16 a[18:19], v2 offset:51272
    v_cvt_pk_bf16_f32 v17, v34, v35
    v_mfma_f32_16x16x32_bf16 v[36:39], a[204:207], v[108:111], v[36:39]
    v_mfma_f32_16x16x32_bf16 v[36:39], a[116:119], v[92:95], v[36:39]
    ds_read_b64_tr_b16 a[20:21], v2 offset:54984
    v_mfma_f32_16x16x32_bf16 v[36:39], a[200:203], v[76:79], v[36:39]
    v_mfma_f32_16x16x32_bf16 v[36:39], a[120:123], v[72:75], v[36:39]
    ds_read_b64_tr_b16 a[22:23], v2 offset:55496
    v_mfma_f32_16x16x32_bf16 v[36:39], a[196:199], v[68:71], v[36:39]
    v_mfma_f32_16x16x32_bf16 v[36:39], a[124:127], v[64:67], v[36:39]
    s_xor_b32 s100, s99, 24576
    ds_read_b64_tr_b16 a[24:25], v2 offset:59208
    v_mfma_f32_16x16x32_bf16 v[36:39], a[192:195], v[60:63], v[36:39]
    s_waitcnt lgkmcnt(4)
    buffer_store_dwordx4 v[12:15], v8, s[20:23], s100 offen offset:0 sc1 nt
    v_mfma_f32_16x16x32_bf16 v[40:43], a[188:191], a[128:131], 0
    ds_read_b64_tr_b16 a[26:27], v2 offset:59720
    v_mfma_f32_16x16x32_bf16 v[40:43], a[184:187], a[132:135], v[40:43]
    v_mfma_f32_16x16x32_bf16 v[40:43], a[180:183], a[136:139], v[40:43]
    ds_read_b64_tr_b16 a[28:29], v2 offset:63432
    v_mfma_f32_16x16x32_bf16 v[40:43], a[176:179], a[140:143], v[40:43]
    v_mfma_f32_16x16x32_bf16 v[40:43], a[172:175], v[48:51], v[40:43]
    ds_read_b64_tr_b16 a[30:31], v2 offset:63944
    v_mfma_f32_16x16x32_bf16 v[40:43], a[232:235], v[80:83], v[40:43]
    s_waitcnt vmcnt(8) lgkmcnt(4)
    v_mul_f32 v36, v27, v36
    v_mul_f32 v37, v27, v37
    v_mfma_f32_16x16x32_bf16 v[40:43], a[228:231], v[96:99], v[40:43]
    s_barrier
    ds_read_b64_tr_b16 a[92:93], v1 offset:33792
    v_mul_f32 v38, v27, v38
    v_mfma_f32_16x16x32_bf16 v[40:43], a[224:227], v[112:115], v[40:43]
    ds_read_b32 v10, v10 offset:0
    v_mul_f32 v39, v27, v39
    v_mfma_f32_16x16x32_bf16 v[40:43], a[0:3], v[128:131], v[40:43]
    ds_read_b64_tr_b16 a[94:95], v1 offset:34304
    v_cvt_pk_bf16_f32 v12, v36, v37
    v_mfma_f32_16x16x32_bf16 v[40:43], a[4:7], v[144:147], v[40:43]
    v_cvt_pk_bf16_f32 v13, v38, v39
    v_mfma_f32_16x16x32_bf16 v[40:43], a[8:11], v[160:163], v[40:43]
    ds_read_b64_tr_b16 a[88:89], v1 offset:38016
    v_mfma_f32_16x16x32_bf16 v[40:43], a[12:15], v[176:179], v[40:43]
    s_xor_b32 s28, s98, 65792
    v_mfma_f32_16x16x32_bf16 v[40:43], a[16:19], v[192:195], v[40:43]
    s_add_u32 m0, s25, 0
    ds_read_b64_tr_b16 a[90:91], v1 offset:38528
    v_mfma_f32_16x16x32_bf16 v[40:43], a[20:23], v[208:211], v[40:43]
    s_waitcnt lgkmcnt(5)
    buffer_load_dwordx4 v5, s[16:19], s28 offen offset:0 lds
    v_mfma_f32_16x16x32_bf16 v[40:43], a[24:27], v[224:227], v[40:43]
    ds_read_b64_tr_b16 a[84:85], v1 offset:42240
    v_mfma_f32_16x16x32_bf16 v[40:43], a[28:31], v[240:243], v[40:43]
    v_mfma_f32_16x16x32_bf16 v[32:35], a[28:31], v[244:247], 0
    ds_read_b64_tr_b16 a[86:87], v1 offset:42752
    v_mfma_f32_16x16x32_bf16 v[32:35], a[24:27], v[228:231], v[32:35]
    v_mfma_f32_16x16x32_bf16 v[32:35], a[20:23], v[212:215], v[32:35]
    s_add_u32 m0, s25, 8
    ds_read_b64_tr_b16 a[80:81], v1 offset:46464
    v_mfma_f32_16x16x32_bf16 v[32:35], a[16:19], v[196:199], v[32:35]
    buffer_load_dwordx4 v5, s[16:19], s28 offen offset:1024 lds
    v_mfma_f32_16x16x32_bf16 v[32:35], a[12:15], v[180:183], v[32:35]
    ds_read_b64_tr_b16 a[82:83], v1 offset:46976
    v_mfma_f32_16x16x32_bf16 v[32:35], a[8:11], v[164:167], v[32:35]
    v_mul_f32 v40, v24, v40
    v_mul_f32 v41, v24, v41
    v_mfma_f32_16x16x32_bf16 v[32:35], a[4:7], v[148:151], v[32:35]
    ds_read_b64_tr_b16 a[76:77], v3 offset:0
    v_mul_f32 v42, v24, v42
    v_mfma_f32_16x16x32_bf16 v[32:35], a[0:3], v[132:135], v[32:35]
    v_mul_f32 v43, v24, v43
    v_cvt_pk_bf16_f32 v30, v40, v41
    v_mfma_f32_16x16x32_bf16 v[32:35], a[224:227], v[116:119], v[32:35]
    s_add_u32 m0, s25, 64
    ds_read_b64_tr_b16 a[78:79], v3 offset:512
    v_cvt_pk_bf16_f32 v31, v42, v43
    v_mfma_f32_16x16x32_bf16 v[32:35], a[228:231], v[100:103], v[32:35]
    buffer_load_dwordx4 v5, s[16:19], s28 offen offset:2048 lds
    v_mfma_f32_16x16x32_bf16 v[32:35], a[232:235], v[84:87], v[32:35]
    ds_read_b64_tr_b16 a[72:73], v3 offset:4224
    v_mfma_f32_16x16x32_bf16 v[32:35], a[172:175], v[52:55], v[32:35]
    v_mfma_f32_16x16x32_bf16 v[32:35], a[176:179], a[156:159], v[32:35]
    ds_read_b64_tr_b16 a[74:75], v3 offset:4736
    v_mfma_f32_16x16x32_bf16 v[32:35], a[180:183], a[152:155], v[32:35]
    v_mfma_f32_16x16x32_bf16 v[32:35], a[184:187], a[148:151], v[32:35]
    s_xor_b32 s100, s99, 0
    ds_read_b64_tr_b16 a[68:69], v3 offset:8448
    v_mfma_f32_16x16x32_bf16 v[32:35], a[188:191], a[144:147], v[32:35]
    buffer_store_dwordx4 v[28:31], v8, s[20:23], s100 offen offset:64 sc1 nt
    v_mfma_f32_16x16x32_bf16 v[36:39], a[188:191], a[160:163], 0
    ds_read_b64_tr_b16 a[70:71], v3 offset:8960
    v_mfma_f32_16x16x32_bf16 v[36:39], a[184:187], a[164:167], v[36:39]
    v_mfma_f32_16x16x32_bf16 v[36:39], a[180:183], a[168:171], v[36:39]
    ds_read_b64_tr_b16 a[64:65], v3 offset:12672
    v_mfma_f32_16x16x32_bf16 v[36:39], a[176:179], v[44:47], v[36:39]
    v_mfma_f32_16x16x32_bf16 v[36:39], a[172:175], v[56:59], v[36:39]
    ds_read_b64_tr_b16 a[66:67], v3 offset:13184
    v_mfma_f32_16x16x32_bf16 v[36:39], a[232:235], v[88:91], v[36:39]
    v_mul_f32 v32, v25, v32
    v_mul_f32 v33, v25, v33
    v_mfma_f32_16x16x32_bf16 v[36:39], a[228:231], v[104:107], v[36:39]
    ds_read_b64_tr_b16 a[32:33], v1 offset:16896
    v_mul_f32 v34, v25, v34
    v_mfma_f32_16x16x32_bf16 v[36:39], a[224:227], v[120:123], v[36:39]
    v_mul_f32 v35, v25, v35
    v_cvt_pk_bf16_f32 v22, v32, v33
    v_mfma_f32_16x16x32_bf16 v[36:39], a[0:3], v[136:139], v[36:39]
    ds_read_b64_tr_b16 a[34:35], v1 offset:17408
    v_cvt_pk_bf16_f32 v23, v34, v35
    v_mfma_f32_16x16x32_bf16 v[36:39], a[4:7], v[152:155], v[36:39]
    v_mfma_f32_16x16x32_bf16 v[36:39], a[8:11], v[168:171], v[36:39]
    ds_read_b64_tr_b16 a[36:37], v1 offset:21120
    v_mfma_f32_16x16x32_bf16 v[36:39], a[12:15], v[184:187], v[36:39]
    v_mfma_f32_16x16x32_bf16 v[36:39], a[16:19], v[200:203], v[36:39]
    s_add_u32 m0, s25, 72
    ds_read_b64_tr_b16 a[38:39], v1 offset:21632
    v_mfma_f32_16x16x32_bf16 v[36:39], a[20:23], v[216:219], v[36:39]
    buffer_load_dwordx4 v5, s[16:19], s28 offen offset:3072 lds
    v_mfma_f32_16x16x32_bf16 v[36:39], a[24:27], v[232:235], v[36:39]
    ds_read_b64_tr_b16 a[40:41], v1 offset:25344
    v_mfma_f32_16x16x32_bf16 v[36:39], a[28:31], v[248:251], v[36:39]
    v_mfma_f32_16x16x32_bf16 v[40:43], a[28:31], v[252:255], 0
    ds_read_b64_tr_b16 a[42:43], v1 offset:25856
    v_mfma_f32_16x16x32_bf16 v[40:43], a[24:27], v[236:239], v[40:43]
    s_xor_b32 s28, s98, 131328
    v_mfma_f32_16x16x32_bf16 v[40:43], a[20:23], v[220:223], v[40:43]
    s_add_u32 m0, s25, 84480
    ds_read_b64_tr_b16 a[44:45], v1 offset:29568
    v_mfma_f32_16x16x32_bf16 v[40:43], a[16:19], v[204:207], v[40:43]
    buffer_load_dwordx4 v5, s[16:19], s28 offen offset:0 lds
    v_mfma_f32_16x16x32_bf16 v[40:43], a[12:15], v[188:191], v[40:43]
    ds_read_b64_tr_b16 a[46:47], v1 offset:30080
    v_mfma_f32_16x16x32_bf16 v[40:43], a[8:11], v[172:175], v[40:43]
    v_mul_f32 v36, v26, v36
    v_mul_f32 v37, v26, v37
    v_mfma_f32_16x16x32_bf16 v[40:43], a[4:7], v[156:159], v[40:43]
    ds_read_b64_tr_b16 a[48:49], v1 offset:50688
    v_mul_f32 v38, v26, v38
    v_mfma_f32_16x16x32_bf16 v[40:43], a[0:3], v[140:143], v[40:43]
    v_mul_f32 v39, v26, v39
    v_cvt_pk_bf16_f32 v18, v36, v37
    v_mfma_f32_16x16x32_bf16 v[40:43], a[224:227], v[124:127], v[40:43]
    s_add_u32 m0, s25, 84488
    ds_read_b64_tr_b16 a[50:51], v1 offset:51200
    v_cvt_pk_bf16_f32 v19, v38, v39
    v_mfma_f32_16x16x32_bf16 v[40:43], a[228:231], v[108:111], v[40:43]
    buffer_load_dwordx4 v5, s[16:19], s28 offen offset:1024 lds
    v_mfma_f32_16x16x32_bf16 v[40:43], a[232:235], v[92:95], v[40:43]
    ds_read_b64_tr_b16 a[52:53], v1 offset:54912
    v_mfma_f32_16x16x32_bf16 v[40:43], a[172:175], v[76:79], v[40:43]
    v_mfma_f32_16x16x32_bf16 v[40:43], a[176:179], v[72:75], v[40:43]
    ds_read_b64_tr_b16 a[54:55], v1 offset:55424
    v_mfma_f32_16x16x32_bf16 v[40:43], a[180:183], v[68:71], v[40:43]
    v_mfma_f32_16x16x32_bf16 v[40:43], a[184:187], v[64:67], v[40:43]
    s_xor_b32 s100, s99, 8192
    ds_read_b64_tr_b16 a[56:57], v1 offset:59136
    v_mfma_f32_16x16x32_bf16 v[40:43], a[188:191], v[60:63], v[40:43]
    s_waitcnt lgkmcnt(4)
    buffer_store_dwordx4 v[20:23], v8, s[20:23], s100 offen offset:64 sc1 nt
    v_mfma_f32_16x16x32_bf16 v[32:35], a[92:95], a[128:131], 0
    ds_read_b64_tr_b16 a[58:59], v1 offset:59648
    v_mfma_f32_16x16x32_bf16 v[32:35], a[88:91], a[132:135], v[32:35]
    v_mfma_f32_16x16x32_bf16 v[32:35], a[84:87], a[136:139], v[32:35]
    ds_read_b64_tr_b16 a[60:61], v1 offset:63360
    v_mfma_f32_16x16x32_bf16 v[32:35], a[80:83], a[140:143], v[32:35]
    v_mfma_f32_16x16x32_bf16 v[32:35], a[76:79], v[48:51], v[32:35]
    ds_read_b64_tr_b16 a[62:63], v1 offset:63872
    v_mfma_f32_16x16x32_bf16 v[32:35], a[72:75], v[80:83], v[32:35]
    v_mul_f32 v40, v27, v40
    v_mul_f32 v41, v27, v41
    v_mfma_f32_16x16x32_bf16 v[32:35], a[68:71], v[96:99], v[32:35]
    ds_read_b64_tr_b16 a[96:97], v1 offset:33800
    v_mul_f32 v42, v27, v42
    v_mfma_f32_16x16x32_bf16 v[32:35], a[64:67], v[112:115], v[32:35]
    v_mul_f32 v43, v27, v43
    v_cvt_pk_bf16_f32 v14, v40, v41
    v_mfma_f32_16x16x32_bf16 v[32:35], a[32:35], v[128:131], v[32:35]
    ds_read_b64_tr_b16 a[98:99], v1 offset:34312
    v_cvt_pk_bf16_f32 v15, v42, v43
    v_mfma_f32_16x16x32_bf16 v[32:35], a[36:39], v[144:147], v[32:35]
    v_mfma_f32_16x16x32_bf16 v[32:35], a[40:43], v[160:163], v[32:35]
    ds_read_b64_tr_b16 a[220:221], v1 offset:38024
    v_mfma_f32_16x16x32_bf16 v[32:35], a[44:47], v[176:179], v[32:35]
    s_waitcnt lgkmcnt(4)
    v_mfma_f32_16x16x32_bf16 v[32:35], a[48:51], v[192:195], v[32:35]
    ds_read_b64_tr_b16 a[222:223], v1 offset:38536
    v_mfma_f32_16x16x32_bf16 v[32:35], a[52:55], v[208:211], v[32:35]
    v_cmp_ne_u32_e64 s[94:95], 0, v10
    v_mfma_f32_16x16x32_bf16 v[32:35], a[56:59], v[224:227], v[32:35]
    s_waitcnt lgkmcnt(3)
    ds_read_b64_tr_b16 a[100:101], v1 offset:42248
    v_mfma_f32_16x16x32_bf16 v[32:35], a[60:63], v[240:243], v[32:35]
    v_mfma_f32_16x16x32_bf16 v[36:39], a[60:63], v[244:247], 0
    ds_read_b64_tr_b16 a[102:103], v1 offset:42760
    v_mfma_f32_16x16x32_bf16 v[36:39], a[56:59], v[228:231], v[36:39]
    v_mfma_f32_16x16x32_bf16 v[36:39], a[52:55], v[212:215], v[36:39]
    s_add_u32 m0, s25, 84544
    ds_read_b64_tr_b16 a[216:217], v1 offset:46472
    v_mfma_f32_16x16x32_bf16 v[36:39], a[48:51], v[196:199], v[36:39]
    buffer_load_dwordx4 v5, s[16:19], s28 offen offset:2048 lds
    v_mfma_f32_16x16x32_bf16 v[36:39], a[44:47], v[180:183], v[36:39]
    ds_read_b64_tr_b16 a[218:219], v1 offset:46984
    v_mfma_f32_16x16x32_bf16 v[36:39], a[40:43], v[164:167], v[36:39]
    v_mul_f32 v32, v24, v32
    v_mul_f32 v33, v24, v33
    v_mfma_f32_16x16x32_bf16 v[36:39], a[36:39], v[148:151], v[36:39]
    ds_read_b64_tr_b16 a[104:105], v3 offset:8
    v_mul_f32 v34, v24, v34
    v_mfma_f32_16x16x32_bf16 v[36:39], a[32:35], v[132:135], v[36:39]
    v_mul_f32 v35, v24, v35
    v_cvt_pk_bf16_f32 v28, v32, v33
    v_mfma_f32_16x16x32_bf16 v[36:39], a[64:67], v[116:119], v[36:39]
    s_add_u32 m0, s25, 84552
    ds_read_b64_tr_b16 a[106:107], v3 offset:520
    v_cvt_pk_bf16_f32 v29, v34, v35
    v_mfma_f32_16x16x32_bf16 v[36:39], a[68:71], v[100:103], v[36:39]
    buffer_load_dwordx4 v5, s[16:19], s28 offen offset:3072 lds
    v_mfma_f32_16x16x32_bf16 v[36:39], a[72:75], v[84:87], v[36:39]
    ds_read_b64_tr_b16 a[212:213], v3 offset:4232
    v_mfma_f32_16x16x32_bf16 v[36:39], a[76:79], v[52:55], v[36:39]
    v_mfma_f32_16x16x32_bf16 v[36:39], a[80:83], a[156:159], v[36:39]
    ds_read_b64_tr_b16 a[214:215], v3 offset:4744
    v_mfma_f32_16x16x32_bf16 v[36:39], a[84:87], a[152:155], v[36:39]
    v_mfma_f32_16x16x32_bf16 v[36:39], a[88:91], a[148:151], v[36:39]
    s_xor_b32 s100, s99, 16384
    ds_read_b64_tr_b16 a[108:109], v3 offset:8456
    v_mfma_f32_16x16x32_bf16 v[36:39], a[92:95], a[144:147], v[36:39]
    buffer_store_dwordx4 v[16:19], v8, s[20:23], s100 offen offset:64 sc1 nt
    v_mfma_f32_16x16x32_bf16 v[40:43], a[92:95], a[160:163], 0
    ds_read_b64_tr_b16 a[110:111], v3 offset:8968
    v_mfma_f32_16x16x32_bf16 v[40:43], a[88:91], a[164:167], v[40:43]
    v_mfma_f32_16x16x32_bf16 v[40:43], a[84:87], a[168:171], v[40:43]
    ds_read_b64_tr_b16 a[208:209], v3 offset:12680
    v_mfma_f32_16x16x32_bf16 v[40:43], a[80:83], v[44:47], v[40:43]
    v_mfma_f32_16x16x32_bf16 v[40:43], a[76:79], v[56:59], v[40:43]
    ds_read_b64_tr_b16 a[210:211], v3 offset:13192
    v_mfma_f32_16x16x32_bf16 v[40:43], a[72:75], v[88:91], v[40:43]
    v_mul_f32 v36, v25, v36
    v_mul_f32 v37, v25, v37
    v_mfma_f32_16x16x32_bf16 v[40:43], a[68:71], v[104:107], v[40:43]
    ds_read_b64_tr_b16 a[112:113], v1 offset:16904
    v_mul_f32 v38, v25, v38
    v_mfma_f32_16x16x32_bf16 v[40:43], a[64:67], v[120:123], v[40:43]
    v_mul_f32 v39, v25, v39
    v_cvt_pk_bf16_f32 v20, v36, v37
    v_mfma_f32_16x16x32_bf16 v[40:43], a[32:35], v[136:139], v[40:43]
    ds_read_b64_tr_b16 a[114:115], v1 offset:17416
    v_cvt_pk_bf16_f32 v21, v38, v39
    v_mfma_f32_16x16x32_bf16 v[40:43], a[36:39], v[152:155], v[40:43]
    v_mfma_f32_16x16x32_bf16 v[40:43], a[40:43], v[168:171], v[40:43]
    ds_read_b64_tr_b16 a[204:205], v1 offset:21128
    v_mfma_f32_16x16x32_bf16 v[40:43], a[44:47], v[184:187], v[40:43]
    s_xor_b32 s28, s98, 196864
    v_mfma_f32_16x16x32_bf16 v[40:43], a[48:51], v[200:203], v[40:43]
    s_add_u32 m0, s25, 101376
    ds_read_b64_tr_b16 a[206:207], v1 offset:21640
    v_mfma_f32_16x16x32_bf16 v[40:43], a[52:55], v[216:219], v[40:43]
    buffer_load_dwordx4 v5, s[16:19], s28 offen offset:0 lds
    v_mfma_f32_16x16x32_bf16 v[40:43], a[56:59], v[232:235], v[40:43]
    ds_read_b64_tr_b16 a[116:117], v1 offset:25352
    v_mfma_f32_16x16x32_bf16 v[40:43], a[60:63], v[248:251], v[40:43]
    v_mfma_f32_16x16x32_bf16 v[32:35], a[60:63], v[252:255], 0
    ds_read_b64_tr_b16 a[118:119], v1 offset:25864
    v_mfma_f32_16x16x32_bf16 v[32:35], a[56:59], v[236:239], v[32:35]
    v_mfma_f32_16x16x32_bf16 v[32:35], a[52:55], v[220:223], v[32:35]
    s_add_u32 m0, s25, 101384
    ds_read_b64_tr_b16 a[200:201], v1 offset:29576
    v_mfma_f32_16x16x32_bf16 v[32:35], a[48:51], v[204:207], v[32:35]
    buffer_load_dwordx4 v5, s[16:19], s28 offen offset:1024 lds
    v_mfma_f32_16x16x32_bf16 v[32:35], a[44:47], v[188:191], v[32:35]
    ds_read_b64_tr_b16 a[202:203], v1 offset:30088
    v_mfma_f32_16x16x32_bf16 v[32:35], a[40:43], v[172:175], v[32:35]
    v_mul_f32 v40, v26, v40
    v_mul_f32 v41, v26, v41
    v_mfma_f32_16x16x32_bf16 v[32:35], a[36:39], v[156:159], v[32:35]
    ds_read_b64_tr_b16 a[120:121], v1 offset:50696
    v_mul_f32 v42, v26, v42
    v_mfma_f32_16x16x32_bf16 v[32:35], a[32:35], v[140:143], v[32:35]
    v_mul_f32 v43, v26, v43
    v_cvt_pk_bf16_f32 v16, v40, v41
    v_mfma_f32_16x16x32_bf16 v[32:35], a[64:67], v[124:127], v[32:35]
    s_add_u32 m0, s25, 101440
    ds_read_b64_tr_b16 a[122:123], v1 offset:51208
    v_cvt_pk_bf16_f32 v17, v42, v43
    v_mfma_f32_16x16x32_bf16 v[32:35], a[68:71], v[108:111], v[32:35]
    buffer_load_dwordx4 v5, s[16:19], s28 offen offset:2048 lds
    v_mfma_f32_16x16x32_bf16 v[32:35], a[72:75], v[92:95], v[32:35]
    ds_read_b64_tr_b16 a[196:197], v1 offset:54920
    v_mfma_f32_16x16x32_bf16 v[32:35], a[76:79], v[76:79], v[32:35]
    v_mfma_f32_16x16x32_bf16 v[32:35], a[80:83], v[72:75], v[32:35]
    ds_read_b64_tr_b16 a[198:199], v1 offset:55432
    v_mfma_f32_16x16x32_bf16 v[32:35], a[84:87], v[68:71], v[32:35]
    v_mfma_f32_16x16x32_bf16 v[32:35], a[88:91], v[64:67], v[32:35]
    s_xor_b32 s100, s99, 24576
    ds_read_b64_tr_b16 a[124:125], v1 offset:59144
    v_mfma_f32_16x16x32_bf16 v[32:35], a[92:95], v[60:63], v[32:35]
    s_waitcnt lgkmcnt(4)
    buffer_store_dwordx4 v[12:15], v8, s[20:23], s100 offen offset:64 sc1 nt
    v_mfma_f32_16x16x32_bf16 v[36:39], a[96:99], a[128:131], 0
    ds_read_b64_tr_b16 a[126:127], v1 offset:59656
    v_mfma_f32_16x16x32_bf16 v[36:39], a[220:223], a[132:135], v[36:39]
    v_mfma_f32_16x16x32_bf16 v[36:39], a[100:103], a[136:139], v[36:39]
    ds_read_b64_tr_b16 a[192:193], v1 offset:63368
    v_mfma_f32_16x16x32_bf16 v[36:39], a[216:219], a[140:143], v[36:39]
    v_mfma_f32_16x16x32_bf16 v[36:39], a[104:107], v[48:51], v[36:39]
    ds_read_b64_tr_b16 a[194:195], v1 offset:63880
    v_mfma_f32_16x16x32_bf16 v[36:39], a[212:215], v[80:83], v[36:39]
    v_mul_f32 v32, v27, v32
    v_mul_f32 v33, v27, v33
    v_mfma_f32_16x16x32_bf16 v[36:39], a[108:111], v[96:99], v[36:39]
    ds_read_b64_tr_b16 a[28:29], v1 offset:33856
    v_mul_f32 v34, v27, v34
    v_mfma_f32_16x16x32_bf16 v[36:39], a[208:211], v[112:115], v[36:39]
    v_mul_f32 v35, v27, v35
    v_cvt_pk_bf16_f32 v12, v32, v33
    v_mfma_f32_16x16x32_bf16 v[36:39], a[112:115], v[128:131], v[36:39]
    ds_read_b64_tr_b16 a[30:31], v1 offset:34368
    v_cvt_pk_bf16_f32 v13, v34, v35
    v_mfma_f32_16x16x32_bf16 v[36:39], a[204:207], v[144:147], v[36:39]
    v_mfma_f32_16x16x32_bf16 v[36:39], a[116:119], v[160:163], v[36:39]
    ds_read_b64_tr_b16 a[24:25], v1 offset:38080
    v_mfma_f32_16x16x32_bf16 v[36:39], a[200:203], v[176:179], v[36:39]
    s_waitcnt lgkmcnt(4)
    v_mfma_f32_16x16x32_bf16 v[36:39], a[120:123], v[192:195], v[36:39]
    s_add_u32 m0, s25, 101448
    ds_read_b64_tr_b16 a[26:27], v1 offset:38592
    v_mfma_f32_16x16x32_bf16 v[36:39], a[196:199], v[208:211], v[36:39]
    buffer_load_dwordx4 v5, s[16:19], s28 offen offset:3072 lds
    v_mfma_f32_16x16x32_bf16 v[36:39], a[124:127], v[224:227], v[36:39]
    s_waitcnt lgkmcnt(3)
    ds_read_b64_tr_b16 a[20:21], v1 offset:42304
    v_mfma_f32_16x16x32_bf16 v[36:39], a[192:195], v[240:243], v[36:39]
    v_mfma_f32_16x16x32_bf16 v[40:43], a[192:195], v[244:247], 0
    ds_read_b64_tr_b16 a[22:23], v1 offset:42816
    v_mfma_f32_16x16x32_bf16 v[40:43], a[124:127], v[228:231], v[40:43]
    v_mfma_f32_16x16x32_bf16 v[40:43], a[196:199], v[212:215], v[40:43]
    ds_read_b64_tr_b16 a[16:17], v1 offset:46528
    v_mfma_f32_16x16x32_bf16 v[40:43], a[120:123], v[196:199], v[40:43]
    v_mfma_f32_16x16x32_bf16 v[40:43], a[200:203], v[180:183], v[40:43]
    ds_read_b64_tr_b16 a[18:19], v1 offset:47040
    v_mfma_f32_16x16x32_bf16 v[40:43], a[116:119], v[164:167], v[40:43]
    v_mul_f32 v36, v24, v36
    v_mul_f32 v37, v24, v37
    v_mfma_f32_16x16x32_bf16 v[40:43], a[204:207], v[148:151], v[40:43]
    ds_read_b64_tr_b16 a[12:13], v3 offset:64
    v_mul_f32 v38, v24, v38
    v_mfma_f32_16x16x32_bf16 v[40:43], a[112:115], v[132:135], v[40:43]
    v_mul_f32 v39, v24, v39
    v_cvt_pk_bf16_f32 v30, v36, v37
    v_mfma_f32_16x16x32_bf16 v[40:43], a[208:211], v[116:119], v[40:43]
    ds_read_b64_tr_b16 a[14:15], v3 offset:576
    v_cvt_pk_bf16_f32 v31, v38, v39
    v_mfma_f32_16x16x32_bf16 v[40:43], a[108:111], v[100:103], v[40:43]
    v_mfma_f32_16x16x32_bf16 v[40:43], a[212:215], v[84:87], v[40:43]
    ds_read_b64_tr_b16 a[8:9], v3 offset:4288
    v_mfma_f32_16x16x32_bf16 v[40:43], a[104:107], v[52:55], v[40:43]
    v_mfma_f32_16x16x32_bf16 v[40:43], a[216:219], a[156:159], v[40:43]
    ds_read_b64_tr_b16 a[10:11], v3 offset:4800
    v_mfma_f32_16x16x32_bf16 v[40:43], a[100:103], a[152:155], v[40:43]
    v_mfma_f32_16x16x32_bf16 v[40:43], a[220:223], a[148:151], v[40:43]
    s_xor_b32 s100, s99, 128
    ds_read_b64_tr_b16 a[4:5], v3 offset:8512
    v_mfma_f32_16x16x32_bf16 v[40:43], a[96:99], a[144:147], v[40:43]
    buffer_store_dwordx4 v[28:31], v8, s[20:23], s100 offen offset:0 sc1 nt
    v_mfma_f32_16x16x32_bf16 v[32:35], a[96:99], a[160:163], 0
    ds_read_b64_tr_b16 a[6:7], v3 offset:9024
    v_mfma_f32_16x16x32_bf16 v[32:35], a[220:223], a[164:167], v[32:35]
    v_mfma_f32_16x16x32_bf16 v[32:35], a[100:103], a[168:171], v[32:35]
    ds_read_b64_tr_b16 a[0:1], v3 offset:12736
    v_mfma_f32_16x16x32_bf16 v[32:35], a[216:219], v[44:47], v[32:35]
    v_mfma_f32_16x16x32_bf16 v[32:35], a[104:107], v[56:59], v[32:35]
    ds_read_b64_tr_b16 a[2:3], v3 offset:13248
    v_mfma_f32_16x16x32_bf16 v[32:35], a[212:215], v[88:91], v[32:35]
    v_mul_f32 v40, v25, v40
    v_mul_f32 v41, v25, v41
    v_mfma_f32_16x16x32_bf16 v[32:35], a[108:111], v[104:107], v[32:35]
    ds_read_b64_tr_b16 a[224:225], v1 offset:16960
    v_mul_f32 v42, v25, v42
    v_mfma_f32_16x16x32_bf16 v[32:35], a[208:211], v[120:123], v[32:35]
    v_mul_f32 v43, v25, v43
    v_cvt_pk_bf16_f32 v22, v40, v41
    v_mfma_f32_16x16x32_bf16 v[32:35], a[112:115], v[136:139], v[32:35]
    ds_read_b64_tr_b16 a[226:227], v1 offset:17472
    v_cvt_pk_bf16_f32 v23, v42, v43
    v_mfma_f32_16x16x32_bf16 v[32:35], a[204:207], v[152:155], v[32:35]
    v_mfma_f32_16x16x32_bf16 v[32:35], a[116:119], v[168:171], v[32:35]
    ds_read_b64_tr_b16 a[228:229], v1 offset:21184
    v_mfma_f32_16x16x32_bf16 v[32:35], a[200:203], v[184:187], v[32:35]
    v_mfma_f32_16x16x32_bf16 v[32:35], a[120:123], v[200:203], v[32:35]
    ds_read_b64_tr_b16 a[230:231], v1 offset:21696
    v_mfma_f32_16x16x32_bf16 v[32:35], a[196:199], v[216:219], v[32:35]
L_pad7:
    s_cbranch_vccnz L_warm_done
    v_mfma_f32_16x16x32_bf16 v[32:35], a[124:127], v[232:235], v[32:35]
    ds_read_b64_tr_b16 a[232:233], v1 offset:25408
    v_mfma_f32_16x16x32_bf16 v[32:35], a[192:195], v[248:251], v[32:35]
    v_mfma_f32_16x16x32_bf16 v[36:39], a[192:195], v[252:255], 0
    ds_read_b64_tr_b16 a[234:235], v1 offset:25920
    v_mfma_f32_16x16x32_bf16 v[36:39], a[124:127], v[236:239], v[36:39]
    v_mfma_f32_16x16x32_bf16 v[36:39], a[196:199], v[220:223], v[36:39]
    ds_read_b64_tr_b16 a[172:173], v1 offset:29632
    v_mfma_f32_16x16x32_bf16 v[36:39], a[120:123], v[204:207], v[36:39]
    v_mfma_f32_16x16x32_bf16 v[36:39], a[200:203], v[188:191], v[36:39]
    ds_read_b64_tr_b16 a[174:175], v1 offset:30144
    v_mfma_f32_16x16x32_bf16 v[36:39], a[116:119], v[172:175], v[36:39]
    v_mul_f32 v32, v26, v32
    v_mul_f32 v33, v26, v33
    v_mfma_f32_16x16x32_bf16 v[36:39], a[204:207], v[156:159], v[36:39]
    ds_read_b64_tr_b16 a[176:177], v1 offset:50752
    v_mul_f32 v34, v26, v34
    v_mfma_f32_16x16x32_bf16 v[36:39], a[112:115], v[140:143], v[36:39]
    v_mul_f32 v35, v26, v35
    v_cvt_pk_bf16_f32 v18, v32, v33
    v_mfma_f32_16x16x32_bf16 v[36:39], a[208:211], v[124:127], v[36:39]
    ds_read_b64_tr_b16 a[178:179], v1 offset:51264
    v_cvt_pk_bf16_f32 v19, v34, v35
    v_mfma_f32_16x16x32_bf16 v[36:39], a[108:111], v[108:111], v[36:39]
    v_mfma_f32_16x16x32_bf16 v[36:39], a[212:215], v[92:95], v[36:39]
    ds_read_b64_tr_b16 a[180:181], v1 offset:54976
    v_mfma_f32_16x16x32_bf16 v[36:39], a[104:107], v[76:79], v[36:39]
    v_mfma_f32_16x16x32_bf16 v[36:39], a[216:219], v[72:75], v[36:39]
    ds_read_b64_tr_b16 a[182:183], v1 offset:55488
    v_mfma_f32_16x16x32_bf16 v[36:39], a[100:103], v[68:71], v[36:39]
    v_mfma_f32_16x16x32_bf16 v[36:39], a[220:223], v[64:67], v[36:39]
    s_xor_b32 s100, s99, 8320
    ds_read_b64_tr_b16 a[184:185], v1 offset:59200
    v_mfma_f32_16x16x32_bf16 v[36:39], a[96:99], v[60:63], v[36:39]
    s_waitcnt lgkmcnt(4)
    buffer_store_dwordx4 v[20:23], v8, s[20:23], s100 offen offset:0 sc1 nt
    v_mfma_f32_16x16x32_bf16 v[40:43], a[28:31], a[128:131], 0
    ds_read_b64_tr_b16 a[186:187], v1 offset:59712
    v_mfma_f32_16x16x32_bf16 v[40:43], a[24:27], a[132:135], v[40:43]
    v_mfma_f32_16x16x32_bf16 v[40:43], a[20:23], a[136:139], v[40:43]
    ds_read_b64_tr_b16 a[188:189], v1 offset:63424
    v_mfma_f32_16x16x32_bf16 v[40:43], a[16:19], a[140:143], v[40:43]
    v_mfma_f32_16x16x32_bf16 v[40:43], a[12:15], v[48:51], v[40:43]
    ds_read_b64_tr_b16 a[190:191], v1 offset:63936
    v_mfma_f32_16x16x32_bf16 v[40:43], a[8:11], v[80:83], v[40:43]
    v_mul_f32 v36, v27, v36
    v_mul_f32 v37, v27, v37
    v_mfma_f32_16x16x32_bf16 v[40:43], a[4:7], v[96:99], v[40:43]
    ds_read_b64_tr_b16 a[60:61], v1 offset:33864
    v_mul_f32 v38, v27, v38
    v_mfma_f32_16x16x32_bf16 v[40:43], a[0:3], v[112:115], v[40:43]
    v_mul_f32 v39, v27, v39
    v_cvt_pk_bf16_f32 v14, v36, v37
    v_mfma_f32_16x16x32_bf16 v[40:43], a[224:227], v[128:131], v[40:43]
    ds_read_b64_tr_b16 a[62:63], v1 offset:34376
    v_cvt_pk_bf16_f32 v15, v38, v39
    v_mfma_f32_16x16x32_bf16 v[40:43], a[228:231], v[144:147], v[40:43]
    v_mfma_f32_16x16x32_bf16 v[40:43], a[232:235], v[160:163], v[40:43]
    ds_read_b64_tr_b16 a[56:57], v1 offset:38088
    v_mfma_f32_16x16x32_bf16 v[40:43], a[172:175], v[176:179], v[40:43]
    s_waitcnt lgkmcnt(4)
    v_mfma_f32_16x16x32_bf16 v[40:43], a[176:179], v[192:195], v[40:43]
    ds_read_b64_tr_b16 a[58:59], v1 offset:38600
    v_mfma_f32_16x16x32_bf16 v[40:43], a[180:183], v[208:211], v[40:43]
    v_mfma_f32_16x16x32_bf16 v[40:43], a[184:187], v[224:227], v[40:43]
    s_waitcnt lgkmcnt(3)
    ds_read_b64_tr_b16 a[52:53], v1 offset:42312
    v_mfma_f32_16x16x32_bf16 v[40:43], a[188:191], v[240:243], v[40:43]
    v_mfma_f32_16x16x32_bf16 v[32:35], a[188:191], v[244:247], 0
    ds_read_b64_tr_b16 a[54:55], v1 offset:42824
    v_mfma_f32_16x16x32_bf16 v[32:35], a[184:187], v[228:231], v[32:35]
    v_mfma_f32_16x16x32_bf16 v[32:35], a[180:183], v[212:215], v[32:35]
    ds_read_b64_tr_b16 a[48:49], v1 offset:46536
    v_mfma_f32_16x16x32_bf16 v[32:35], a[176:179], v[196:199], v[32:35]
    v_mfma_f32_16x16x32_bf16 v[32:35], a[172:175], v[180:183], v[32:35]
    ds_read_b64_tr_b16 a[50:51], v1 offset:47048
    v_mfma_f32_16x16x32_bf16 v[32:35], a[232:235], v[164:167], v[32:35]
    v_mul_f32 v40, v24, v40
    v_mul_f32 v41, v24, v41
    v_mfma_f32_16x16x32_bf16 v[32:35], a[228:231], v[148:151], v[32:35]
    ds_read_b64_tr_b16 a[44:45], v3 offset:72
    v_mul_f32 v42, v24, v42
    v_mfma_f32_16x16x32_bf16 v[32:35], a[224:227], v[132:135], v[32:35]
    v_mul_f32 v43, v24, v43
    v_cvt_pk_bf16_f32 v28, v40, v41
    v_mfma_f32_16x16x32_bf16 v[32:35], a[0:3], v[116:119], v[32:35]
    ds_read_b64_tr_b16 a[46:47], v3 offset:584
    v_cvt_pk_bf16_f32 v29, v42, v43
    v_mfma_f32_16x16x32_bf16 v[32:35], a[4:7], v[100:103], v[32:35]
    v_mfma_f32_16x16x32_bf16 v[32:35], a[8:11], v[84:87], v[32:35]
    ds_read_b64_tr_b16 a[40:41], v3 offset:4296
    v_mfma_f32_16x16x32_bf16 v[32:35], a[12:15], v[52:55], v[32:35]
    v_mfma_f32_16x16x32_bf16 v[32:35], a[16:19], a[156:159], v[32:35]
    ds_read_b64_tr_b16 a[42:43], v3 offset:4808
    v_mfma_f32_16x16x32_bf16 v[32:35], a[20:23], a[152:155], v[32:35]
    v_mfma_f32_16x16x32_bf16 v[32:35], a[24:27], a[148:151], v[32:35]
    s_xor_b32 s100, s99, 16512
    ds_read_b64_tr_b16 a[36:37], v3 offset:8520
    v_mfma_f32_16x16x32_bf16 v[32:35], a[28:31], a[144:147], v[32:35]
    buffer_store_dwordx4 v[16:19], v8, s[20:23], s100 offen offset:0 sc1 nt
    v_mfma_f32_16x16x32_bf16 v[36:39], a[28:31], a[160:163], 0
    ds_read_b64_tr_b16 a[38:39], v3 offset:9032
    v_mfma_f32_16x16x32_bf16 v[36:39], a[24:27], a[164:167], v[36:39]
    v_mfma_f32_16x16x32_bf16 v[36:39], a[20:23], a[168:171], v[36:39]
    ds_read_b64_tr_b16 a[32:33], v3 offset:12744
    v_mfma_f32_16x16x32_bf16 v[36:39], a[16:19], v[44:47], v[36:39]
    v_mfma_f32_16x16x32_bf16 v[36:39], a[12:15], v[56:59], v[36:39]
    ds_read_b64_tr_b16 a[34:35], v3 offset:13256
    v_mfma_f32_16x16x32_bf16 v[36:39], a[8:11], v[88:91], v[36:39]
    v_mul_f32 v32, v25, v32
    v_mul_f32 v33, v25, v33
    v_mfma_f32_16x16x32_bf16 v[36:39], a[4:7], v[104:107], v[36:39]
    ds_read_b64_tr_b16 a[64:65], v1 offset:16968
    v_mul_f32 v34, v25, v34
    v_mfma_f32_16x16x32_bf16 v[36:39], a[0:3], v[120:123], v[36:39]
    v_mul_f32 v35, v25, v35
    v_cvt_pk_bf16_f32 v20, v32, v33
    v_mfma_f32_16x16x32_bf16 v[36:39], a[224:227], v[136:139], v[36:39]
    ds_read_b64_tr_b16 a[66:67], v1 offset:17480
    v_cvt_pk_bf16_f32 v21, v34, v35
    v_mfma_f32_16x16x32_bf16 v[36:39], a[228:231], v[152:155], v[36:39]
    v_mfma_f32_16x16x32_bf16 v[36:39], a[232:235], v[168:171], v[36:39]
    ds_read_b64_tr_b16 a[68:69], v1 offset:21192
    v_mfma_f32_16x16x32_bf16 v[36:39], a[172:175], v[184:187], v[36:39]
    v_mfma_f32_16x16x32_bf16 v[36:39], a[176:179], v[200:203], v[36:39]
    ds_read_b64_tr_b16 a[70:71], v1 offset:21704
    v_mfma_f32_16x16x32_bf16 v[36:39], a[180:183], v[216:219], v[36:39]
    v_mfma_f32_16x16x32_bf16 v[36:39], a[184:187], v[232:235], v[36:39]
    ds_read_b64_tr_b16 a[72:73], v1 offset:25416
    v_mfma_f32_16x16x32_bf16 v[36:39], a[188:191], v[248:251], v[36:39]
    v_mfma_f32_16x16x32_bf16 v[40:43], a[188:191], v[252:255], 0
    ds_read_b64_tr_b16 a[74:75], v1 offset:25928
    v_mfma_f32_16x16x32_bf16 v[40:43], a[184:187], v[236:239], v[40:43]
    v_mfma_f32_16x16x32_bf16 v[40:43], a[180:183], v[220:223], v[40:43]
    ds_read_b64_tr_b16 a[76:77], v1 offset:29640
    v_mfma_f32_16x16x32_bf16 v[40:43], a[176:179], v[204:207], v[40:43]
    v_mfma_f32_16x16x32_bf16 v[40:43], a[172:175], v[188:191], v[40:43]
    ds_read_b64_tr_b16 a[78:79], v1 offset:30152
    v_mfma_f32_16x16x32_bf16 v[40:43], a[232:235], v[172:175], v[40:43]
    v_mul_f32 v36, v26, v36
    v_mul_f32 v37, v26, v37
    v_mfma_f32_16x16x32_bf16 v[40:43], a[228:231], v[156:159], v[40:43]
    ds_read_b64_tr_b16 a[80:81], v1 offset:50760
    v_mul_f32 v38, v26, v38
    v_mfma_f32_16x16x32_bf16 v[40:43], a[224:227], v[140:143], v[40:43]
    v_mul_f32 v39, v26, v39
    v_cvt_pk_bf16_f32 v16, v36, v37
    v_mfma_f32_16x16x32_bf16 v[40:43], a[0:3], v[124:127], v[40:43]
    ds_read_b64_tr_b16 a[82:83], v1 offset:51272
    v_cvt_pk_bf16_f32 v17, v38, v39
    v_mfma_f32_16x16x32_bf16 v[40:43], a[4:7], v[108:111], v[40:43]
    v_mfma_f32_16x16x32_bf16 v[40:43], a[8:11], v[92:95], v[40:43]
    ds_read_b64_tr_b16 a[84:85], v1 offset:54984
    v_mfma_f32_16x16x32_bf16 v[40:43], a[12:15], v[76:79], v[40:43]
    v_mfma_f32_16x16x32_bf16 v[40:43], a[16:19], v[72:75], v[40:43]
    ds_read_b64_tr_b16 a[86:87], v1 offset:55496
    v_mfma_f32_16x16x32_bf16 v[40:43], a[20:23], v[68:71], v[40:43]
    v_mfma_f32_16x16x32_bf16 v[40:43], a[24:27], v[64:67], v[40:43]
    s_xor_b32 s100, s99, 24704
    ds_read_b64_tr_b16 a[88:89], v1 offset:59208
    v_mfma_f32_16x16x32_bf16 v[40:43], a[28:31], v[60:63], v[40:43]
    s_waitcnt lgkmcnt(4)
    buffer_store_dwordx4 v[12:15], v8, s[20:23], s100 offen offset:0 sc1 nt
    v_mfma_f32_16x16x32_bf16 v[32:35], a[60:63], a[128:131], 0
    ds_read_b64_tr_b16 a[90:91], v1 offset:59720
    v_mfma_f32_16x16x32_bf16 v[32:35], a[56:59], a[132:135], v[32:35]
    v_mfma_f32_16x16x32_bf16 v[32:35], a[52:55], a[136:139], v[32:35]
    ds_read_b64_tr_b16 a[92:93], v1 offset:63432
    v_mfma_f32_16x16x32_bf16 v[32:35], a[48:51], a[140:143], v[32:35]
    v_mfma_f32_16x16x32_bf16 v[32:35], a[44:47], v[48:51], v[32:35]
    ds_read_b64_tr_b16 a[94:95], v1 offset:63944
    v_mfma_f32_16x16x32_bf16 v[32:35], a[40:43], v[80:83], v[32:35]
    s_waitcnt vmcnt(4) lgkmcnt(4)
    v_mul_f32 v40, v27, v40
    v_mul_f32 v41, v27, v41
    v_mfma_f32_16x16x32_bf16 v[32:35], a[36:39], v[96:99], v[32:35]
    s_barrier
    ds_read_b64_tr_b16 a[192:193], v2 offset:0
    v_mul_f32 v42, v27, v42
    v_mfma_f32_16x16x32_bf16 v[32:35], a[32:35], v[112:115], v[32:35]
    v_mul_f32 v43, v27, v43
    v_cvt_pk_bf16_f32 v12, v40, v41
    v_mfma_f32_16x16x32_bf16 v[32:35], a[64:67], v[128:131], v[32:35]
    ds_read_b64_tr_b16 a[194:195], v2 offset:512
    v_cvt_pk_bf16_f32 v13, v42, v43
    v_mfma_f32_16x16x32_bf16 v[32:35], a[68:71], v[144:147], v[32:35]
    v_mfma_f32_16x16x32_bf16 v[32:35], a[72:75], v[160:163], v[32:35]
    ds_read_b64_tr_b16 a[124:125], v2 offset:4224
    v_mfma_f32_16x16x32_bf16 v[32:35], a[76:79], v[176:179], v[32:35]
    s_xor_b32 s28, s98, 384
    v_mfma_f32_16x16x32_bf16 v[32:35], a[80:83], v[192:195], v[32:35]
    s_add_u32 m0, s25, 16896
    ds_read_b64_tr_b16 a[126:127], v2 offset:4736
    v_mfma_f32_16x16x32_bf16 v[32:35], a[84:87], v[208:211], v[32:35]
    s_waitcnt lgkmcnt(4)
    buffer_load_dwordx4 v5, s[16:19], s28 offen offset:0 lds
    v_mfma_f32_16x16x32_bf16 v[32:35], a[88:91], v[224:227], v[32:35]
    ds_read_b64_tr_b16 a[196:197], v2 offset:8448
    v_mfma_f32_16x16x32_bf16 v[32:35], a[92:95], v[240:243], v[32:35]
    v_mfma_f32_16x16x32_bf16 v[36:39], a[92:95], v[244:247], 0
    ds_read_b64_tr_b16 a[198:199], v2 offset:8960
    v_mfma_f32_16x16x32_bf16 v[36:39], a[88:91], v[228:231], v[36:39]
    v_mfma_f32_16x16x32_bf16 v[36:39], a[84:87], v[212:215], v[36:39]
    s_add_u32 m0, s25, 16904
    ds_read_b64_tr_b16 a[120:121], v2 offset:12672
    v_mfma_f32_16x16x32_bf16 v[36:39], a[80:83], v[196:199], v[36:39]
    buffer_load_dwordx4 v5, s[16:19], s28 offen offset:1024 lds
    v_mfma_f32_16x16x32_bf16 v[36:39], a[76:79], v[180:183], v[36:39]
    ds_read_b64_tr_b16 a[122:123], v2 offset:13184
    v_mfma_f32_16x16x32_bf16 v[36:39], a[72:75], v[164:167], v[36:39]
    v_mul_f32 v32, v24, v32
    v_mul_f32 v33, v24, v33
    v_mfma_f32_16x16x32_bf16 v[36:39], a[68:71], v[148:151], v[36:39]
    ds_read_b64_tr_b16 a[200:201], v1 offset:0
    v_mul_f32 v34, v24, v34
    v_mfma_f32_16x16x32_bf16 v[36:39], a[64:67], v[132:135], v[36:39]
    v_mul_f32 v35, v24, v35
    v_cvt_pk_bf16_f32 v30, v32, v33
    v_mfma_f32_16x16x32_bf16 v[36:39], a[32:35], v[116:119], v[36:39]
    s_add_u32 m0, s25, 16960
    ds_read_b64_tr_b16 a[202:203], v1 offset:512
    v_cvt_pk_bf16_f32 v31, v34, v35
    v_mfma_f32_16x16x32_bf16 v[36:39], a[36:39], v[100:103], v[36:39]
    buffer_load_dwordx4 v5, s[16:19], s28 offen offset:2048 lds
    v_mfma_f32_16x16x32_bf16 v[36:39], a[40:43], v[84:87], v[36:39]
    ds_read_b64_tr_b16 a[116:117], v1 offset:4224
    v_mfma_f32_16x16x32_bf16 v[36:39], a[44:47], v[52:55], v[36:39]
    v_mfma_f32_16x16x32_bf16 v[36:39], a[48:51], a[156:159], v[36:39]
    ds_read_b64_tr_b16 a[118:119], v1 offset:4736
    v_mfma_f32_16x16x32_bf16 v[36:39], a[52:55], a[152:155], v[36:39]
    v_mfma_f32_16x16x32_bf16 v[36:39], a[56:59], a[148:151], v[36:39]
    s_xor_b32 s100, s99, 128
    ds_read_b64_tr_b16 a[204:205], v1 offset:8448
    v_mfma_f32_16x16x32_bf16 v[36:39], a[60:63], a[144:147], v[36:39]
    buffer_store_dwordx4 v[28:31], v8, s[20:23], s100 offen offset:64 sc1 nt
    v_mfma_f32_16x16x32_bf16 v[40:43], a[60:63], a[160:163], 0
    ds_read_b64_tr_b16 a[206:207], v1 offset:8960
    v_mfma_f32_16x16x32_bf16 v[40:43], a[56:59], a[164:167], v[40:43]
    v_mfma_f32_16x16x32_bf16 v[40:43], a[52:55], a[168:171], v[40:43]
    ds_read_b64_tr_b16 a[112:113], v1 offset:12672
    v_mfma_f32_16x16x32_bf16 v[40:43], a[48:51], v[44:47], v[40:43]
    v_mfma_f32_16x16x32_bf16 v[40:43], a[44:47], v[56:59], v[40:43]
    ds_read_b64_tr_b16 a[114:115], v1 offset:13184
    v_mfma_f32_16x16x32_bf16 v[40:43], a[40:43], v[88:91], v[40:43]
    v_mul_f32 v36, v25, v36
    v_mul_f32 v37, v25, v37
    v_mfma_f32_16x16x32_bf16 v[40:43], a[36:39], v[104:107], v[40:43]
    ds_read_b64_tr_b16 a[208:209], v2 offset:16896
    v_mul_f32 v38, v25, v38
    v_mfma_f32_16x16x32_bf16 v[40:43], a[32:35], v[120:123], v[40:43]
    v_mul_f32 v39, v25, v39
    v_cvt_pk_bf16_f32 v22, v36, v37
    v_mfma_f32_16x16x32_bf16 v[40:43], a[64:67], v[136:139], v[40:43]
    ds_read_b64_tr_b16 a[210:211], v2 offset:17408
    v_cvt_pk_bf16_f32 v23, v38, v39
    v_mfma_f32_16x16x32_bf16 v[40:43], a[68:71], v[152:155], v[40:43]
    v_mfma_f32_16x16x32_bf16 v[40:43], a[72:75], v[168:171], v[40:43]
    ds_read_b64_tr_b16 a[108:109], v2 offset:21120
    v_mfma_f32_16x16x32_bf16 v[40:43], a[76:79], v[184:187], v[40:43]
    v_mfma_f32_16x16x32_bf16 v[40:43], a[80:83], v[200:203], v[40:43]
    s_add_u32 m0, s25, 16968
    ds_read_b64_tr_b16 a[110:111], v2 offset:21632
    v_mfma_f32_16x16x32_bf16 v[40:43], a[84:87], v[216:219], v[40:43]
    buffer_load_dwordx4 v5, s[16:19], s28 offen offset:3072 lds
    v_mfma_f32_16x16x32_bf16 v[40:43], a[88:91], v[232:235], v[40:43]
    ds_read_b64_tr_b16 a[212:213], v2 offset:25344
    v_mfma_f32_16x16x32_bf16 v[40:43], a[92:95], v[248:251], v[40:43]
    v_mfma_f32_16x16x32_bf16 v[32:35], a[92:95], v[252:255], 0
    ds_read_b64_tr_b16 a[214:215], v2 offset:25856
    v_mfma_f32_16x16x32_bf16 v[32:35], a[88:91], v[236:239], v[32:35]
    s_xor_b32 s28, s98, 65920
    v_mfma_f32_16x16x32_bf16 v[32:35], a[84:87], v[220:223], v[32:35]
    s_add_u32 m0, s25, 33792
    ds_read_b64_tr_b16 a[104:105], v2 offset:29568
    v_mfma_f32_16x16x32_bf16 v[32:35], a[80:83], v[204:207], v[32:35]
    buffer_load_dwordx4 v5, s[16:19], s28 offen offset:0 lds
    v_mfma_f32_16x16x32_bf16 v[32:35], a[76:79], v[188:191], v[32:35]
    ds_read_b64_tr_b16 a[106:107], v2 offset:30080
    v_mfma_f32_16x16x32_bf16 v[32:35], a[72:75], v[172:175], v[32:35]
    v_mul_f32 v40, v26, v40
    v_mul_f32 v41, v26, v41
    v_mfma_f32_16x16x32_bf16 v[32:35], a[68:71], v[156:159], v[32:35]
    ds_read_b64_tr_b16 a[216:217], v2 offset:33792
    v_mul_f32 v42, v26, v42
    v_mfma_f32_16x16x32_bf16 v[32:35], a[64:67], v[140:143], v[32:35]
    v_mul_f32 v43, v26, v43
    v_cvt_pk_bf16_f32 v18, v40, v41
    v_mfma_f32_16x16x32_bf16 v[32:35], a[32:35], v[124:127], v[32:35]
    s_add_u32 m0, s25, 33800
    ds_read_b64_tr_b16 a[218:219], v2 offset:34304
    v_cvt_pk_bf16_f32 v19, v42, v43
    v_mfma_f32_16x16x32_bf16 v[32:35], a[36:39], v[108:111], v[32:35]
    buffer_load_dwordx4 v5, s[16:19], s28 offen offset:1024 lds
    v_mfma_f32_16x16x32_bf16 v[32:35], a[40:43], v[92:95], v[32:35]
    ds_read_b64_tr_b16 a[100:101], v2 offset:38016
    v_mfma_f32_16x16x32_bf16 v[32:35], a[44:47], v[76:79], v[32:35]
    v_mfma_f32_16x16x32_bf16 v[32:35], a[48:51], v[72:75], v[32:35]
    ds_read_b64_tr_b16 a[102:103], v2 offset:38528
    v_mfma_f32_16x16x32_bf16 v[32:35], a[52:55], v[68:71], v[32:35]
    v_mfma_f32_16x16x32_bf16 v[32:35], a[56:59], v[64:67], v[32:35]
    s_xor_b32 s100, s99, 8320
    ds_read_b64_tr_b16 a[220:221], v2 offset:42240
    v_mfma_f32_16x16x32_bf16 v[32:35], a[60:63], v[60:63], v[32:35]
    s_waitcnt lgkmcnt(4)
    buffer_store_dwordx4 v[20:23], v8, s[20:23], s100 offen offset:64 sc1 nt
    v_mfma_f32_16x16x32_bf16 v[36:39], a[192:195], a[128:131], 0
    ds_read_b64_tr_b16 a[222:223], v2 offset:42752
    v_mfma_f32_16x16x32_bf16 v[36:39], a[124:127], a[132:135], v[36:39]
    v_mfma_f32_16x16x32_bf16 v[36:39], a[196:199], a[136:139], v[36:39]
    ds_read_b64_tr_b16 a[96:97], v2 offset:46464
    v_mfma_f32_16x16x32_bf16 v[36:39], a[120:123], a[140:143], v[36:39]
    v_mfma_f32_16x16x32_bf16 v[36:39], a[200:203], v[48:51], v[36:39]
    ds_read_b64_tr_b16 a[98:99], v2 offset:46976
    v_mfma_f32_16x16x32_bf16 v[36:39], a[116:119], v[80:83], v[36:39]
    v_mul_f32 v32, v27, v32
    v_mul_f32 v33, v27, v33
    v_mfma_f32_16x16x32_bf16 v[36:39], a[204:207], v[96:99], v[36:39]
    ds_read_b64_tr_b16 a[188:189], v2 offset:8
    v_mul_f32 v34, v27, v34
    v_mfma_f32_16x16x32_bf16 v[36:39], a[112:115], v[112:115], v[36:39]
    v_mul_f32 v35, v27, v35
    v_cvt_pk_bf16_f32 v14, v32, v33
    v_mfma_f32_16x16x32_bf16 v[36:39], a[208:211], v[128:131], v[36:39]
    ds_read_b64_tr_b16 a[190:191], v2 offset:520
    v_cvt_pk_bf16_f32 v15, v34, v35
    v_mfma_f32_16x16x32_bf16 v[36:39], a[108:111], v[144:147], v[36:39]
    v_mfma_f32_16x16x32_bf16 v[36:39], a[212:215], v[160:163], v[36:39]
    ds_read_b64_tr_b16 a[184:185], v2 offset:4232
    v_mfma_f32_16x16x32_bf16 v[36:39], a[104:107], v[176:179], v[36:39]
    s_waitcnt lgkmcnt(4)
    v_mfma_f32_16x16x32_bf16 v[36:39], a[216:219], v[192:195], v[36:39]
    s_add_u32 m0, s25, 33856
    ds_read_b64_tr_b16 a[186:187], v2 offset:4744
    v_mfma_f32_16x16x32_bf16 v[36:39], a[100:103], v[208:211], v[36:39]
    buffer_load_dwordx4 v5, s[16:19], s28 offen offset:2048 lds
    v_mfma_f32_16x16x32_bf16 v[36:39], a[220:223], v[224:227], v[36:39]
    s_waitcnt lgkmcnt(3)
    ds_read_b64_tr_b16 a[180:181], v2 offset:8456
    v_mfma_f32_16x16x32_bf16 v[36:39], a[96:99], v[240:243], v[36:39]
    v_mfma_f32_16x16x32_bf16 v[40:43], a[96:99], v[244:247], 0
    ds_read_b64_tr_b16 a[182:183], v2 offset:8968
    v_mfma_f32_16x16x32_bf16 v[40:43], a[220:223], v[228:231], v[40:43]
    v_mfma_f32_16x16x32_bf16 v[40:43], a[100:103], v[212:215], v[40:43]
    s_add_u32 m0, s25, 33864
    ds_read_b64_tr_b16 a[176:177], v2 offset:12680
    v_mfma_f32_16x16x32_bf16 v[40:43], a[216:219], v[196:199], v[40:43]
    buffer_load_dwordx4 v5, s[16:19], s28 offen offset:3072 lds
    v_mfma_f32_16x16x32_bf16 v[40:43], a[104:107], v[180:183], v[40:43]
    ds_read_b64_tr_b16 a[178:179], v2 offset:13192
    v_mfma_f32_16x16x32_bf16 v[40:43], a[212:215], v[164:167], v[40:43]
    v_mul_f32 v36, v24, v36
    v_mul_f32 v37, v24, v37
    v_mfma_f32_16x16x32_bf16 v[40:43], a[108:111], v[148:151], v[40:43]
    ds_read_b64_tr_b16 a[172:173], v1 offset:8
    v_mul_f32 v38, v24, v38
    v_mfma_f32_16x16x32_bf16 v[40:43], a[208:211], v[132:135], v[40:43]
    s_xor_b32 s28, s98, 131456
    v_mul_f32 v39, v24, v39
    v_cvt_pk_bf16_f32 v28, v36, v37
    v_mfma_f32_16x16x32_bf16 v[40:43], a[112:115], v[116:119], v[40:43]
    s_add_u32 m0, s25, 118272
    ds_read_b64_tr_b16 a[174:175], v1 offset:520
    v_cvt_pk_bf16_f32 v29, v38, v39
    v_mfma_f32_16x16x32_bf16 v[40:43], a[204:207], v[100:103], v[40:43]
    buffer_load_dwordx4 v5, s[16:19], s28 offen offset:0 lds
    v_mfma_f32_16x16x32_bf16 v[40:43], a[116:119], v[84:87], v[40:43]
    ds_read_b64_tr_b16 a[232:233], v1 offset:4232
    v_mfma_f32_16x16x32_bf16 v[40:43], a[200:203], v[52:55], v[40:43]
    v_mfma_f32_16x16x32_bf16 v[40:43], a[120:123], a[156:159], v[40:43]
    ds_read_b64_tr_b16 a[234:235], v1 offset:4744
    v_mfma_f32_16x16x32_bf16 v[40:43], a[196:199], a[152:155], v[40:43]
    v_mfma_f32_16x16x32_bf16 v[40:43], a[124:127], a[148:151], v[40:43]
    s_xor_b32 s100, s99, 16512
    ds_read_b64_tr_b16 a[228:229], v1 offset:8456
    v_mfma_f32_16x16x32_bf16 v[40:43], a[192:195], a[144:147], v[40:43]
    buffer_store_dwordx4 v[16:19], v8, s[20:23], s100 offen offset:64 sc1 nt
    v_mfma_f32_16x16x32_bf16 v[32:35], a[192:195], a[160:163], 0
    ds_read_b64_tr_b16 a[230:231], v1 offset:8968
    v_mfma_f32_16x16x32_bf16 v[32:35], a[124:127], a[164:167], v[32:35]
    v_mfma_f32_16x16x32_bf16 v[32:35], a[196:199], a[168:171], v[32:35]
    ds_read_b64_tr_b16 a[224:225], v1 offset:12680
    v_mfma_f32_16x16x32_bf16 v[32:35], a[120:123], v[44:47], v[32:35]
    v_mfma_f32_16x16x32_bf16 v[32:35], a[200:203], v[56:59], v[32:35]
    ds_read_b64_tr_b16 a[226:227], v1 offset:13192
    v_mfma_f32_16x16x32_bf16 v[32:35], a[116:119], v[88:91], v[32:35]
    v_mul_f32 v40, v25, v40
    v_mul_f32 v41, v25, v41
    v_mfma_f32_16x16x32_bf16 v[32:35], a[204:207], v[104:107], v[32:35]
    ds_read_b64_tr_b16 a[0:1], v2 offset:16904
    v_mul_f32 v42, v25, v42
    v_mfma_f32_16x16x32_bf16 v[32:35], a[112:115], v[120:123], v[32:35]
    v_mul_f32 v43, v25, v43
    v_cvt_pk_bf16_f32 v20, v40, v41
    v_mfma_f32_16x16x32_bf16 v[32:35], a[208:211], v[136:139], v[32:35]
    ds_read_b64_tr_b16 a[2:3], v2 offset:17416
    v_cvt_pk_bf16_f32 v21, v42, v43
    v_mfma_f32_16x16x32_bf16 v[32:35], a[108:111], v[152:155], v[32:35]
    v_mfma_f32_16x16x32_bf16 v[32:35], a[212:215], v[168:171], v[32:35]
    ds_read_b64_tr_b16 a[4:5], v2 offset:21128
    v_mfma_f32_16x16x32_bf16 v[32:35], a[104:107], v[184:187], v[32:35]
    v_mfma_f32_16x16x32_bf16 v[32:35], a[216:219], v[200:203], v[32:35]
    s_add_u32 m0, s25, 118280
    ds_read_b64_tr_b16 a[6:7], v2 offset:21640
    v_mfma_f32_16x16x32_bf16 v[32:35], a[100:103], v[216:219], v[32:35]
    buffer_load_dwordx4 v5, s[16:19], s28 offen offset:1024 lds
    v_mfma_f32_16x16x32_bf16 v[32:35], a[220:223], v[232:235], v[32:35]
    ds_read_b64_tr_b16 a[8:9], v2 offset:25352
    v_mfma_f32_16x16x32_bf16 v[32:35], a[96:99], v[248:251], v[32:35]
    v_mfma_f32_16x16x32_bf16 v[36:39], a[96:99], v[252:255], 0
    ds_read_b64_tr_b16 a[10:11], v2 offset:25864
    v_mfma_f32_16x16x32_bf16 v[36:39], a[220:223], v[236:239], v[36:39]
    v_mfma_f32_16x16x32_bf16 v[36:39], a[100:103], v[220:223], v[36:39]
    s_add_u32 m0, s25, 118336
    ds_read_b64_tr_b16 a[12:13], v2 offset:29576
    v_mfma_f32_16x16x32_bf16 v[36:39], a[216:219], v[204:207], v[36:39]
    buffer_load_dwordx4 v5, s[16:19], s28 offen offset:2048 lds
    v_mfma_f32_16x16x32_bf16 v[36:39], a[104:107], v[188:191], v[36:39]
    ds_read_b64_tr_b16 a[14:15], v2 offset:30088
    v_mfma_f32_16x16x32_bf16 v[36:39], a[212:215], v[172:175], v[36:39]
    v_mul_f32 v32, v26, v32
    v_mul_f32 v33, v26, v33
    v_mfma_f32_16x16x32_bf16 v[36:39], a[108:111], v[156:159], v[36:39]
    ds_read_b64_tr_b16 a[16:17], v2 offset:33800
    v_mul_f32 v34, v26, v34
    v_mfma_f32_16x16x32_bf16 v[36:39], a[208:211], v[140:143], v[36:39]
    v_mul_f32 v35, v26, v35
    v_cvt_pk_bf16_f32 v16, v32, v33
    v_mfma_f32_16x16x32_bf16 v[36:39], a[112:115], v[124:127], v[36:39]
    s_add_u32 m0, s25, 118344
    ds_read_b64_tr_b16 a[18:19], v2 offset:34312
    v_cvt_pk_bf16_f32 v17, v34, v35
    v_mfma_f32_16x16x32_bf16 v[36:39], a[204:207], v[108:111], v[36:39]
    buffer_load_dwordx4 v5, s[16:19], s28 offen offset:3072 lds
    v_mfma_f32_16x16x32_bf16 v[36:39], a[116:119], v[92:95], v[36:39]
    ds_read_b64_tr_b16 a[20:21], v2 offset:38024
    v_mfma_f32_16x16x32_bf16 v[36:39], a[200:203], v[76:79], v[36:39]
    v_mfma_f32_16x16x32_bf16 v[36:39], a[120:123], v[72:75], v[36:39]
    ds_read_b64_tr_b16 a[22:23], v2 offset:38536
    v_mfma_f32_16x16x32_bf16 v[36:39], a[196:199], v[68:71], v[36:39]
    v_mfma_f32_16x16x32_bf16 v[36:39], a[124:127], v[64:67], v[36:39]
    s_xor_b32 s100, s99, 24704
    ds_read_b64_tr_b16 a[24:25], v2 offset:42248
    v_mfma_f32_16x16x32_bf16 v[36:39], a[192:195], v[60:63], v[36:39]
    s_waitcnt lgkmcnt(4)
    buffer_store_dwordx4 v[12:15], v8, s[20:23], s100 offen offset:64 sc1 nt
    v_mfma_f32_16x16x32_bf16 v[40:43], a[188:191], a[128:131], 0
    ds_read_b64_tr_b16 a[26:27], v2 offset:42760
    v_mfma_f32_16x16x32_bf16 v[40:43], a[184:187], a[132:135], v[40:43]
    v_mfma_f32_16x16x32_bf16 v[40:43], a[180:183], a[136:139], v[40:43]
    ds_read_b64_tr_b16 a[28:29], v2 offset:46472
    v_mfma_f32_16x16x32_bf16 v[40:43], a[176:179], a[140:143], v[40:43]
    v_mfma_f32_16x16x32_bf16 v[40:43], a[172:175], v[48:51], v[40:43]
    ds_read_b64_tr_b16 a[30:31], v2 offset:46984
    v_mfma_f32_16x16x32_bf16 v[40:43], a[232:235], v[80:83], v[40:43]
    v_mul_f32 v36, v27, v36
    v_mul_f32 v37, v27, v37
    v_mfma_f32_16x16x32_bf16 v[40:43], a[228:231], v[96:99], v[40:43]
    ds_read_b64_tr_b16 a[92:93], v2 offset:64
    v_mul_f32 v38, v27, v38
    v_mfma_f32_16x16x32_bf16 v[40:43], a[224:227], v[112:115], v[40:43]
    v_mul_f32 v39, v27, v39
    v_cvt_pk_bf16_f32 v12, v36, v37
    v_mfma_f32_16x16x32_bf16 v[40:43], a[0:3], v[128:131], v[40:43]
    ds_read_b64_tr_b16 a[94:95], v2 offset:576
    v_cvt_pk_bf16_f32 v13, v38, v39
    v_mfma_f32_16x16x32_bf16 v[40:43], a[4:7], v[144:147], v[40:43]
    v_mfma_f32_16x16x32_bf16 v[40:43], a[8:11], v[160:163], v[40:43]
    s_xor_b32 s28, s98, 196992
    ds_read_b64_tr_b16 a[88:89], v2 offset:4288
    v_mfma_f32_16x16x32_bf16 v[40:43], a[12:15], v[176:179], v[40:43]
    s_waitcnt lgkmcnt(4)
    v_mfma_f32_16x16x32_bf16 v[40:43], a[16:19], v[192:195], v[40:43]
    s_add_u32 m0, s25, 135168
    ds_read_b64_tr_b16 a[90:91], v2 offset:4800
    v_mfma_f32_16x16x32_bf16 v[40:43], a[20:23], v[208:211], v[40:43]
    buffer_load_dwordx4 v5, s[16:19], s28 offen offset:0 lds
    v_mfma_f32_16x16x32_bf16 v[40:43], a[24:27], v[224:227], v[40:43]
    s_waitcnt lgkmcnt(3)
    ds_read_b64_tr_b16 a[84:85], v2 offset:8512
    v_mfma_f32_16x16x32_bf16 v[40:43], a[28:31], v[240:243], v[40:43]
    v_mfma_f32_16x16x32_bf16 v[32:35], a[28:31], v[244:247], 0
    ds_read_b64_tr_b16 a[86:87], v2 offset:9024
    v_mfma_f32_16x16x32_bf16 v[32:35], a[24:27], v[228:231], v[32:35]
    v_mfma_f32_16x16x32_bf16 v[32:35], a[20:23], v[212:215], v[32:35]
    s_add_u32 m0, s25, 135176
    ds_read_b64_tr_b16 a[80:81], v2 offset:12736
    v_mfma_f32_16x16x32_bf16 v[32:35], a[16:19], v[196:199], v[32:35]
    buffer_load_dwordx4 v5, s[16:19], s28 offen offset:1024 lds
    v_mfma_f32_16x16x32_bf16 v[32:35], a[12:15], v[180:183], v[32:35]
    ds_read_b64_tr_b16 a[82:83], v2 offset:13248
    v_mfma_f32_16x16x32_bf16 v[32:35], a[8:11], v[164:167], v[32:35]
    v_mul_f32 v40, v24, v40
    v_mul_f32 v41, v24, v41
    v_mfma_f32_16x16x32_bf16 v[32:35], a[4:7], v[148:151], v[32:35]
    ds_read_b64_tr_b16 a[76:77], v1 offset:64
    v_mul_f32 v42, v24, v42
    v_mfma_f32_16x16x32_bf16 v[32:35], a[0:3], v[132:135], v[32:35]
    v_mul_f32 v43, v24, v43
    v_cvt_pk_bf16_f32 v30, v40, v41
    v_mfma_f32_16x16x32_bf16 v[32:35], a[224:227], v[116:119], v[32:35]
    s_add_u32 m0, s25, 135232
    ds_read_b64_tr_b16 a[78:79], v1 offset:576
    v_cvt_pk_bf16_f32 v31, v42, v43
    v_mfma_f32_16x16x32_bf16 v[32:35], a[228:231], v[100:103], v[32:35]
    buffer_load_dwordx4 v5, s[16:19], s28 offen offset:2048 lds
    v_mfma_f32_16x16x32_bf16 v[32:35], a[232:235], v[84:87], v[32:35]
    ds_read_b64_tr_b16 a[72:73], v1 offset:4288
    v_mfma_f32_16x16x32_bf16 v[32:35], a[172:175], v[52:55], v[32:35]
    v_mfma_f32_16x16x32_bf16 v[32:35], a[176:179], a[156:159], v[32:35]
    ds_read_b64_tr_b16 a[74:75], v1 offset:4800
    v_mfma_f32_16x16x32_bf16 v[32:35], a[180:183], a[152:155], v[32:35]
    v_mfma_f32_16x16x32_bf16 v[32:35], a[184:187], a[148:151], v[32:35]
    s_xor_b32 s100, s99, 256
    ds_read_b64_tr_b16 a[68:69], v1 offset:8512
    v_mfma_f32_16x16x32_bf16 v[32:35], a[188:191], a[144:147], v[32:35]
    buffer_store_dwordx4 v[28:31], v8, s[20:23], s100 offen offset:0 sc1 nt
    v_mfma_f32_16x16x32_bf16 v[36:39], a[188:191], a[160:163], 0
    ds_read_b64_tr_b16 a[70:71], v1 offset:9024
    v_mfma_f32_16x16x32_bf16 v[36:39], a[184:187], a[164:167], v[36:39]
    v_mfma_f32_16x16x32_bf16 v[36:39], a[180:183], a[168:171], v[36:39]
    ds_read_b64_tr_b16 a[64:65], v1 offset:12736
    v_mfma_f32_16x16x32_bf16 v[36:39], a[176:179], v[44:47], v[36:39]
    v_mfma_f32_16x16x32_bf16 v[36:39], a[172:175], v[56:59], v[36:39]
    ds_read_b64_tr_b16 a[66:67], v1 offset:13248
    v_mfma_f32_16x16x32_bf16 v[36:39], a[232:235], v[88:91], v[36:39]
    v_mul_f32 v32, v25, v32
    v_mul_f32 v33, v25, v33
    v_mfma_f32_16x16x32_bf16 v[36:39], a[228:231], v[104:107], v[36:39]
    ds_read_b64_tr_b16 a[32:33], v2 offset:16960
    v_mul_f32 v34, v25, v34
    v_mfma_f32_16x16x32_bf16 v[36:39], a[224:227], v[120:123], v[36:39]
    v_mul_f32 v35, v25, v35
    v_cvt_pk_bf16_f32 v22, v32, v33
    v_mfma_f32_16x16x32_bf16 v[36:39], a[0:3], v[136:139], v[36:39]
    ds_read_b64_tr_b16 a[34:35], v2 offset:17472
    v_cvt_pk_bf16_f32 v23, v34, v35
    v_mfma_f32_16x16x32_bf16 v[36:39], a[4:7], v[152:155], v[36:39]
    v_mfma_f32_16x16x32_bf16 v[36:39], a[8:11], v[168:171], v[36:39]
    ds_read_b64_tr_b16 a[36:37], v2 offset:21184
    v_mfma_f32_16x16x32_bf16 v[36:39], a[12:15], v[184:187], v[36:39]
    v_mfma_f32_16x16x32_bf16 v[36:39], a[16:19], v[200:203], v[36:39]
    s_add_u32 m0, s25, 135240
    ds_read_b64_tr_b16 a[38:39], v2 offset:21696
    v_mfma_f32_16x16x32_bf16 v[36:39], a[20:23], v[216:219], v[36:39]
    buffer_load_dwordx4 v5, s[16:19], s28 offen offset:3072 lds
    v_mfma_f32_16x16x32_bf16 v[36:39], a[24:27], v[232:235], v[36:39]
    ds_read_b64_tr_b16 a[40:41], v2 offset:25408
    v_mfma_f32_16x16x32_bf16 v[36:39], a[28:31], v[248:251], v[36:39]
    v_mfma_f32_16x16x32_bf16 v[40:43], a[28:31], v[252:255], 0
L_pad8:
    s_cbranch_vccnz L_warm_done
    ds_read_b64_tr_b16 a[42:43], v2 offset:25920
    v_mfma_f32_16x16x32_bf16 v[40:43], a[24:27], v[236:239], v[40:43]
    v_mfma_f32_16x16x32_bf16 v[40:43], a[20:23], v[220:223], v[40:43]
    ds_read_b64_tr_b16 a[44:45], v2 offset:29632
    v_mfma_f32_16x16x32_bf16 v[40:43], a[16:19], v[204:207], v[40:43]
    v_mfma_f32_16x16x32_bf16 v[40:43], a[12:15], v[188:191], v[40:43]
    ds_read_b64_tr_b16 a[46:47], v2 offset:30144
    v_mfma_f32_16x16x32_bf16 v[40:43], a[8:11], v[172:175], v[40:43]
    v_mul_f32 v36, v26, v36
    v_mul_f32 v37, v26, v37
    v_mfma_f32_16x16x32_bf16 v[40:43], a[4:7], v[156:159], v[40:43]
    ds_read_b64_tr_b16 a[48:49], v2 offset:33856
    v_mul_f32 v38, v26, v38
    v_mfma_f32_16x16x32_bf16 v[40:43], a[0:3], v[140:143], v[40:43]
    v_mul_f32 v39, v26, v39
    v_cvt_pk_bf16_f32 v18, v36, v37
    v_mfma_f32_16x16x32_bf16 v[40:43], a[224:227], v[124:127], v[40:43]
    ds_read_b64_tr_b16 a[50:51], v2 offset:34368
    v_cvt_pk_bf16_f32 v19, v38, v39
    v_mfma_f32_16x16x32_bf16 v[40:43], a[228:231], v[108:111], v[40:43]
    v_mfma_f32_16x16x32_bf16 v[40:43], a[232:235], v[92:95], v[40:43]
    ds_read_b64_tr_b16 a[52:53], v2 offset:38080
    v_mfma_f32_16x16x32_bf16 v[40:43], a[172:175], v[76:79], v[40:43]
    v_mfma_f32_16x16x32_bf16 v[40:43], a[176:179], v[72:75], v[40:43]
    ds_read_b64_tr_b16 a[54:55], v2 offset:38592
    v_mfma_f32_16x16x32_bf16 v[40:43], a[180:183], v[68:71], v[40:43]
    v_mfma_f32_16x16x32_bf16 v[40:43], a[184:187], v[64:67], v[40:43]
    s_xor_b32 s100, s99, 8448
    ds_read_b64_tr_b16 a[56:57], v2 offset:42304
    v_mfma_f32_16x16x32_bf16 v[40:43], a[188:191], v[60:63], v[40:43]
    s_waitcnt lgkmcnt(4)
    buffer_store_dwordx4 v[20:23], v8, s[20:23], s100 offen offset:0 sc1 nt
    v_mfma_f32_16x16x32_bf16 v[32:35], a[92:95], a[128:131], 0
    ds_read_b64_tr_b16 a[58:59], v2 offset:42816
    v_mfma_f32_16x16x32_bf16 v[32:35], a[88:91], a[132:135], v[32:35]
    v_mfma_f32_16x16x32_bf16 v[32:35], a[84:87], a[136:139], v[32:35]
    ds_read_b64_tr_b16 a[60:61], v2 offset:46528
    v_mfma_f32_16x16x32_bf16 v[32:35], a[80:83], a[140:143], v[32:35]
    v_mfma_f32_16x16x32_bf16 v[32:35], a[76:79], v[48:51], v[32:35]
    ds_read_b64_tr_b16 a[62:63], v2 offset:47040
    v_mfma_f32_16x16x32_bf16 v[32:35], a[72:75], v[80:83], v[32:35]
    v_mul_f32 v40, v27, v40
    v_mul_f32 v41, v27, v41
    v_mfma_f32_16x16x32_bf16 v[32:35], a[68:71], v[96:99], v[32:35]
    ds_read_b64_tr_b16 a[96:97], v2 offset:72
    v_mul_f32 v42, v27, v42
    v_mfma_f32_16x16x32_bf16 v[32:35], a[64:67], v[112:115], v[32:35]
    v_mul_f32 v43, v27, v43
    v_cvt_pk_bf16_f32 v14, v40, v41
    v_mfma_f32_16x16x32_bf16 v[32:35], a[32:35], v[128:131], v[32:35]
    ds_read_b64_tr_b16 a[98:99], v2 offset:584
    v_cvt_pk_bf16_f32 v15, v42, v43
    v_mfma_f32_16x16x32_bf16 v[32:35], a[36:39], v[144:147], v[32:35]
    v_mfma_f32_16x16x32_bf16 v[32:35], a[40:43], v[160:163], v[32:35]
    ds_read_b64_tr_b16 a[220:221], v2 offset:4296
    v_mfma_f32_16x16x32_bf16 v[32:35], a[44:47], v[176:179], v[32:35]
    s_waitcnt lgkmcnt(4)
    v_mfma_f32_16x16x32_bf16 v[32:35], a[48:51], v[192:195], v[32:35]
    ds_read_b64_tr_b16 a[222:223], v2 offset:4808
    v_mfma_f32_16x16x32_bf16 v[32:35], a[52:55], v[208:211], v[32:35]
    v_mfma_f32_16x16x32_bf16 v[32:35], a[56:59], v[224:227], v[32:35]
    s_waitcnt lgkmcnt(3)
    ds_read_b64_tr_b16 a[100:101], v2 offset:8520
    v_mfma_f32_16x16x32_bf16 v[32:35], a[60:63], v[240:243], v[32:35]
    v_mfma_f32_16x16x32_bf16 v[36:39], a[60:63], v[244:247], 0
    ds_read_b64_tr_b16 a[102:103], v2 offset:9032
    v_mfma_f32_16x16x32_bf16 v[36:39], a[56:59], v[228:231], v[36:39]
    v_mfma_f32_16x16x32_bf16 v[36:39], a[52:55], v[212:215], v[36:39]
    ds_read_b64_tr_b16 a[216:217], v2 offset:12744
    v_mfma_f32_16x16x32_bf16 v[36:39], a[48:51], v[196:199], v[36:39]
    v_mfma_f32_16x16x32_bf16 v[36:39], a[44:47], v[180:183], v[36:39]
    ds_read_b64_tr_b16 a[218:219], v2 offset:13256
    v_mfma_f32_16x16x32_bf16 v[36:39], a[40:43], v[164:167], v[36:39]
    v_mul_f32 v32, v24, v32
    v_mul_f32 v33, v24, v33
    v_mfma_f32_16x16x32_bf16 v[36:39], a[36:39], v[148:151], v[36:39]
    ds_read_b64_tr_b16 a[104:105], v1 offset:72
    v_mul_f32 v34, v24, v34
    v_mfma_f32_16x16x32_bf16 v[36:39], a[32:35], v[132:135], v[36:39]
    v_mul_f32 v35, v24, v35
    v_cvt_pk_bf16_f32 v28, v32, v33
    v_mfma_f32_16x16x32_bf16 v[36:39], a[64:67], v[116:119], v[36:39]
    ds_read_b64_tr_b16 a[106:107], v1 offset:584
    v_cvt_pk_bf16_f32 v29, v34, v35
    v_mfma_f32_16x16x32_bf16 v[36:39], a[68:71], v[100:103], v[36:39]
    v_mfma_f32_16x16x32_bf16 v[36:39], a[72:75], v[84:87], v[36:39]
    ds_read_b64_tr_b16 a[212:213], v1 offset:4296
    v_mfma_f32_16x16x32_bf16 v[36:39], a[76:79], v[52:55], v[36:39]
    v_mfma_f32_16x16x32_bf16 v[36:39], a[80:83], a[156:159], v[36:39]
    ds_read_b64_tr_b16 a[214:215], v1 offset:4808
    v_mfma_f32_16x16x32_bf16 v[36:39], a[84:87], a[152:155], v[36:39]
    v_mfma_f32_16x16x32_bf16 v[36:39], a[88:91], a[148:151], v[36:39]
    s_xor_b32 s100, s99, 16640
    ds_read_b64_tr_b16 a[108:109], v1 offset:8520
    v_mfma_f32_16x16x32_bf16 v[36:39], a[92:95], a[144:147], v[36:39]
    buffer_store_dwordx4 v[16:19], v8, s[20:23], s100 offen offset:0 sc1 nt
    v_mfma_f32_16x16x32_bf16 v[40:43], a[92:95], a[160:163], 0
    ds_read_b64_tr_b16 a[110:111], v1 offset:9032
    v_mfma_f32_16x16x32_bf16 v[40:43], a[88:91], a[164:167], v[40:43]
    v_mfma_f32_16x16x32_bf16 v[40:43], a[84:87], a[168:171], v[40:43]
    ds_read_b64_tr_b16 a[208:209], v1 offset:12744
    v_mfma_f32_16x16x32_bf16 v[40:43], a[80:83], v[44:47], v[40:43]
    v_mfma_f32_16x16x32_bf16 v[40:43], a[76:79], v[56:59], v[40:43]
    ds_read_b64_tr_b16 a[210:211], v1 offset:13256
    v_mfma_f32_16x16x32_bf16 v[40:43], a[72:75], v[88:91], v[40:43]
    v_mul_f32 v36, v25, v36
    v_mul_f32 v37, v25, v37
    v_mfma_f32_16x16x32_bf16 v[40:43], a[68:71], v[104:107], v[40:43]
    ds_read_b64_tr_b16 a[112:113], v2 offset:16968
    v_mul_f32 v38, v25, v38
    v_mfma_f32_16x16x32_bf16 v[40:43], a[64:67], v[120:123], v[40:43]
    v_mul_f32 v39, v25, v39
    v_cvt_pk_bf16_f32 v20, v36, v37
    v_mfma_f32_16x16x32_bf16 v[40:43], a[32:35], v[136:139], v[40:43]
    ds_read_b64_tr_b16 a[114:115], v2 offset:17480
    v_cvt_pk_bf16_f32 v21, v38, v39
    v_mfma_f32_16x16x32_bf16 v[40:43], a[36:39], v[152:155], v[40:43]
    v_mfma_f32_16x16x32_bf16 v[40:43], a[40:43], v[168:171], v[40:43]
    ds_read_b64_tr_b16 a[204:205], v2 offset:21192
    v_mfma_f32_16x16x32_bf16 v[40:43], a[44:47], v[184:187], v[40:43]
    v_mfma_f32_16x16x32_bf16 v[40:43], a[48:51], v[200:203], v[40:43]
    ds_read_b64_tr_b16 a[206:207], v2 offset:21704
    v_mfma_f32_16x16x32_bf16 v[40:43], a[52:55], v[216:219], v[40:43]
    v_mfma_f32_16x16x32_bf16 v[40:43], a[56:59], v[232:235], v[40:43]
    ds_read_b64_tr_b16 a[116:117], v2 offset:25416
    v_mfma_f32_16x16x32_bf16 v[40:43], a[60:63], v[248:251], v[40:43]
    v_mfma_f32_16x16x32_bf16 v[32:35], a[60:63], v[252:255], 0
    ds_read_b64_tr_b16 a[118:119], v2 offset:25928
    v_mfma_f32_16x16x32_bf16 v[32:35], a[56:59], v[236:239], v[32:35]
    v_mfma_f32_16x16x32_bf16 v[32:35], a[52:55], v[220:223], v[32:35]
    ds_read_b64_tr_b16 a[200:201], v2 offset:29640
    v_mfma_f32_16x16x32_bf16 v[32:35], a[48:51], v[204:207], v[32:35]
    v_mfma_f32_16x16x32_bf16 v[32:35], a[44:47], v[188:191], v[32:35]
    ds_read_b64_tr_b16 a[202:203], v2 offset:30152
    v_mfma_f32_16x16x32_bf16 v[32:35], a[40:43], v[172:175], v[32:35]
    v_mul_f32 v40, v26, v40
    v_mul_f32 v41, v26, v41
    v_mfma_f32_16x16x32_bf16 v[32:35], a[36:39], v[156:159], v[32:35]
    ds_read_b64_tr_b16 a[120:121], v2 offset:33864
    v_mul_f32 v42, v26, v42
    v_mfma_f32_16x16x32_bf16 v[32:35], a[32:35], v[140:143], v[32:35]
    v_mul_f32 v43, v26, v43
    v_cvt_pk_bf16_f32 v16, v40, v41
    v_mfma_f32_16x16x32_bf16 v[32:35], a[64:67], v[124:127], v[32:35]
    ds_read_b64_tr_b16 a[122:123], v2 offset:34376
    v_cvt_pk_bf16_f32 v17, v42, v43
    v_mfma_f32_16x16x32_bf16 v[32:35], a[68:71], v[108:111], v[32:35]
    v_mfma_f32_16x16x32_bf16 v[32:35], a[72:75], v[92:95], v[32:35]
    ds_read_b64_tr_b16 a[196:197], v2 offset:38088
    v_mfma_f32_16x16x32_bf16 v[32:35], a[76:79], v[76:79], v[32:35]
    v_mfma_f32_16x16x32_bf16 v[32:35], a[80:83], v[72:75], v[32:35]
    ds_read_b64_tr_b16 a[198:199], v2 offset:38600
    v_mfma_f32_16x16x32_bf16 v[32:35], a[84:87], v[68:71], v[32:35]
    v_mfma_f32_16x16x32_bf16 v[32:35], a[88:91], v[64:67], v[32:35]
    s_xor_b32 s100, s99, 24832
    ds_read_b64_tr_b16 a[124:125], v2 offset:42312
    v_mfma_f32_16x16x32_bf16 v[32:35], a[92:95], v[60:63], v[32:35]
    s_waitcnt lgkmcnt(4)
    buffer_store_dwordx4 v[12:15], v8, s[20:23], s100 offen offset:0 sc1 nt
    v_mfma_f32_16x16x32_bf16 v[36:39], a[96:99], a[128:131], 0
    ds_read_b64_tr_b16 a[126:127], v2 offset:42824
    v_mfma_f32_16x16x32_bf16 v[36:39], a[220:223], a[132:135], v[36:39]
    v_mfma_f32_16x16x32_bf16 v[36:39], a[100:103], a[136:139], v[36:39]
    ds_read_b64_tr_b16 a[192:193], v2 offset:46536
    v_mfma_f32_16x16x32_bf16 v[36:39], a[216:219], a[140:143], v[36:39]
    v_mfma_f32_16x16x32_bf16 v[36:39], a[104:107], v[48:51], v[36:39]
    ds_read_b64_tr_b16 a[194:195], v2 offset:47048
    v_mfma_f32_16x16x32_bf16 v[36:39], a[212:215], v[80:83], v[36:39]
    s_waitcnt vmcnt(3) lgkmcnt(4)
    v_mul_f32 v32, v27, v32
    v_mul_f32 v33, v27, v33
    v_mfma_f32_16x16x32_bf16 v[36:39], a[108:111], v[96:99], v[36:39]
    s_barrier
    ds_read_b64_tr_b16 a[28:29], v1 offset:16896
    v_mul_f32 v34, v27, v34
    v_mfma_f32_16x16x32_bf16 v[36:39], a[208:211], v[112:115], v[36:39]
    v_mul_f32 v35, v27, v35
    v_cvt_pk_bf16_f32 v12, v32, v33
    v_mfma_f32_16x16x32_bf16 v[36:39], a[112:115], v[128:131], v[36:39]
    ds_read_b64_tr_b16 a[30:31], v1 offset:17408
    v_cvt_pk_bf16_f32 v13, v34, v35
    v_mfma_f32_16x16x32_bf16 v[36:39], a[204:207], v[144:147], v[36:39]
    v_mfma_f32_16x16x32_bf16 v[36:39], a[116:119], v[160:163], v[36:39]
    ds_read_b64_tr_b16 a[24:25], v1 offset:21120
    v_mfma_f32_16x16x32_bf16 v[36:39], a[200:203], v[176:179], v[36:39]
    v_mfma_f32_16x16x32_bf16 v[36:39], a[120:123], v[192:195], v[36:39]
    ds_read_b64_tr_b16 a[26:27], v1 offset:21632
    v_mfma_f32_16x16x32_bf16 v[36:39], a[196:199], v[208:211], v[36:39]
    s_waitcnt lgkmcnt(4)
    v_mfma_f32_16x16x32_bf16 v[36:39], a[124:127], v[224:227], v[36:39]
    ds_read_b64_tr_b16 a[20:21], v1 offset:25344
    v_mfma_f32_16x16x32_bf16 v[36:39], a[192:195], v[240:243], v[36:39]
    v_mfma_f32_16x16x32_bf16 v[40:43], a[192:195], v[244:247], 0
    ds_read_b64_tr_b16 a[22:23], v1 offset:25856
    v_mfma_f32_16x16x32_bf16 v[40:43], a[124:127], v[228:231], v[40:43]
    v_mfma_f32_16x16x32_bf16 v[40:43], a[196:199], v[212:215], v[40:43]
    ds_read_b64_tr_b16 a[16:17], v1 offset:29568
    v_mfma_f32_16x16x32_bf16 v[40:43], a[120:123], v[196:199], v[40:43]
    v_mfma_f32_16x16x32_bf16 v[40:43], a[200:203], v[180:183], v[40:43]
    ds_read_b64_tr_b16 a[18:19], v1 offset:30080
    v_mfma_f32_16x16x32_bf16 v[40:43], a[116:119], v[164:167], v[40:43]
    v_mul_f32 v36, v24, v36
    v_mul_f32 v37, v24, v37
    v_mfma_f32_16x16x32_bf16 v[40:43], a[204:207], v[148:151], v[40:43]
    ds_read_b64_tr_b16 a[12:13], v1 offset:33792
    v_mul_f32 v38, v24, v38
    v_mfma_f32_16x16x32_bf16 v[40:43], a[112:115], v[132:135], v[40:43]
    v_mul_f32 v39, v24, v39
    v_cvt_pk_bf16_f32 v30, v36, v37
    v_mfma_f32_16x16x32_bf16 v[40:43], a[208:211], v[116:119], v[40:43]
    ds_read_b64_tr_b16 a[14:15], v1 offset:34304
    v_cvt_pk_bf16_f32 v31, v38, v39
    v_mfma_f32_16x16x32_bf16 v[40:43], a[108:111], v[100:103], v[40:43]
    v_mfma_f32_16x16x32_bf16 v[40:43], a[212:215], v[84:87], v[40:43]
    ds_read_b64_tr_b16 a[8:9], v1 offset:38016
    v_mfma_f32_16x16x32_bf16 v[40:43], a[104:107], v[52:55], v[40:43]
    v_mfma_f32_16x16x32_bf16 v[40:43], a[216:219], a[156:159], v[40:43]
    ds_read_b64_tr_b16 a[10:11], v1 offset:38528
    v_mfma_f32_16x16x32_bf16 v[40:43], a[100:103], a[152:155], v[40:43]
    v_mfma_f32_16x16x32_bf16 v[40:43], a[220:223], a[148:151], v[40:43]
    s_xor_b32 s100, s99, 256
    ds_read_b64_tr_b16 a[4:5], v1 offset:42240
    v_mfma_f32_16x16x32_bf16 v[40:43], a[96:99], a[144:147], v[40:43]
    buffer_store_dwordx4 v[28:31], v8, s[20:23], s100 offen offset:64 sc1 nt
    v_mfma_f32_16x16x32_bf16 v[32:35], a[96:99], a[160:163], 0
    ds_read_b64_tr_b16 a[6:7], v1 offset:42752
    v_mfma_f32_16x16x32_bf16 v[32:35], a[220:223], a[164:167], v[32:35]
    v_mfma_f32_16x16x32_bf16 v[32:35], a[100:103], a[168:171], v[32:35]
    ds_read_b64_tr_b16 a[0:1], v1 offset:46464
    v_mfma_f32_16x16x32_bf16 v[32:35], a[216:219], v[44:47], v[32:35]
    v_mfma_f32_16x16x32_bf16 v[32:35], a[104:107], v[56:59], v[32:35]
    ds_read_b64_tr_b16 a[2:3], v1 offset:46976
    v_mfma_f32_16x16x32_bf16 v[32:35], a[212:215], v[88:91], v[32:35]
    v_mul_f32 v40, v25, v40
    v_mul_f32 v41, v25, v41
    v_mfma_f32_16x16x32_bf16 v[32:35], a[108:111], v[104:107], v[32:35]
    ds_read_b64_tr_b16 a[224:225], v2 offset:50688
    v_mul_f32 v42, v25, v42
    v_mfma_f32_16x16x32_bf16 v[32:35], a[208:211], v[120:123], v[32:35]
    v_mul_f32 v43, v25, v43
    v_cvt_pk_bf16_f32 v22, v40, v41
    v_mfma_f32_16x16x32_bf16 v[32:35], a[112:115], v[136:139], v[32:35]
    ds_read_b64_tr_b16 a[226:227], v2 offset:51200
    v_cvt_pk_bf16_f32 v23, v42, v43
    v_mfma_f32_16x16x32_bf16 v[32:35], a[204:207], v[152:155], v[32:35]
    v_mfma_f32_16x16x32_bf16 v[32:35], a[116:119], v[168:171], v[32:35]
    ds_read_b64_tr_b16 a[228:229], v2 offset:54912
    v_mfma_f32_16x16x32_bf16 v[32:35], a[200:203], v[184:187], v[32:35]
    v_mfma_f32_16x16x32_bf16 v[32:35], a[120:123], v[200:203], v[32:35]
    ds_read_b64_tr_b16 a[230:231], v2 offset:55424
    v_mfma_f32_16x16x32_bf16 v[32:35], a[196:199], v[216:219], v[32:35]
    v_mfma_f32_16x16x32_bf16 v[32:35], a[124:127], v[232:235], v[32:35]
    ds_read_b64_tr_b16 a[232:233], v2 offset:59136
    v_mfma_f32_16x16x32_bf16 v[32:35], a[192:195], v[248:251], v[32:35]
    v_mfma_f32_16x16x32_bf16 v[36:39], a[192:195], v[252:255], 0
    ds_read_b64_tr_b16 a[234:235], v2 offset:59648
    v_mfma_f32_16x16x32_bf16 v[36:39], a[124:127], v[236:239], v[36:39]
    v_mfma_f32_16x16x32_bf16 v[36:39], a[196:199], v[220:223], v[36:39]
    ds_read_b64_tr_b16 a[172:173], v2 offset:63360
    v_mfma_f32_16x16x32_bf16 v[36:39], a[120:123], v[204:207], v[36:39]
    v_mfma_f32_16x16x32_bf16 v[36:39], a[200:203], v[188:191], v[36:39]
    ds_read_b64_tr_b16 a[174:175], v2 offset:63872
    v_mfma_f32_16x16x32_bf16 v[36:39], a[116:119], v[172:175], v[36:39]
    v_mul_f32 v32, v26, v32
    v_mul_f32 v33, v26, v33
    v_mfma_f32_16x16x32_bf16 v[36:39], a[204:207], v[156:159], v[36:39]
    ds_read_b64_tr_b16 a[176:177], v3 offset:0
    v_mul_f32 v34, v26, v34
    v_mfma_f32_16x16x32_bf16 v[36:39], a[112:115], v[140:143], v[36:39]
    v_mul_f32 v35, v26, v35
    v_cvt_pk_bf16_f32 v18, v32, v33
    v_mfma_f32_16x16x32_bf16 v[36:39], a[208:211], v[124:127], v[36:39]
    ds_read_b64_tr_b16 a[178:179], v3 offset:512
    v_cvt_pk_bf16_f32 v19, v34, v35
    v_mfma_f32_16x16x32_bf16 v[36:39], a[108:111], v[108:111], v[36:39]
    v_mfma_f32_16x16x32_bf16 v[36:39], a[212:215], v[92:95], v[36:39]
    ds_read_b64_tr_b16 a[180:181], v3 offset:4224
    v_mfma_f32_16x16x32_bf16 v[36:39], a[104:107], v[76:79], v[36:39]
    v_mfma_f32_16x16x32_bf16 v[36:39], a[216:219], v[72:75], v[36:39]
    ds_read_b64_tr_b16 a[182:183], v3 offset:4736
    v_mfma_f32_16x16x32_bf16 v[36:39], a[100:103], v[68:71], v[36:39]
    v_mfma_f32_16x16x32_bf16 v[36:39], a[220:223], v[64:67], v[36:39]
    s_xor_b32 s100, s99, 8448
    ds_read_b64_tr_b16 a[184:185], v3 offset:8448
    v_mfma_f32_16x16x32_bf16 v[36:39], a[96:99], v[60:63], v[36:39]
    s_waitcnt lgkmcnt(4)
    buffer_store_dwordx4 v[20:23], v8, s[20:23], s100 offen offset:64 sc1 nt
    v_mfma_f32_16x16x32_bf16 v[40:43], a[28:31], a[128:131], 0
    ds_read_b64_tr_b16 a[186:187], v3 offset:8960
    v_mfma_f32_16x16x32_bf16 v[40:43], a[24:27], a[132:135], v[40:43]
    v_mfma_f32_16x16x32_bf16 v[40:43], a[20:23], a[136:139], v[40:43]
    ds_read_b64_tr_b16 a[188:189], v3 offset:12672
    v_mfma_f32_16x16x32_bf16 v[40:43], a[16:19], a[140:143], v[40:43]
    v_mfma_f32_16x16x32_bf16 v[40:43], a[12:15], v[48:51], v[40:43]
    ds_read_b64_tr_b16 a[190:191], v3 offset:13184
    v_mfma_f32_16x16x32_bf16 v[40:43], a[8:11], v[80:83], v[40:43]
    v_mul_f32 v36, v27, v36
    v_mul_f32 v37, v27, v37
    v_mfma_f32_16x16x32_bf16 v[40:43], a[4:7], v[96:99], v[40:43]
    ds_read_b64_tr_b16 a[60:61], v1 offset:16904
    v_mul_f32 v38, v27, v38
    v_mfma_f32_16x16x32_bf16 v[40:43], a[0:3], v[112:115], v[40:43]
    v_mul_f32 v39, v27, v39
    v_cvt_pk_bf16_f32 v14, v36, v37
    v_mfma_f32_16x16x32_bf16 v[40:43], a[224:227], v[128:131], v[40:43]
    ds_read_b64_tr_b16 a[62:63], v1 offset:17416
    v_cvt_pk_bf16_f32 v15, v38, v39
    v_mfma_f32_16x16x32_bf16 v[40:43], a[228:231], v[144:147], v[40:43]
    v_mfma_f32_16x16x32_bf16 v[40:43], a[232:235], v[160:163], v[40:43]
    ds_read_b64_tr_b16 a[56:57], v1 offset:21128
    v_mfma_f32_16x16x32_bf16 v[40:43], a[172:175], v[176:179], v[40:43]
    s_waitcnt lgkmcnt(4)
    v_mfma_f32_16x16x32_bf16 v[40:43], a[176:179], v[192:195], v[40:43]
    ds_read_b64_tr_b16 a[58:59], v1 offset:21640
    v_mfma_f32_16x16x32_bf16 v[40:43], a[180:183], v[208:211], v[40:43]
    v_mfma_f32_16x16x32_bf16 v[40:43], a[184:187], v[224:227], v[40:43]
    s_waitcnt lgkmcnt(3)
    ds_read_b64_tr_b16 a[52:53], v1 offset:25352
    v_mfma_f32_16x16x32_bf16 v[40:43], a[188:191], v[240:243], v[40:43]
    v_mfma_f32_16x16x32_bf16 v[32:35], a[188:191], v[244:247], 0
    ds_read_b64_tr_b16 a[54:55], v1 offset:25864
    v_mfma_f32_16x16x32_bf16 v[32:35], a[184:187], v[228:231], v[32:35]
    v_mfma_f32_16x16x32_bf16 v[32:35], a[180:183], v[212:215], v[32:35]
    ds_read_b64_tr_b16 a[48:49], v1 offset:29576
    v_mfma_f32_16x16x32_bf16 v[32:35], a[176:179], v[196:199], v[32:35]
    v_mfma_f32_16x16x32_bf16 v[32:35], a[172:175], v[180:183], v[32:35]
    ds_read_b64_tr_b16 a[50:51], v1 offset:30088
    v_mfma_f32_16x16x32_bf16 v[32:35], a[232:235], v[164:167], v[32:35]
    v_mul_f32 v40, v24, v40
    v_mul_f32 v41, v24, v41
    v_mfma_f32_16x16x32_bf16 v[32:35], a[228:231], v[148:151], v[32:35]
    ds_read_b64_tr_b16 a[44:45], v1 offset:33800
    v_mul_f32 v42, v24, v42
    v_mfma_f32_16x16x32_bf16 v[32:35], a[224:227], v[132:135], v[32:35]
    v_mul_f32 v43, v24, v43
    v_cvt_pk_bf16_f32 v28, v40, v41
    v_mfma_f32_16x16x32_bf16 v[32:35], a[0:3], v[116:119], v[32:35]
    ds_read_b64_tr_b16 a[46:47], v1 offset:34312
    v_cvt_pk_bf16_f32 v29, v42, v43
    v_mfma_f32_16x16x32_bf16 v[32:35], a[4:7], v[100:103], v[32:35]
    v_mfma_f32_16x16x32_bf16 v[32:35], a[8:11], v[84:87], v[32:35]
    ds_read_b64_tr_b16 a[40:41], v1 offset:38024
    v_mfma_f32_16x16x32_bf16 v[32:35], a[12:15], v[52:55], v[32:35]
    v_mfma_f32_16x16x32_bf16 v[32:35], a[16:19], a[156:159], v[32:35]
    ds_read_b64_tr_b16 a[42:43], v1 offset:38536
    v_mfma_f32_16x16x32_bf16 v[32:35], a[20:23], a[152:155], v[32:35]
    v_mfma_f32_16x16x32_bf16 v[32:35], a[24:27], a[148:151], v[32:35]
    s_xor_b32 s100, s99, 16640
    ds_read_b64_tr_b16 a[36:37], v1 offset:42248
    v_mfma_f32_16x16x32_bf16 v[32:35], a[28:31], a[144:147], v[32:35]
    buffer_store_dwordx4 v[16:19], v8, s[20:23], s100 offen offset:64 sc1 nt
    v_mfma_f32_16x16x32_bf16 v[36:39], a[28:31], a[160:163], 0
    ds_read_b64_tr_b16 a[38:39], v1 offset:42760
    v_mfma_f32_16x16x32_bf16 v[36:39], a[24:27], a[164:167], v[36:39]
    v_mfma_f32_16x16x32_bf16 v[36:39], a[20:23], a[168:171], v[36:39]
    ds_read_b64_tr_b16 a[32:33], v1 offset:46472
    v_mfma_f32_16x16x32_bf16 v[36:39], a[16:19], v[44:47], v[36:39]
    v_mfma_f32_16x16x32_bf16 v[36:39], a[12:15], v[56:59], v[36:39]
    ds_read_b64_tr_b16 a[34:35], v1 offset:46984
    v_mfma_f32_16x16x32_bf16 v[36:39], a[8:11], v[88:91], v[36:39]
    v_mul_f32 v32, v25, v32
    v_mul_f32 v33, v25, v33
    v_mfma_f32_16x16x32_bf16 v[36:39], a[4:7], v[104:107], v[36:39]
    ds_read_b64_tr_b16 a[64:65], v2 offset:50696
    v_mul_f32 v34, v25, v34
    v_mfma_f32_16x16x32_bf16 v[36:39], a[0:3], v[120:123], v[36:39]
    v_mul_f32 v35, v25, v35
    v_cvt_pk_bf16_f32 v20, v32, v33
    v_mfma_f32_16x16x32_bf16 v[36:39], a[224:227], v[136:139], v[36:39]
    ds_read_b64_tr_b16 a[66:67], v2 offset:51208
    v_cvt_pk_bf16_f32 v21, v34, v35
    v_mfma_f32_16x16x32_bf16 v[36:39], a[228:231], v[152:155], v[36:39]
    v_mfma_f32_16x16x32_bf16 v[36:39], a[232:235], v[168:171], v[36:39]
    ds_read_b64_tr_b16 a[68:69], v2 offset:54920
    v_mfma_f32_16x16x32_bf16 v[36:39], a[172:175], v[184:187], v[36:39]
    v_mfma_f32_16x16x32_bf16 v[36:39], a[176:179], v[200:203], v[36:39]
    ds_read_b64_tr_b16 a[70:71], v2 offset:55432
    v_mfma_f32_16x16x32_bf16 v[36:39], a[180:183], v[216:219], v[36:39]
    v_mfma_f32_16x16x32_bf16 v[36:39], a[184:187], v[232:235], v[36:39]
    ds_read_b64_tr_b16 a[72:73], v2 offset:59144
    v_mfma_f32_16x16x32_bf16 v[36:39], a[188:191], v[248:251], v[36:39]
    v_mfma_f32_16x16x32_bf16 v[40:43], a[188:191], v[252:255], 0
    ds_read_b64_tr_b16 a[74:75], v2 offset:59656
    v_mfma_f32_16x16x32_bf16 v[40:43], a[184:187], v[236:239], v[40:43]
    v_mfma_f32_16x16x32_bf16 v[40:43], a[180:183], v[220:223], v[40:43]
    ds_read_b64_tr_b16 a[76:77], v2 offset:63368
    v_mfma_f32_16x16x32_bf16 v[40:43], a[176:179], v[204:207], v[40:43]
    v_mfma_f32_16x16x32_bf16 v[40:43], a[172:175], v[188:191], v[40:43]
    ds_read_b64_tr_b16 a[78:79], v2 offset:63880
    v_mfma_f32_16x16x32_bf16 v[40:43], a[232:235], v[172:175], v[40:43]
    v_mul_f32 v36, v26, v36
    v_mul_f32 v37, v26, v37
    v_mfma_f32_16x16x32_bf16 v[40:43], a[228:231], v[156:159], v[40:43]
    ds_read_b64_tr_b16 a[80:81], v3 offset:8
    v_mul_f32 v38, v26, v38
    v_mfma_f32_16x16x32_bf16 v[40:43], a[224:227], v[140:143], v[40:43]
    v_mul_f32 v39, v26, v39
    v_cvt_pk_bf16_f32 v16, v36, v37
    v_mfma_f32_16x16x32_bf16 v[40:43], a[0:3], v[124:127], v[40:43]
    ds_read_b64_tr_b16 a[82:83], v3 offset:520
    v_cvt_pk_bf16_f32 v17, v38, v39
    v_mfma_f32_16x16x32_bf16 v[40:43], a[4:7], v[108:111], v[40:43]
    v_mfma_f32_16x16x32_bf16 v[40:43], a[8:11], v[92:95], v[40:43]
    ds_read_b64_tr_b16 a[84:85], v3 offset:4232
    v_mfma_f32_16x16x32_bf16 v[40:43], a[12:15], v[76:79], v[40:43]
    v_mfma_f32_16x16x32_bf16 v[40:43], a[16:19], v[72:75], v[40:43]
    ds_read_b64_tr_b16 a[86:87], v3 offset:4744
    v_mfma_f32_16x16x32_bf16 v[40:43], a[20:23], v[68:71], v[40:43]
    v_mfma_f32_16x16x32_bf16 v[40:43], a[24:27], v[64:67], v[40:43]
    s_xor_b32 s100, s99, 24832
    ds_read_b64_tr_b16 a[88:89], v3 offset:8456
    v_mfma_f32_16x16x32_bf16 v[40:43], a[28:31], v[60:63], v[40:43]
    s_waitcnt lgkmcnt(4)
    buffer_store_dwordx4 v[12:15], v8, s[20:23], s100 offen offset:64 sc1 nt
    v_mfma_f32_16x16x32_bf16 v[32:35], a[60:63], a[128:131], 0
    ds_read_b64_tr_b16 a[90:91], v3 offset:8968
    v_mfma_f32_16x16x32_bf16 v[32:35], a[56:59], a[132:135], v[32:35]
    v_mfma_f32_16x16x32_bf16 v[32:35], a[52:55], a[136:139], v[32:35]
    ds_read_b64_tr_b16 a[92:93], v3 offset:12680
    v_mfma_f32_16x16x32_bf16 v[32:35], a[48:51], a[140:143], v[32:35]
    v_mfma_f32_16x16x32_bf16 v[32:35], a[44:47], v[48:51], v[32:35]
    ds_read_b64_tr_b16 a[94:95], v3 offset:13192
    v_mfma_f32_16x16x32_bf16 v[32:35], a[40:43], v[80:83], v[32:35]
    v_mul_f32 v40, v27, v40
    v_mul_f32 v41, v27, v41
    v_mfma_f32_16x16x32_bf16 v[32:35], a[36:39], v[96:99], v[32:35]
    v_mul_f32 v42, v27, v42
    v_mul_f32 v43, v27, v43
    v_mfma_f32_16x16x32_bf16 v[32:35], a[32:35], v[112:115], v[32:35]
    ds_read_b64_tr_b16 a[192:193], v1 offset:16960
    v_cvt_pk_bf16_f32 v12, v40, v41
    v_mfma_f32_16x16x32_bf16 v[32:35], a[64:67], v[128:131], v[32:35]
    ds_read_b64_tr_b16 a[194:195], v1 offset:17472
    v_cvt_pk_bf16_f32 v13, v42, v43
    v_mfma_f32_16x16x32_bf16 v[32:35], a[68:71], v[144:147], v[32:35]
    ds_read_b64_tr_b16 a[124:125], v1 offset:21184
    v_mfma_f32_16x16x32_bf16 v[32:35], a[72:75], v[160:163], v[32:35]
    v_mfma_f32_16x16x32_bf16 v[32:35], a[76:79], v[176:179], v[32:35]
    s_waitcnt lgkmcnt(4)
    ds_read_b64_tr_b16 a[126:127], v1 offset:21696
    v_mfma_f32_16x16x32_bf16 v[32:35], a[80:83], v[192:195], v[32:35]
    ds_read_b64_tr_b16 a[196:197], v1 offset:25408
    v_mfma_f32_16x16x32_bf16 v[32:35], a[84:87], v[208:211], v[32:35]
    v_mfma_f32_16x16x32_bf16 v[32:35], a[88:91], v[224:227], v[32:35]
    s_waitcnt lgkmcnt(5)
    ds_read_b64_tr_b16 a[198:199], v1 offset:25920
    v_mfma_f32_16x16x32_bf16 v[32:35], a[92:95], v[240:243], v[32:35]
    ds_read_b64_tr_b16 a[120:121], v1 offset:29632
    v_mfma_f32_16x16x32_bf16 v[36:39], a[92:95], v[244:247], 0
    v_mfma_f32_16x16x32_bf16 v[36:39], a[88:91], v[228:231], v[36:39]
    ds_read_b64_tr_b16 a[122:123], v1 offset:30144
    v_mfma_f32_16x16x32_bf16 v[36:39], a[84:87], v[212:215], v[36:39]
    ds_read_b64_tr_b16 a[200:201], v1 offset:33856
    v_mfma_f32_16x16x32_bf16 v[36:39], a[80:83], v[196:199], v[36:39]
    v_mfma_f32_16x16x32_bf16 v[36:39], a[76:79], v[180:183], v[36:39]
    ds_read_b64_tr_b16 a[202:203], v1 offset:34368
    v_mfma_f32_16x16x32_bf16 v[36:39], a[72:75], v[164:167], v[36:39]
    ds_read_b64_tr_b16 a[116:117], v1 offset:38080
    v_mul_f32 v32, v24, v32
    v_mfma_f32_16x16x32_bf16 v[36:39], a[68:71], v[148:151], v[36:39]
    ds_read_b64_tr_b16 a[118:119], v1 offset:38592
    v_mul_f32 v33, v24, v33
    v_mfma_f32_16x16x32_bf16 v[36:39], a[64:67], v[132:135], v[36:39]
    v_mul_f32 v34, v24, v34
    v_mul_f32 v35, v24, v35
    v_mfma_f32_16x16x32_bf16 v[36:39], a[32:35], v[116:119], v[36:39]
    ds_read_b64_tr_b16 a[204:205], v1 offset:42304
    v_cvt_pk_bf16_f32 v30, v32, v33
    v_mfma_f32_16x16x32_bf16 v[36:39], a[36:39], v[100:103], v[36:39]
    ds_read_b64_tr_b16 a[206:207], v1 offset:42816
    v_cvt_pk_bf16_f32 v31, v34, v35
    v_mfma_f32_16x16x32_bf16 v[36:39], a[40:43], v[84:87], v[36:39]
    v_mfma_f32_16x16x32_bf16 v[36:39], a[44:47], v[52:55], v[36:39]
    ds_read_b64_tr_b16 a[112:113], v1 offset:46528
    v_mfma_f32_16x16x32_bf16 v[36:39], a[48:51], a[156:159], v[36:39]
    ds_read_b64_tr_b16 a[114:115], v1 offset:47040
    v_mfma_f32_16x16x32_bf16 v[36:39], a[52:55], a[152:155], v[36:39]
    v_mfma_f32_16x16x32_bf16 v[36:39], a[56:59], a[148:151], v[36:39]
    ds_read_b64_tr_b16 a[208:209], v2 offset:50752
    v_mfma_f32_16x16x32_bf16 v[36:39], a[60:63], a[144:147], v[36:39]
    s_xor_b32 s100, s99, 384
    ds_read_b64_tr_b16 a[210:211], v2 offset:51264
    v_mfma_f32_16x16x32_bf16 v[40:43], a[60:63], a[160:163], 0
    buffer_store_dwordx4 v[28:31], v8, s[20:23], s100 offen offset:0 sc1 nt
    v_mfma_f32_16x16x32_bf16 v[40:43], a[56:59], a[164:167], v[40:43]
    ds_read_b64_tr_b16 a[108:109], v2 offset:54976
    v_mfma_f32_16x16x32_bf16 v[40:43], a[52:55], a[168:171], v[40:43]
    ds_read_b64_tr_b16 a[110:111], v2 offset:55488
    v_mfma_f32_16x16x32_bf16 v[40:43], a[48:51], v[44:47], v[40:43]
    v_mfma_f32_16x16x32_bf16 v[40:43], a[44:47], v[56:59], v[40:43]
    ds_read_b64_tr_b16 a[212:213], v2 offset:59200
    v_mfma_f32_16x16x32_bf16 v[40:43], a[40:43], v[88:91], v[40:43]
    ds_read_b64_tr_b16 a[214:215], v2 offset:59712
    v_mul_f32 v36, v25, v36
    v_mfma_f32_16x16x32_bf16 v[40:43], a[36:39], v[104:107], v[40:43]
    ds_read_b64_tr_b16 a[104:105], v2 offset:63424
    v_mul_f32 v37, v25, v37
    v_mfma_f32_16x16x32_bf16 v[40:43], a[32:35], v[120:123], v[40:43]
    v_mul_f32 v38, v25, v38
    v_mul_f32 v39, v25, v39
    v_mfma_f32_16x16x32_bf16 v[40:43], a[64:67], v[136:139], v[40:43]
    ds_read_b64_tr_b16 a[106:107], v2 offset:63936
    v_cvt_pk_bf16_f32 v22, v36, v37
    v_mfma_f32_16x16x32_bf16 v[40:43], a[68:71], v[152:155], v[40:43]
    ds_read_b64_tr_b16 a[216:217], v3 offset:64
    v_cvt_pk_bf16_f32 v23, v38, v39
    v_mfma_f32_16x16x32_bf16 v[40:43], a[72:75], v[168:171], v[40:43]
    v_mfma_f32_16x16x32_bf16 v[40:43], a[76:79], v[184:187], v[40:43]
    ds_read_b64_tr_b16 a[218:219], v3 offset:576
    v_mfma_f32_16x16x32_bf16 v[40:43], a[80:83], v[200:203], v[40:43]
    ds_read_b64_tr_b16 a[100:101], v3 offset:4288
    v_mfma_f32_16x16x32_bf16 v[40:43], a[84:87], v[216:219], v[40:43]
    v_mfma_f32_16x16x32_bf16 v[40:43], a[88:91], v[232:235], v[40:43]
    ds_read_b64_tr_b16 a[102:103], v3 offset:4800
    v_mfma_f32_16x16x32_bf16 v[40:43], a[92:95], v[248:251], v[40:43]
    s_xor_b32 s100, s99, 8576
    ds_read_b64_tr_b16 a[220:221], v3 offset:8512
    v_mfma_f32_16x16x32_bf16 v[32:35], a[92:95], v[252:255], 0
    buffer_store_dwordx4 v[20:23], v8, s[20:23], s100 offen offset:0 sc1 nt
    v_mfma_f32_16x16x32_bf16 v[32:35], a[88:91], v[236:239], v[32:35]
    ds_read_b64_tr_b16 a[222:223], v3 offset:9024
    v_mfma_f32_16x16x32_bf16 v[32:35], a[84:87], v[220:223], v[32:35]
    ds_read_b64_tr_b16 a[96:97], v3 offset:12736
    v_mfma_f32_16x16x32_bf16 v[32:35], a[80:83], v[204:207], v[32:35]
    v_mfma_f32_16x16x32_bf16 v[32:35], a[76:79], v[188:191], v[32:35]
    ds_read_b64_tr_b16 a[98:99], v3 offset:13248
    v_mfma_f32_16x16x32_bf16 v[32:35], a[72:75], v[172:175], v[32:35]
    ds_read_b64_tr_b16 a[188:189], v3 offset:12744
    v_mul_f32 v40, v26, v40
    v_mfma_f32_16x16x32_bf16 v[32:35], a[68:71], v[156:159], v[32:35]
    ds_read_b64_tr_b16 a[190:191], v3 offset:13256
    v_mul_f32 v41, v26, v41
    v_mfma_f32_16x16x32_bf16 v[32:35], a[64:67], v[140:143], v[32:35]
    ds_read_b64_tr_b16 a[184:185], v3 offset:8520
    v_mul_f32 v42, v26, v42
    v_mfma_f32_16x16x32_bf16 v[32:35], a[32:35], v[124:127], v[32:35]
    ds_read_b64_tr_b16 a[186:187], v3 offset:9032
    v_mul_f32 v43, v26, v43
    v_mfma_f32_16x16x32_bf16 v[32:35], a[36:39], v[108:111], v[32:35]
    ds_read_b64_tr_b16 a[180:181], v3 offset:4296
    v_cvt_pk_bf16_f32 v18, v40, v41
    v_mfma_f32_16x16x32_bf16 v[32:35], a[40:43], v[92:95], v[32:35]
    ds_read_b64_tr_b16 a[182:183], v3 offset:4808
    v_cvt_pk_bf16_f32 v19, v42, v43
    v_mfma_f32_16x16x32_bf16 v[32:35], a[44:47], v[76:79], v[32:35]
    ds_read_b64_tr_b16 a[176:177], v3 offset:72
    v_mfma_f32_16x16x32_bf16 v[32:35], a[48:51], v[72:75], v[32:35]
    ds_read_b64_tr_b16 a[178:179], v3 offset:584
    v_mfma_f32_16x16x32_bf16 v[32:35], a[52:55], v[68:71], v[32:35]
    ds_read_b64_tr_b16 a[172:173], v2 offset:63432
    v_mfma_f32_16x16x32_bf16 v[32:35], a[56:59], v[64:67], v[32:35]
    s_xor_b32 s100, s99, 16768
    ds_read_b64_tr_b16 a[174:175], v2 offset:63944
    v_mfma_f32_16x16x32_bf16 v[32:35], a[60:63], v[60:63], v[32:35]
    s_waitcnt lgkmcnt(7)
    ds_read_b64_tr_b16 a[232:233], v2 offset:59208
    buffer_store_dwordx4 v[16:19], v8, s[20:23], s100 offen offset:0 sc1 nt
    v_mfma_f32_16x16x32_bf16 v[36:39], a[192:195], a[128:131], 0
L_pad9:
    s_cbranch_vccnz L_warm_done
    ds_read_b64_tr_b16 a[234:235], v2 offset:59720
    v_mfma_f32_16x16x32_bf16 v[36:39], a[124:127], a[132:135], v[36:39]
    ds_read_b64_tr_b16 a[228:229], v2 offset:54984
    v_mfma_f32_16x16x32_bf16 v[36:39], a[196:199], a[136:139], v[36:39]
    ds_read_b64_tr_b16 a[230:231], v2 offset:55496
    v_mfma_f32_16x16x32_bf16 v[36:39], a[120:123], a[140:143], v[36:39]
    ds_read_b64_tr_b16 a[224:225], v2 offset:50760
    v_mfma_f32_16x16x32_bf16 v[36:39], a[200:203], v[48:51], v[36:39]
    ds_read_b64_tr_b16 a[226:227], v2 offset:51272
    v_mfma_f32_16x16x32_bf16 v[36:39], a[116:119], v[80:83], v[36:39]
    ds_read_b64_tr_b16 a[0:1], v1 offset:46536
    v_mul_f32 v32, v27, v32
    v_mfma_f32_16x16x32_bf16 v[36:39], a[204:207], v[96:99], v[36:39]
    ds_read_b64_tr_b16 a[2:3], v1 offset:47048
    v_mul_f32 v33, v27, v33
    v_mfma_f32_16x16x32_bf16 v[36:39], a[112:115], v[112:115], v[36:39]
    ds_read_b64_tr_b16 a[4:5], v1 offset:42312
    v_mul_f32 v34, v27, v34
    v_mfma_f32_16x16x32_bf16 v[36:39], a[208:211], v[128:131], v[36:39]
    ds_read_b64_tr_b16 a[6:7], v1 offset:42824
    v_mul_f32 v35, v27, v35
    v_mfma_f32_16x16x32_bf16 v[36:39], a[108:111], v[144:147], v[36:39]
    ds_read_b64_tr_b16 a[8:9], v1 offset:38088
    v_cvt_pk_bf16_f32 v14, v32, v33
    v_mfma_f32_16x16x32_bf16 v[36:39], a[212:215], v[160:163], v[36:39]
    ds_read_b64_tr_b16 a[10:11], v1 offset:38600
    v_cvt_pk_bf16_f32 v15, v34, v35
    v_mfma_f32_16x16x32_bf16 v[36:39], a[104:107], v[176:179], v[36:39]
    ds_read_b64_tr_b16 a[12:13], v1 offset:33864
    v_mfma_f32_16x16x32_bf16 v[36:39], a[216:219], v[192:195], v[36:39]
    ds_read_b64_tr_b16 a[14:15], v1 offset:34376
    v_mfma_f32_16x16x32_bf16 v[36:39], a[100:103], v[208:211], v[36:39]
    ds_read_b64_tr_b16 a[16:17], v1 offset:29640
    v_mfma_f32_16x16x32_bf16 v[36:39], a[220:223], v[224:227], v[36:39]
    s_xor_b32 s100, s99, 24960
    ds_read_b64_tr_b16 a[18:19], v1 offset:30152
    v_mfma_f32_16x16x32_bf16 v[36:39], a[96:99], v[240:243], v[36:39]
    ds_read_b64_tr_b16 a[20:21], v1 offset:25416
    buffer_store_dwordx4 v[12:15], v8, s[20:23], s100 offen offset:0 sc1 nt
    v_mfma_f32_16x16x32_bf16 v[40:43], a[188:191], v[240:243], 0
    s_waitcnt lgkmcnt(7)
    ds_read_b64_tr_b16 a[22:23], v1 offset:25928
    v_mfma_f32_16x16x32_bf16 v[40:43], a[184:187], v[224:227], v[40:43]
    ds_read_b64_tr_b16 a[24:25], v1 offset:21192
    v_mfma_f32_16x16x32_bf16 v[40:43], a[180:183], v[208:211], v[40:43]
    ds_read_b64_tr_b16 a[26:27], v1 offset:21704
    v_mfma_f32_16x16x32_bf16 v[40:43], a[176:179], v[192:195], v[40:43]
    ds_read_b64_tr_b16 a[28:29], v1 offset:16968
    v_mfma_f32_16x16x32_bf16 v[40:43], a[172:175], v[176:179], v[40:43]
    ds_read_b64_tr_b16 a[30:31], v1 offset:17480
    v_mfma_f32_16x16x32_bf16 v[40:43], a[232:235], v[160:163], v[40:43]
    v_mfma_f32_16x16x32_bf16 v[40:43], a[228:231], v[144:147], v[40:43]
    v_mfma_f32_16x16x32_bf16 v[40:43], a[224:227], v[128:131], v[40:43]
    v_mul_f32 v36, v24, v36
    v_mul_f32 v37, v24, v37
    v_mfma_f32_16x16x32_bf16 v[40:43], a[0:3], v[112:115], v[40:43]
    v_mul_f32 v38, v24, v38
    v_mul_f32 v39, v24, v39
    v_mfma_f32_16x16x32_bf16 v[40:43], a[4:7], v[96:99], v[40:43]
    s_waitcnt lgkmcnt(3)
    v_cvt_pk_bf16_f32 v28, v36, v37
    v_cvt_pk_bf16_f32 v29, v38, v39
    v_mfma_f32_16x16x32_bf16 v[40:43], a[8:11], v[80:83], v[40:43]
    v_mfma_f32_16x16x32_bf16 v[40:43], a[12:15], v[48:51], v[40:43]
    v_mfma_f32_16x16x32_bf16 v[40:43], a[16:19], a[140:143], v[40:43]
    v_mfma_f32_16x16x32_bf16 v[40:43], a[20:23], a[136:139], v[40:43]
    s_waitcnt lgkmcnt(0)
    v_mfma_f32_16x16x32_bf16 v[40:43], a[24:27], a[132:135], v[40:43]
    v_mfma_f32_16x16x32_bf16 v[40:43], a[28:31], a[128:131], v[40:43]
    v_mfma_f32_16x16x32_bf16 v[32:35], a[28:31], a[144:147], 0
    v_mfma_f32_16x16x32_bf16 v[32:35], a[24:27], a[148:151], v[32:35]
    v_mfma_f32_16x16x32_bf16 v[32:35], a[20:23], a[152:155], v[32:35]
    v_mfma_f32_16x16x32_bf16 v[32:35], a[16:19], a[156:159], v[32:35]
    v_mfma_f32_16x16x32_bf16 v[32:35], a[12:15], v[52:55], v[32:35]
    v_mfma_f32_16x16x32_bf16 v[32:35], a[8:11], v[84:87], v[32:35]
    v_mfma_f32_16x16x32_bf16 v[32:35], a[4:7], v[100:103], v[32:35]
    v_mfma_f32_16x16x32_bf16 v[32:35], a[0:3], v[116:119], v[32:35]
    v_mul_f32 v40, v24, v40
    v_mul_f32 v41, v24, v41
    v_mfma_f32_16x16x32_bf16 v[32:35], a[224:227], v[132:135], v[32:35]
    v_mul_f32 v42, v24, v42
    v_mul_f32 v43, v24, v43
    v_mfma_f32_16x16x32_bf16 v[32:35], a[228:231], v[148:151], v[32:35]
    v_cvt_pk_bf16_f32 v30, v40, v41
    v_cvt_pk_bf16_f32 v31, v42, v43
    v_mfma_f32_16x16x32_bf16 v[32:35], a[232:235], v[164:167], v[32:35]
    v_mfma_f32_16x16x32_bf16 v[32:35], a[172:175], v[180:183], v[32:35]
    v_mfma_f32_16x16x32_bf16 v[32:35], a[176:179], v[196:199], v[32:35]
    v_mfma_f32_16x16x32_bf16 v[32:35], a[180:183], v[212:215], v[32:35]
    v_mfma_f32_16x16x32_bf16 v[32:35], a[184:187], v[228:231], v[32:35]
    s_xor_b32 s100, s99, 384
    v_mfma_f32_16x16x32_bf16 v[32:35], a[188:191], v[244:247], v[32:35]
    buffer_store_dwordx4 v[28:31], v8, s[20:23], s100 offen offset:64 sc1 nt
    v_mfma_f32_16x16x32_bf16 v[36:39], a[96:99], v[244:247], 0
    v_mfma_f32_16x16x32_bf16 v[36:39], a[220:223], v[228:231], v[36:39]
    v_mfma_f32_16x16x32_bf16 v[36:39], a[100:103], v[212:215], v[36:39]
    v_mfma_f32_16x16x32_bf16 v[36:39], a[216:219], v[196:199], v[36:39]
    v_mfma_f32_16x16x32_bf16 v[36:39], a[104:107], v[180:183], v[36:39]
    v_mfma_f32_16x16x32_bf16 v[36:39], a[212:215], v[164:167], v[36:39]
    v_mfma_f32_16x16x32_bf16 v[36:39], a[108:111], v[148:151], v[36:39]
    v_mfma_f32_16x16x32_bf16 v[36:39], a[208:211], v[132:135], v[36:39]
    v_mul_f32 v32, v25, v32
    v_mul_f32 v33, v25, v33
    v_mfma_f32_16x16x32_bf16 v[36:39], a[112:115], v[116:119], v[36:39]
    v_mul_f32 v34, v25, v34
    v_mul_f32 v35, v25, v35
    v_mfma_f32_16x16x32_bf16 v[36:39], a[204:207], v[100:103], v[36:39]
    v_cvt_pk_bf16_f32 v22, v32, v33
    v_cvt_pk_bf16_f32 v23, v34, v35
    v_mfma_f32_16x16x32_bf16 v[36:39], a[116:119], v[84:87], v[36:39]
    v_mfma_f32_16x16x32_bf16 v[36:39], a[200:203], v[52:55], v[36:39]
    v_mfma_f32_16x16x32_bf16 v[36:39], a[120:123], a[156:159], v[36:39]
    v_mfma_f32_16x16x32_bf16 v[36:39], a[196:199], a[152:155], v[36:39]
    v_mfma_f32_16x16x32_bf16 v[36:39], a[124:127], a[148:151], v[36:39]
    v_mfma_f32_16x16x32_bf16 v[36:39], a[192:195], a[144:147], v[36:39]
    v_mfma_f32_16x16x32_bf16 v[40:43], a[192:195], a[160:163], 0
    v_mfma_f32_16x16x32_bf16 v[40:43], a[124:127], a[164:167], v[40:43]
    v_mfma_f32_16x16x32_bf16 v[40:43], a[196:199], a[168:171], v[40:43]
    v_mfma_f32_16x16x32_bf16 v[40:43], a[120:123], v[44:47], v[40:43]
    v_mfma_f32_16x16x32_bf16 v[40:43], a[200:203], v[56:59], v[40:43]
    v_mfma_f32_16x16x32_bf16 v[40:43], a[116:119], v[88:91], v[40:43]
    v_mfma_f32_16x16x32_bf16 v[40:43], a[204:207], v[104:107], v[40:43]
    v_mfma_f32_16x16x32_bf16 v[40:43], a[112:115], v[120:123], v[40:43]
    v_mul_f32 v36, v25, v36
    v_mul_f32 v37, v25, v37
    v_mfma_f32_16x16x32_bf16 v[40:43], a[208:211], v[136:139], v[40:43]
    v_mul_f32 v38, v25, v38
    v_mul_f32 v39, v25, v39
    v_mfma_f32_16x16x32_bf16 v[40:43], a[108:111], v[152:155], v[40:43]
    v_cvt_pk_bf16_f32 v20, v36, v37
    v_cvt_pk_bf16_f32 v21, v38, v39
    v_mfma_f32_16x16x32_bf16 v[40:43], a[212:215], v[168:171], v[40:43]
    v_mfma_f32_16x16x32_bf16 v[40:43], a[104:107], v[184:187], v[40:43]
    v_mfma_f32_16x16x32_bf16 v[40:43], a[216:219], v[200:203], v[40:43]
    v_mfma_f32_16x16x32_bf16 v[40:43], a[100:103], v[216:219], v[40:43]
    v_mfma_f32_16x16x32_bf16 v[40:43], a[220:223], v[232:235], v[40:43]
    s_xor_b32 s100, s99, 8576
    v_mfma_f32_16x16x32_bf16 v[40:43], a[96:99], v[248:251], v[40:43]
    buffer_store_dwordx4 v[20:23], v8, s[20:23], s100 offen offset:64 sc1 nt
    v_mfma_f32_16x16x32_bf16 v[32:35], a[188:191], v[248:251], 0
    v_mfma_f32_16x16x32_bf16 v[32:35], a[184:187], v[232:235], v[32:35]
    v_mfma_f32_16x16x32_bf16 v[32:35], a[180:183], v[216:219], v[32:35]
    v_mfma_f32_16x16x32_bf16 v[32:35], a[176:179], v[200:203], v[32:35]
    v_mfma_f32_16x16x32_bf16 v[32:35], a[172:175], v[184:187], v[32:35]
    v_mfma_f32_16x16x32_bf16 v[32:35], a[232:235], v[168:171], v[32:35]
    v_mfma_f32_16x16x32_bf16 v[32:35], a[228:231], v[152:155], v[32:35]
    v_mfma_f32_16x16x32_bf16 v[32:35], a[224:227], v[136:139], v[32:35]
    v_mul_f32 v40, v26, v40
    v_mul_f32 v41, v26, v41
    v_mfma_f32_16x16x32_bf16 v[32:35], a[0:3], v[120:123], v[32:35]
    v_mul_f32 v42, v26, v42
    v_mul_f32 v43, v26, v43
    v_mfma_f32_16x16x32_bf16 v[32:35], a[4:7], v[104:107], v[32:35]
    v_cvt_pk_bf16_f32 v16, v40, v41
    v_cvt_pk_bf16_f32 v17, v42, v43
    v_mfma_f32_16x16x32_bf16 v[32:35], a[8:11], v[88:91], v[32:35]
    v_mfma_f32_16x16x32_bf16 v[32:35], a[12:15], v[56:59], v[32:35]
    v_mfma_f32_16x16x32_bf16 v[32:35], a[16:19], v[44:47], v[32:35]
    v_mfma_f32_16x16x32_bf16 v[32:35], a[20:23], a[168:171], v[32:35]
    v_mfma_f32_16x16x32_bf16 v[32:35], a[24:27], a[164:167], v[32:35]
    v_mfma_f32_16x16x32_bf16 v[32:35], a[28:31], a[160:163], v[32:35]
    v_mfma_f32_16x16x32_bf16 v[36:39], a[28:31], v[60:63], 0
    v_mfma_f32_16x16x32_bf16 v[36:39], a[24:27], v[64:67], v[36:39]
    v_mfma_f32_16x16x32_bf16 v[36:39], a[20:23], v[68:71], v[36:39]
    v_mfma_f32_16x16x32_bf16 v[36:39], a[16:19], v[72:75], v[36:39]
    v_mfma_f32_16x16x32_bf16 v[36:39], a[12:15], v[76:79], v[36:39]
    v_mfma_f32_16x16x32_bf16 v[36:39], a[8:11], v[92:95], v[36:39]
    v_mfma_f32_16x16x32_bf16 v[36:39], a[4:7], v[108:111], v[36:39]
    v_mfma_f32_16x16x32_bf16 v[36:39], a[0:3], v[124:127], v[36:39]
    v_mul_f32 v32, v26, v32
    v_mul_f32 v33, v26, v33
    v_mfma_f32_16x16x32_bf16 v[36:39], a[224:227], v[140:143], v[36:39]
    v_mul_f32 v34, v26, v34
    v_mul_f32 v35, v26, v35
    v_mfma_f32_16x16x32_bf16 v[36:39], a[228:231], v[156:159], v[36:39]
    v_cvt_pk_bf16_f32 v18, v32, v33
    v_cvt_pk_bf16_f32 v19, v34, v35
    v_mfma_f32_16x16x32_bf16 v[36:39], a[232:235], v[172:175], v[36:39]
    v_mfma_f32_16x16x32_bf16 v[36:39], a[172:175], v[188:191], v[36:39]
    v_mfma_f32_16x16x32_bf16 v[36:39], a[176:179], v[204:207], v[36:39]
    v_mfma_f32_16x16x32_bf16 v[36:39], a[180:183], v[220:223], v[36:39]
    v_mfma_f32_16x16x32_bf16 v[36:39], a[184:187], v[236:239], v[36:39]
    s_xor_b32 s100, s99, 16768
    v_mfma_f32_16x16x32_bf16 v[36:39], a[188:191], v[252:255], v[36:39]
    buffer_store_dwordx4 v[16:19], v8, s[20:23], s100 offen offset:64 sc1 nt
    v_mfma_f32_16x16x32_bf16 v[40:43], a[96:99], v[252:255], 0
    v_mfma_f32_16x16x32_bf16 v[40:43], a[220:223], v[236:239], v[40:43]
    v_mfma_f32_16x16x32_bf16 v[40:43], a[100:103], v[220:223], v[40:43]
    v_mfma_f32_16x16x32_bf16 v[40:43], a[216:219], v[204:207], v[40:43]
    v_mfma_f32_16x16x32_bf16 v[40:43], a[104:107], v[188:191], v[40:43]
    v_mfma_f32_16x16x32_bf16 v[40:43], a[212:215], v[172:175], v[40:43]
    v_mfma_f32_16x16x32_bf16 v[40:43], a[108:111], v[156:159], v[40:43]
    v_mfma_f32_16x16x32_bf16 v[40:43], a[208:211], v[140:143], v[40:43]
    v_mul_f32 v36, v27, v36
    v_mul_f32 v37, v27, v37
    v_mfma_f32_16x16x32_bf16 v[40:43], a[112:115], v[124:127], v[40:43]
    v_mul_f32 v38, v27, v38
    v_mul_f32 v39, v27, v39
    v_mfma_f32_16x16x32_bf16 v[40:43], a[204:207], v[108:111], v[40:43]
    v_cvt_pk_bf16_f32 v14, v36, v37
    v_cvt_pk_bf16_f32 v15, v38, v39
    v_mfma_f32_16x16x32_bf16 v[40:43], a[116:119], v[92:95], v[40:43]
    v_mfma_f32_16x16x32_bf16 v[40:43], a[200:203], v[76:79], v[40:43]
    v_mfma_f32_16x16x32_bf16 v[40:43], a[120:123], v[72:75], v[40:43]
    v_mfma_f32_16x16x32_bf16 v[40:43], a[196:199], v[68:71], v[40:43]
    v_mfma_f32_16x16x32_bf16 v[40:43], a[124:127], v[64:67], v[40:43]
    v_mfma_f32_16x16x32_bf16 v[40:43], a[192:195], v[60:63], v[40:43]
    s_xor_b32 s100, s99, 24960
    s_nop 6
    v_mul_f32 v40, v27, v40
    v_mul_f32 v41, v27, v41
    v_mul_f32 v42, v27, v42
    v_mul_f32 v43, v27, v43
    v_cvt_pk_bf16_f32 v12, v40, v41
    v_cvt_pk_bf16_f32 v13, v42, v43
    buffer_store_dwordx4 v[12:15], v8, s[20:23], s100 offen offset:64 sc1 nt
    s_cmp_lg_u64 s[94:95], 0
    s_cbranch_scc1 L_redo
L_fin:
L_end:
    s_endpgm
L_redo:
    s_cmp_lg_u32 s27, 0
    s_cbranch_scc1 L_fin
    s_mov_b32 s27, 1
    s_waitcnt vmcnt(0) lgkmcnt(0)
    s_nop 7
    v_and_b32 v16, 0xfffffe00, v8
    v_lshrrev_b32 v17, 4, v0
    v_lshl_add_u32 v16, v17, 4, v16
    s_xor_b32 s29, s97, 0
    s_and_b32 s29, s29, 24576
    buffer_load_dwordx4 a[0:3], v16, s[8:11], s29 offen offset:0
    buffer_load_dwordx4 a[4:7], v16, s[8:11], s29 offen offset:64
    buffer_load_dwordx4 a[8:11], v16, s[8:11], s29 offen offset:128
    buffer_load_dwordx4 a[12:15], v16, s[8:11], s29 offen offset:192
    buffer_load_dwordx4 a[16:19], v16, s[8:11], s29 offen offset:256
    buffer_load_dwordx4 a[20:23], v16, s[8:11], s29 offen offset:320
    buffer_load_dwordx4 a[24:27], v16, s[8:11], s29 offen offset:384
    buffer_load_dwordx4 a[28:31], v16, s[8:11], s29 offen offset:448
    s_xor_b32 s29, s97, 8192
    s_and_b32 s29, s29, 24576
    buffer_load_dwordx4 a[32:35], v16, s[8:11], s29 offen offset:0
    buffer_load_dwordx4 a[36:39], v16, s[8:11], s29 offen offset:64
    buffer_load_dwordx4 a[40:43], v16, s[8:11], s29 offen offset:128
    buffer_load_dwordx4 a[44:47], v16, s[8:11], s29 offen offset:192
    buffer_load_dwordx4 a[48:51], v16, s[8:11], s29 offen offset:256
    buffer_load_dwordx4 a[52:55], v16, s[8:11], s29 offen offset:320
    buffer_load_dwordx4 a[56:59], v16, s[8:11], s29 offen offset:384
    buffer_load_dwordx4 a[60:63], v16, s[8:11], s29 offen offset:448
    s_xor_b32 s29, s97, 16384
    s_and_b32 s29, s29, 24576
    buffer_load_dwordx4 a[64:67], v16, s[8:11], s29 offen offset:0
    buffer_load_dwordx4 a[68:71], v16, s[8:11], s29 offen offset:64
    buffer_load_dwordx4 a[72:75], v16, s[8:11], s29 offen offset:128
    buffer_load_dwordx4 a[76:79], v16, s[8:11], s29 offen offset:192
    buffer_load_dwordx4 a[80:83], v16, s[8:11], s29 offen offset:256
    buffer_load_dwordx4 a[84:87], v16, s[8:11], s29 offen offset:320
    buffer_load_dwordx4 a[88:91], v16, s[8:11], s29 offen offset:384
    buffer_load_dwordx4 a[92:95], v16, s[8:11], s29 offen offset:448
    s_xor_b32 s29, s97, 24576
    s_and_b32 s29, s29, 24576
    buffer_load_dwordx4 a[96:99], v16, s[8:11], s29 offen offset:0
    buffer_load_dwordx4 a[100:103], v16, s[8:11], s29 offen offset:64
    buffer_load_dwordx4 a[104:107], v16, s[8:11], s29 offen offset:128
    buffer_load_dwordx4 a[108:111], v16, s[8:11], s29 offen offset:192
    buffer_load_dwordx4 a[112:115], v16, s[8:11], s29 offen offset:256
    buffer_load_dwordx4 a[116:119], v16, s[8:11], s29 offen offset:320
    buffer_load_dwordx4 a[120:123], v16, s[8:11], s29 offen offset:384
    buffer_load_dwordx4 a[124:127], v16, s[8:11], s29 offen offset:448
    v_mov_b32 v12, 0xff800000
    v_mov_b32 v13, 0xff800000
    v_mov_b32 v14, 0xff800000
    v_mov_b32 v15, 0xff800000
    s_mov_b32 s28, 0
L_redo_loop:
    buffer_load_dwordx4 a[192:195], v16, s[12:15], s28 offen offset:0
    buffer_load_dwordx4 a[196:199], v16, s[12:15], s28 offen offset:64
    buffer_load_dwordx4 a[200:203], v16, s[12:15], s28 offen offset:128
    buffer_load_dwordx4 a[204:207], v16, s[12:15], s28 offen offset:192
    buffer_load_dwordx4 a[208:211], v16, s[12:15], s28 offen offset:256
    buffer_load_dwordx4 a[212:215], v16, s[12:15], s28 offen offset:320
    buffer_load_dwordx4 a[216:219], v16, s[12:15], s28 offen offset:384
    buffer_load_dwordx4 a[220:223], v16, s[12:15], s28 offen offset:448
    s_waitcnt vmcnt(0)
    v_mfma_f32_16x16x32_bf16 v[32:35], a[192:195], a[0:3], 0
    v_mfma_f32_16x16x32_bf16 v[36:39], a[192:195], a[32:35], 0
    v_mfma_f32_16x16x32_bf16 v[40:43], a[192:195], a[64:67], 0
    v_mfma_f32_16x16x32_bf16 v[44:47], a[192:195], a[96:99], 0
    v_mfma_f32_16x16x32_bf16 v[32:35], a[196:199], a[4:7], v[32:35]
    v_mfma_f32_16x16x32_bf16 v[36:39], a[196:199], a[36:39], v[36:39]
    v_mfma_f32_16x16x32_bf16 v[40:43], a[196:199], a[68:71], v[40:43]
    v_mfma_f32_16x16x32_bf16 v[44:47], a[196:199], a[100:103], v[44:47]
    v_mfma_f32_16x16x32_bf16 v[32:35], a[200:203], a[8:11], v[32:35]
    v_mfma_f32_16x16x32_bf16 v[36:39], a[200:203], a[40:43], v[36:39]
    v_mfma_f32_16x16x32_bf16 v[40:43], a[200:203], a[72:75], v[40:43]
    v_mfma_f32_16x16x32_bf16 v[44:47], a[200:203], a[104:107], v[44:47]
    v_mfma_f32_16x16x32_bf16 v[32:35], a[204:207], a[12:15], v[32:35]
    v_mfma_f32_16x16x32_bf16 v[36:39], a[204:207], a[44:47], v[36:39]
    v_mfma_f32_16x16x32_bf16 v[40:43], a[204:207], a[76:79], v[40:43]
    v_mfma_f32_16x16x32_bf16 v[44:47], a[204:207], a[108:111], v[44:47]
    v_mfma_f32_16x16x32_bf16 v[32:35], a[208:211], a[16:19], v[32:35]
    v_mfma_f32_16x16x32_bf16 v[36:39], a[208:211], a[48:51], v[36:39]
    v_mfma_f32_16x16x32_bf16 v[40:43], a[208:211], a[80:83], v[40:43]
    v_mfma_f32_16x16x32_bf16 v[44:47], a[208:211], a[112:115], v[44:47]
    v_mfma_f32_16x16x32_bf16 v[32:35], a[212:215], a[20:23], v[32:35]
    v_mfma_f32_16x16x32_bf16 v[36:39], a[212:215], a[52:55], v[36:39]
    v_mfma_f32_16x16x32_bf16 v[40:43], a[212:215], a[84:87], v[40:43]
    v_mfma_f32_16x16x32_bf16 v[44:47], a[212:215], a[116:119], v[44:47]
    v_mfma_f32_16x16x32_bf16 v[32:35], a[216:219], a[24:27], v[32:35]
    v_mfma_f32_16x16x32_bf16 v[36:39], a[216:219], a[56:59], v[36:39]
    v_mfma_f32_16x16x32_bf16 v[40:43], a[216:219], a[88:91], v[40:43]
    v_mfma_f32_16x16x32_bf16 v[44:47], a[216:219], a[120:123], v[44:47]
    v_mfma_f32_16x16x32_bf16 v[32:35], a[220:223], a[28:31], v[32:35]
    v_mfma_f32_16x16x32_bf16 v[36:39], a[220:223], a[60:63], v[36:39]
    v_mfma_f32_16x16x32_bf16 v[40:43], a[220:223], a[92:95], v[40:43]
    v_mfma_f32_16x16x32_bf16 v[44:47], a[220:223], a[124:127], v[44:47]
    s_nop 7
    v_max3_f32 v12, v32, v33, v12
    v_max3_f32 v12, v34, v35, v12
    v_max3_f32 v13, v36, v37, v13
    v_max3_f32 v13, v38, v39, v13
    v_max3_f32 v14, v40, v41, v14
    v_max3_f32 v14, v42, v43, v14
    v_max3_f32 v15, v44, v45, v15
    v_max3_f32 v15, v46, v47, v15
    s_add_u32 s28, s28, 8192
    s_cmp_lt_u32 s28, 0x40000
    s_cbranch_scc1 L_redo_loop
    s_barrier
    s_branch L_start
L_code_end:
.section .rodata,"a"
.p2align 6
.amdhsa_kernel standalone__gqa_softmax__near_ridge_kernel
  .amdhsa_next_free_vgpr 512
  .amdhsa_next_free_sgpr 102
  .amdhsa_accum_offset 256
  .amdhsa_group_segment_fixed_size 0
  .amdhsa_kernarg_size 48
  .amdhsa_user_sgpr_count 2
  .amdhsa_user_sgpr_kernarg_segment_ptr 1
  .amdhsa_system_sgpr_workgroup_id_x 1
.end_amdhsa_kernel
```
